```python
import torch

def _softmax(x, axis=-1):
    return torch.softmax(x, dim=axis)
def _gelu(x):
    return torch.nn.functional.gelu(x, approximate="tanh")
def _silu(x):
    return torch.nn.functional.silu(x)
def _sigmoid(x):
    return torch.sigmoid(x)
def _layernorm(x, axis=-1, eps=1e-5):
    m = x.mean(dim=axis, keepdim=True)
    v = x.var(dim=axis, keepdim=True, unbiased=False)
    return (x - m) / torch.sqrt(v + eps)
def _scatter_add(tgt, idx, src, axis=0):
    return tgt.clone().index_add_(axis, idx, src)
def _segment_sum(src, seg, n):
    out = torch.zeros((n,) + src.shape[1:], dtype=src.dtype)
    return out.index_add_(0, seg, src)
def _pad(x, pw):
    flat = tuple(v for pair in reversed(pw) for v in pair)
    return torch.nn.functional.pad(x, flat)

kernel_name = 'recurrent_scan__mha_block_cached__dense_activation_silu__prompt'

def setup_inputs():

    _w = (lambda a: (lambda t: t.to(torch.bfloat16) if t.is_floating_point() else t)(torch.as_tensor(a)))
    def _A_setup():
        B, Sq, D = 1, 2048, 1024
        H, Sk, Dh = 32, 2048, 128
        return {
            "x": _w((lambda *s: torch.randn(*s, dtype=torch.bfloat16) * 0.05)(B, Sq, D)),
            "k_cache": _w((lambda *s: torch.randn(*s, dtype=torch.bfloat16) * 3.2)(B, H, Sk, Dh)),
            "v_cache": _w((lambda *s: torch.randn(*s, dtype=torch.bfloat16) * 3.2)(B, H, Sk, Dh)),
            "wq": _w((lambda *s: torch.randn(*s, dtype=torch.bfloat16) * 3.2)(D, H * Dh) * (D ** -0.5)),
            "wo": _w((lambda *s: torch.randn(*s, dtype=torch.bfloat16) * 3.2)(H * Dh, D) * ((H * Dh) ** -0.5)),
        }
    _A_in = _A_setup()

    def _B_setup():
        B, S, D, F = 1, 2048, 1024, 3584
        return {
            "x": _w((lambda *s: torch.randn(*s, dtype=torch.bfloat16) * 0.05)(B, S, D)),
            "w1": _w((lambda *s: torch.randn(*s, dtype=torch.bfloat16) * 3.2)(D, F) * (D ** -0.5)),
            "w2": _w((lambda *s: torch.randn(*s, dtype=torch.bfloat16) * 0.4)(F, D) * (F ** -0.5)),
        }
    _B_in = _B_setup()

    return {
        "A_x": _A_in["x"],
        "A_k_cache": _A_in["k_cache"],
        "A_v_cache": _A_in["v_cache"],
        "A_wq": _A_in["wq"],
        "A_wo": _A_in["wo"],
        "B_x": _B_in["x"],
        "B_w1": _B_in["w1"],
        "B_w2": _B_in["w2"],
    }

def reference(A_x, A_k_cache, A_v_cache, A_wq, A_wo, B_x, B_w1, B_w2):
    def _A_ref(x, k_cache, v_cache, wq, wo):
        B, Sq, D = x.shape
        H, Dh = 32, 128
        q = (lambda x, *d: x.permute(*d))((x @ wq).reshape(B, Sq, H, Dh), 0, 2, 1, 3)
        scores = torch.einsum("bhqd,bhkd->bhqk", q, k_cache) * (Dh ** -0.5)
        p = _softmax(scores, axis=-1)
        o = torch.einsum("bhqk,bhkd->bhqd", p, v_cache)
        return (lambda x, *d: x.permute(*d))(o, 0, 2, 1, 3).reshape(B, Sq, H * Dh) @ wo

    def _B_ref(x, w1, w2):
        h = torch.einsum("bsd,df->bsf", x, w1)
        h = _silu(h)
        out = torch.einsum("bsf,fd->bsd", h, w2)
        return out

    x = A_x
    xn = _layernorm(x, axis=-1)
    s = _A_ref(xn, A_k_cache, A_v_cache, A_wq, A_wo)
    g = _silu(_B_ref(xn, B_w1, B_w2))
    return x + s * g
```

```asm
; @launch grid=(256,1,1) block=(256,1,1) lds=163840
.amdgcn_target "amdgcn-amd-amdhsa--gfx950"
.text
.globl recurrent_scan__mha_block_cached__dense_activation_silu__prompt_kernel
.p2align 8
.type recurrent_scan__mha_block_cached__dense_activation_silu__prompt_kernel,@function
recurrent_scan__mha_block_cached__dense_activation_silu__prompt_kernel:
    s_cmp_ge_u32 s2, 256
    s_cbranch_scc1 k_done
    s_load_dwordx2 s[42:43], s[0:1], 0
    s_load_dwordx2 s[34:35], s[0:1], 80
    s_load_dwordx4 s[4:7], s[0:1], 8
    s_load_dwordx4 s[44:47], s[0:1], 24
    s_load_dwordx4 s[48:51], s[0:1], 48
    v_lshrrev_b32 v4, 6, v0
    v_and_b32 v1, 63, v0
    v_bfe_u32 v2, v0, 2, 2
    v_readfirstlane_b32 s20, v4
    v_and_b32 v3, 3, v0
    v_and_b32 v5, 15, v0
    v_bfe_u32 v4, v0, 4, 2
    s_and_b32 s3, s2, 7
    s_lshl_b32 s3, s3, 2
    s_lshr_b32 s29, s2, 6
    s_add_u32 s21, s3, s29
    s_bfe_u32 s22, s2, 0x30003
    s_lshl_b32 s101, s22, 5
    s_add_u32 s101, s101, s21
    s_lshl_b32 s3, s101, 3
    v_lshrrev_b32 v7, 5, v0
    v_add_u32 v7, s3, v7
    v_and_b32 v8, 31, v0
    v_lshlrev_b32 v156, 11, v7
    v_lshl_add_u32 v156, v8, 4, v156
    s_lshl_b32 s101, s101, 10
    s_lshl_b32 s3, s22, 7
    s_add_u32 s3, s3, 262144
    v_mov_b32 v158, s3
    s_waitcnt lgkmcnt(0)
    s_mov_b32 s12, s42
    s_mov_b32 s13, s43
    s_and_b32 s13, s13, 0xffff
    s_mov_b32 s14, 4194304
    s_mov_b32 s15, 0x20000
    buffer_load_dwordx4 v[96:99], v156, s[12:15], 0 offen offset:0
    buffer_load_dwordx4 v[100:103], v156, s[12:15], 0 offen offset:512
    buffer_load_dwordx4 v[104:107], v156, s[12:15], 0 offen offset:1024
    buffer_load_dwordx4 v[108:111], v156, s[12:15], 0 offen offset:1536
    s_add_u32 s98, s34, 62914560
    s_addc_u32 s99, s35, 0
    global_load_dword v159, v158, s[98:99] sc1
    s_getpc_b64 s[42:43]
recurrent_scan__mha_block_cached__dense_activation_silu__prompt_kernel_pc:
    s_and_b32 s42, s42, -16
    v_and_b32 v234, 0xff, v0
    v_lshlrev_b32 v234, 4, v234
    s_lshr_b32 s29, s2, 3
    s_lshl_b32 s29, s29, 12
    v_add_u32 v234, s29, v234
    v_min_u32 v234, (code_end-recurrent_scan__mha_block_cached__dense_activation_silu__prompt_kernel_pc-16)&~15, v234
    global_load_dwordx4 v[236:239], v234, s[42:43]
    v_lshrrev_b32 v9, 5, v0
    v_lshlrev_b32 v160, 4, v9
    v_lshl_add_u32 v160, v8, 7, v160
    v_and_b32 v161, 63, v0
    v_lshlrev_b32 v161, 4, v161
    v_lshrrev_b32 v9, 6, v0
    v_lshl_add_u32 v161, v9, 12, v161
    s_lshr_b32 s3, s101, 11
    s_lshl_b32 s3, s3, 15
    s_and_b32 s29, s21, 1
    s_lshl_b32 s29, s29, 7
    s_add_u32 s3, s3, s29
    v_lshlrev_b32 v157, 13, v9
    v_add_u32 v157, s3, v157
    v_bfe_u32 v9, v0, 5, 1
    v_lshl_add_u32 v157, v9, 10, v157
    v_bfe_u32 v9, v0, 3, 2
    v_lshl_add_u32 v157, v9, 8, v157
    v_and_b32 v9, 7, v0
    v_lshl_add_u32 v157, v9, 4, v157
    s_mov_b32 s36, s34
    s_mov_b32 s37, s35
    s_and_b32 s37, s37, 0xffff
    s_mov_b32 s38, 4194304
    s_mov_b32 s39, 0x20000
    s_lshl_b32 s25, s20, 12
    s_lshl_b32 s23, s20, 11
    v_lshlrev_b32 v6, 4, v1
    s_lshl_b32 s29, s20, 3
    v_add_u32 v7, s29, v4
    v_lshlrev_b32 v8, 2, v4
    v_xor_b32 v8, v8, v5
    v_lshlrev_b32 v9, 13, v7
    v_lshl_add_u32 v21, v8, 4, v9
    v_add_u32 v22, 31744, v21
    s_and_b32 s29, s20, 1
    s_lshl_b32 s29, s29, 2
    v_or_b32 v8, s29, v4
    v_lshlrev_b32 v8, 1, v8
    v_xor_b32 v8, v8, v5
    v_mul_u32_u24 v9, 7168, v7
    v_lshl_add_u32 v9, v8, 4, v9
    v_cmp_gt_u32 vcc, 14, v8
    v_mov_b32 v8, 0x80000000
    s_nop 0
    v_cndmask_b32 v23, v8, v9, vcc
    v_add_u32 v24, 27648, v23
    s_lshl_b32 s3, s21, 8
    s_sub_u32 s32, 8388608, s3
    s_mov_b32 s52, s44
    s_mov_b32 s53, s45
    s_add_u32 s52, s52, s3
    s_addc_u32 s53, s53, 0
    s_and_b32 s53, s53, 0xffff
    s_mov_b32 s54, s32
    s_mov_b32 s55, 0x20000
    s_mul_i32 s3, s21, 224
    s_sub_u32 s32, 7340032, s3
    s_mov_b32 s56, s48
    s_mov_b32 s57, s49
    s_add_u32 s56, s56, s3
    s_addc_u32 s57, s57, 0
    s_and_b32 s57, s57, 0xffff
    s_mov_b32 s58, s32
    s_mov_b32 s59, 0x20000
    s_mov_b32 s26, 0
    s_mov_b32 s27, 0
    s_mov_b32 s24, 0
    s_cmp_lt_u32 s20, 2
    s_cselect_b32 s60, s52, s56
    s_cselect_b32 s61, s53, s57
    s_cselect_b32 s62, s54, s58
    s_mov_b32 s63, 0x20000
    s_mov_b32 s29, 7168
    s_cselect_b32 s29, 8192, s29
    s_lshl_b32 s93, s29, 5
    s_and_b32 s32, s20, 1
    s_lshl_b32 s32, s32, 4
    v_lshrrev_b32 v7, 2, v1
    v_add_u32 v7, s32, v7
    v_mul_lo_u32 v7, v7, s29
    v_lshl_add_u32 v30, v3, 6, v7
    s_mul_i32 s96, s93, s22
    s_lshl_b32 s94, s93, 3
    s_sub_u32 s95, 8, s22
    s_add_u32 m0, s23, 98304
    s_nop 0
    buffer_load_dwordx4 v21, s[52:55], s27 offen offset:0 lds
    buffer_load_dwordx4 v22, s[52:55], s27 offen offset:1024 lds
    s_add_u32 m0, s23, 106496
    s_nop 0
    buffer_load_dwordx4 v23, s[56:59], s24 offen offset:0 lds
    buffer_load_dwordx4 v24, s[56:59], s24 offen offset:1024 lds
    s_add_u32 s27, s27, 262144
    s_add_u32 s24, s24, 229376
    s_add_u32 m0, s23, 114688
    s_nop 0
    buffer_load_dwordx4 v21, s[52:55], s27 offen offset:0 lds
    buffer_load_dwordx4 v22, s[52:55], s27 offen offset:1024 lds
    s_add_u32 m0, s23, 122880
    s_nop 0
    buffer_load_dwordx4 v23, s[56:59], s24 offen offset:0 lds
    buffer_load_dwordx4 v24, s[56:59], s24 offen offset:1024 lds
    s_add_u32 s27, s27, 262144
    s_add_u32 s24, s24, 229376
    s_add_u32 m0, s23, 131072
    s_nop 0
    buffer_load_dwordx4 v21, s[52:55], s27 offen offset:0 lds
    buffer_load_dwordx4 v22, s[52:55], s27 offen offset:1024 lds
    s_add_u32 m0, s23, 139264
    s_nop 0
    buffer_load_dwordx4 v23, s[56:59], s24 offen offset:0 lds
    buffer_load_dwordx4 v24, s[56:59], s24 offen offset:1024 lds
    s_add_u32 s27, s27, 262144
    s_add_u32 s24, s24, 229376
    s_lshl_b32 s3, s21, 19
    s_cmp_lt_u32 s20, 2
    s_cselect_b32 s44, s4, s6
    s_cselect_b32 s45, s5, s7
    s_mov_b32 s44, s44
    s_mov_b32 s45, s45
    s_add_u32 s44, s44, s3
    s_addc_u32 s45, s45, 0
    s_and_b32 s45, s45, 0xffff
    s_mov_b32 s46, 524288
    s_mov_b32 s47, 0x20000
    s_and_b32 s3, s20, 1
    s_lshl_b32 s48, s22, 1
    s_add_u32 s48, s48, s3
    s_lshl_b32 s48, s48, 10
    s_mov_b32 s32, 0x3a800000
    s_waitcnt vmcnt(17)
    v_lshlrev_b32 v112, 16, v96
    v_and_b32 v113, 0xffff0000, v96
    v_lshlrev_b32 v114, 16, v97
    v_and_b32 v115, 0xffff0000, v97
    v_lshlrev_b32 v116, 16, v98
    v_and_b32 v117, 0xffff0000, v98
    v_lshlrev_b32 v118, 16, v99
    v_and_b32 v119, 0xffff0000, v99
    s_waitcnt vmcnt(16)
    v_lshlrev_b32 v120, 16, v100
    v_and_b32 v121, 0xffff0000, v100
    v_lshlrev_b32 v122, 16, v101
    v_and_b32 v123, 0xffff0000, v101
    v_lshlrev_b32 v124, 16, v102
    v_and_b32 v125, 0xffff0000, v102
    v_lshlrev_b32 v126, 16, v103
    v_and_b32 v127, 0xffff0000, v103
    s_waitcnt vmcnt(15)
    v_lshlrev_b32 v128, 16, v104
    v_and_b32 v129, 0xffff0000, v104
    v_lshlrev_b32 v130, 16, v105
    v_and_b32 v131, 0xffff0000, v105
    v_lshlrev_b32 v132, 16, v106
    v_and_b32 v133, 0xffff0000, v106
    v_lshlrev_b32 v134, 16, v107
    v_and_b32 v135, 0xffff0000, v107
    s_waitcnt vmcnt(14)
    v_lshlrev_b32 v136, 16, v108
    v_and_b32 v137, 0xffff0000, v108
    v_lshlrev_b32 v138, 16, v109
    v_and_b32 v139, 0xffff0000, v109
    v_lshlrev_b32 v140, 16, v110
    v_and_b32 v141, 0xffff0000, v110
    v_lshlrev_b32 v142, 16, v111
    v_and_b32 v143, 0xffff0000, v111
    v_pk_add_f32 v[144:145], v[112:113], v[116:117]
    v_pk_add_f32 v[146:147], v[114:115], v[118:119]
    v_pk_add_f32 v[144:145], v[144:145], v[120:121]
    v_pk_add_f32 v[146:147], v[146:147], v[122:123]
    v_pk_add_f32 v[144:145], v[144:145], v[124:125]
    v_pk_add_f32 v[146:147], v[146:147], v[126:127]
    v_pk_add_f32 v[144:145], v[144:145], v[128:129]
    v_pk_add_f32 v[146:147], v[146:147], v[130:131]
    v_pk_add_f32 v[144:145], v[144:145], v[132:133]
    v_pk_add_f32 v[146:147], v[146:147], v[134:135]
    v_pk_add_f32 v[144:145], v[144:145], v[136:137]
    v_pk_add_f32 v[146:147], v[146:147], v[138:139]
    v_pk_add_f32 v[144:145], v[144:145], v[140:141]
    v_pk_add_f32 v[146:147], v[146:147], v[142:143]
    v_pk_add_f32 v[144:145], v[144:145], v[146:147]
    v_add_f32 v144, v144, v145
    s_nop 1
    v_add_f32_dpp v144, v144, v144 quad_perm:[1,0,3,2] row_mask:0xf bank_mask:0xf
    s_nop 1
    v_add_f32_dpp v144, v144, v144 quad_perm:[2,3,0,1] row_mask:0xf bank_mask:0xf
    s_nop 1
    v_add_f32_dpp v144, v144, v144 row_half_mirror row_mask:0xf bank_mask:0xf
    s_nop 1
    v_add_f32_dpp v144, v144, v144 row_mirror row_mask:0xf bank_mask:0xf
    v_mov_b32 v145, v144
    s_nop 1
    v_permlane16_swap_b32 v144, v145
    s_nop 1
    v_add_f32 v144, v144, v145
    v_mul_f32 v144, s32, v144
    v_pk_add_f32 v[152:153], v[112:113], v[144:145] op_sel_hi:[1,0] neg_lo:[0,1] neg_hi:[0,1]
    v_pk_mul_f32 v[146:147], v[152:153], v[152:153]
    v_pk_add_f32 v[154:155], v[114:115], v[144:145] op_sel_hi:[1,0] neg_lo:[0,1] neg_hi:[0,1]
    v_pk_mul_f32 v[148:149], v[154:155], v[154:155]
    v_pk_add_f32 v[152:153], v[116:117], v[144:145] op_sel_hi:[1,0] neg_lo:[0,1] neg_hi:[0,1]
    v_pk_fma_f32 v[146:147], v[152:153], v[152:153], v[146:147]
    v_pk_add_f32 v[154:155], v[118:119], v[144:145] op_sel_hi:[1,0] neg_lo:[0,1] neg_hi:[0,1]
    v_pk_fma_f32 v[148:149], v[154:155], v[154:155], v[148:149]
    v_pk_add_f32 v[152:153], v[120:121], v[144:145] op_sel_hi:[1,0] neg_lo:[0,1] neg_hi:[0,1]
    v_pk_fma_f32 v[146:147], v[152:153], v[152:153], v[146:147]
    v_pk_add_f32 v[154:155], v[122:123], v[144:145] op_sel_hi:[1,0] neg_lo:[0,1] neg_hi:[0,1]
    v_pk_fma_f32 v[148:149], v[154:155], v[154:155], v[148:149]
    v_pk_add_f32 v[152:153], v[124:125], v[144:145] op_sel_hi:[1,0] neg_lo:[0,1] neg_hi:[0,1]
    v_pk_fma_f32 v[146:147], v[152:153], v[152:153], v[146:147]
    v_pk_add_f32 v[154:155], v[126:127], v[144:145] op_sel_hi:[1,0] neg_lo:[0,1] neg_hi:[0,1]
    v_pk_fma_f32 v[148:149], v[154:155], v[154:155], v[148:149]
    v_pk_add_f32 v[152:153], v[128:129], v[144:145] op_sel_hi:[1,0] neg_lo:[0,1] neg_hi:[0,1]
    v_pk_fma_f32 v[146:147], v[152:153], v[152:153], v[146:147]
    v_pk_add_f32 v[154:155], v[130:131], v[144:145] op_sel_hi:[1,0] neg_lo:[0,1] neg_hi:[0,1]
    v_pk_fma_f32 v[148:149], v[154:155], v[154:155], v[148:149]
    v_pk_add_f32 v[152:153], v[132:133], v[144:145] op_sel_hi:[1,0] neg_lo:[0,1] neg_hi:[0,1]
    v_pk_fma_f32 v[146:147], v[152:153], v[152:153], v[146:147]
    v_pk_add_f32 v[154:155], v[134:135], v[144:145] op_sel_hi:[1,0] neg_lo:[0,1] neg_hi:[0,1]
    v_pk_fma_f32 v[148:149], v[154:155], v[154:155], v[148:149]
    v_pk_add_f32 v[152:153], v[136:137], v[144:145] op_sel_hi:[1,0] neg_lo:[0,1] neg_hi:[0,1]
    v_pk_fma_f32 v[146:147], v[152:153], v[152:153], v[146:147]
    v_pk_add_f32 v[154:155], v[138:139], v[144:145] op_sel_hi:[1,0] neg_lo:[0,1] neg_hi:[0,1]
    v_pk_fma_f32 v[148:149], v[154:155], v[154:155], v[148:149]
    v_pk_add_f32 v[152:153], v[140:141], v[144:145] op_sel_hi:[1,0] neg_lo:[0,1] neg_hi:[0,1]
    v_pk_fma_f32 v[146:147], v[152:153], v[152:153], v[146:147]
    v_pk_add_f32 v[154:155], v[142:143], v[144:145] op_sel_hi:[1,0] neg_lo:[0,1] neg_hi:[0,1]
    v_pk_fma_f32 v[148:149], v[154:155], v[154:155], v[148:149]
    v_pk_add_f32 v[146:147], v[146:147], v[148:149]
    v_add_f32 v146, v146, v147
    s_nop 1
    v_add_f32_dpp v146, v146, v146 quad_perm:[1,0,3,2] row_mask:0xf bank_mask:0xf
    s_nop 1
    v_add_f32_dpp v146, v146, v146 quad_perm:[2,3,0,1] row_mask:0xf bank_mask:0xf
    s_nop 1
    v_add_f32_dpp v146, v146, v146 row_half_mirror row_mask:0xf bank_mask:0xf
    s_nop 1
    v_add_f32_dpp v146, v146, v146 row_mirror row_mask:0xf bank_mask:0xf
    v_mov_b32 v147, v146
    s_nop 1
    v_permlane16_swap_b32 v146, v147
    s_nop 1
    v_add_f32 v146, v146, v147
    v_mul_f32 v146, s32, v146
    v_cvt_pk_bf16_f32 v144, v144, v146
    v_and_b32 v146, 0xffff0000, v144
    v_lshlrev_b32 v144, 16, v144
    v_add_f32 v146, 0x3727c5ac, v146
    v_cvt_pk_bf16_f32 v146, v146, v146
    v_lshlrev_b32 v146, 16, v146
    v_sqrt_f32 v146, v146
    s_nop 0
    v_cvt_pk_bf16_f32 v146, v146, v146
    v_lshlrev_b32 v146, 16, v146
    v_rcp_f32 v146, v146
    s_mov_b32 s32, 4096
    v_pk_add_f32 v[112:113], v[112:113], v[144:145] op_sel_hi:[1,0] neg_lo:[0,1] neg_hi:[0,1]
    v_pk_add_f32 v[114:115], v[114:115], v[144:145] op_sel_hi:[1,0] neg_lo:[0,1] neg_hi:[0,1]
    v_pk_add_f32 v[116:117], v[116:117], v[144:145] op_sel_hi:[1,0] neg_lo:[0,1] neg_hi:[0,1]
    v_pk_add_f32 v[118:119], v[118:119], v[144:145] op_sel_hi:[1,0] neg_lo:[0,1] neg_hi:[0,1]
    v_pk_add_f32 v[120:121], v[120:121], v[144:145] op_sel_hi:[1,0] neg_lo:[0,1] neg_hi:[0,1]
    v_pk_add_f32 v[122:123], v[122:123], v[144:145] op_sel_hi:[1,0] neg_lo:[0,1] neg_hi:[0,1]
    v_pk_add_f32 v[124:125], v[124:125], v[144:145] op_sel_hi:[1,0] neg_lo:[0,1] neg_hi:[0,1]
    v_pk_add_f32 v[126:127], v[126:127], v[144:145] op_sel_hi:[1,0] neg_lo:[0,1] neg_hi:[0,1]
    v_pk_add_f32 v[128:129], v[128:129], v[144:145] op_sel_hi:[1,0] neg_lo:[0,1] neg_hi:[0,1]
    v_pk_add_f32 v[130:131], v[130:131], v[144:145] op_sel_hi:[1,0] neg_lo:[0,1] neg_hi:[0,1]
    v_pk_add_f32 v[132:133], v[132:133], v[144:145] op_sel_hi:[1,0] neg_lo:[0,1] neg_hi:[0,1]
    v_pk_add_f32 v[134:135], v[134:135], v[144:145] op_sel_hi:[1,0] neg_lo:[0,1] neg_hi:[0,1]
    v_pk_add_f32 v[136:137], v[136:137], v[144:145] op_sel_hi:[1,0] neg_lo:[0,1] neg_hi:[0,1]
    v_pk_add_f32 v[138:139], v[138:139], v[144:145] op_sel_hi:[1,0] neg_lo:[0,1] neg_hi:[0,1]
    v_pk_add_f32 v[140:141], v[140:141], v[144:145] op_sel_hi:[1,0] neg_lo:[0,1] neg_hi:[0,1]
    v_pk_add_f32 v[142:143], v[142:143], v[144:145] op_sel_hi:[1,0] neg_lo:[0,1] neg_hi:[0,1]
    v_pk_mul_f32 v[112:113], v[112:113], v[146:147] op_sel_hi:[1,0]
    v_pk_mul_f32 v[114:115], v[114:115], v[146:147] op_sel_hi:[1,0]
    v_pk_mul_f32 v[116:117], v[116:117], v[146:147] op_sel_hi:[1,0]
    v_pk_mul_f32 v[118:119], v[118:119], v[146:147] op_sel_hi:[1,0]
    v_cvt_pk_bf16_f32 v96, v112, v113
    v_cvt_pk_bf16_f32 v97, v114, v115
    v_cvt_pk_bf16_f32 v98, v116, v117
    v_cvt_pk_bf16_f32 v99, v118, v119
    ds_write_b128 v160, v[96:99] offset:0
    v_pk_mul_f32 v[120:121], v[120:121], v[146:147] op_sel_hi:[1,0]
    v_pk_mul_f32 v[122:123], v[122:123], v[146:147] op_sel_hi:[1,0]
    v_pk_mul_f32 v[124:125], v[124:125], v[146:147] op_sel_hi:[1,0]
    v_pk_mul_f32 v[126:127], v[126:127], v[146:147] op_sel_hi:[1,0]
    v_cvt_pk_bf16_f32 v100, v120, v121
    v_cvt_pk_bf16_f32 v101, v122, v123
    v_cvt_pk_bf16_f32 v102, v124, v125
    v_cvt_pk_bf16_f32 v103, v126, v127
    ds_write_b128 v160, v[100:103] offset:4096
    v_pk_mul_f32 v[128:129], v[128:129], v[146:147] op_sel_hi:[1,0]
    v_pk_mul_f32 v[130:131], v[130:131], v[146:147] op_sel_hi:[1,0]
    v_pk_mul_f32 v[132:133], v[132:133], v[146:147] op_sel_hi:[1,0]
    v_pk_mul_f32 v[134:135], v[134:135], v[146:147] op_sel_hi:[1,0]
    v_cvt_pk_bf16_f32 v104, v128, v129
    v_cvt_pk_bf16_f32 v105, v130, v131
    v_cvt_pk_bf16_f32 v106, v132, v133
    v_cvt_pk_bf16_f32 v107, v134, v135
    ds_write_b128 v160, v[104:107] offset:8192
    v_pk_mul_f32 v[136:137], v[136:137], v[146:147] op_sel_hi:[1,0]
    v_pk_mul_f32 v[138:139], v[138:139], v[146:147] op_sel_hi:[1,0]
    v_pk_mul_f32 v[140:141], v[140:141], v[146:147] op_sel_hi:[1,0]
    v_pk_mul_f32 v[142:143], v[142:143], v[146:147] op_sel_hi:[1,0]
    v_cvt_pk_bf16_f32 v108, v136, v137
    v_cvt_pk_bf16_f32 v109, v138, v139
    v_cvt_pk_bf16_f32 v110, v140, v141
    v_cvt_pk_bf16_f32 v111, v142, v143
    ds_write_b128 v160, v[108:111] offset:12288
    s_waitcnt lgkmcnt(0)
    s_barrier
    ds_read_b128 v[96:99], v161 offset:0
    ds_read_b128 v[100:103], v161 offset:1024
    ds_read_b128 v[104:107], v161 offset:2048
    ds_read_b128 v[108:111], v161 offset:3072
    s_waitcnt lgkmcnt(3)
    buffer_store_dwordx4 v[96:99], v157, s[36:39], 0 offen offset:0 sc1
    s_waitcnt lgkmcnt(2)
    buffer_store_dwordx4 v[100:103], v157, s[36:39], 0 offen offset:2048 sc1
    s_waitcnt lgkmcnt(1)
    buffer_store_dwordx4 v[104:107], v157, s[36:39], s32 offen offset:0 sc1
    s_waitcnt lgkmcnt(0)
    buffer_store_dwordx4 v[108:111], v157, s[36:39], s32 offen offset:2048 sc1
    s_lshl_b32 s3, s22, 4
    s_lshl_b32 s29, s20, 2
    s_add_u32 s33, s3, s29
    s_lshl_b32 s3, s33, 15
    s_mov_b32 s16, s34
    s_mov_b32 s17, s35
    s_add_u32 s16, s16, s3
    s_addc_u32 s17, s17, 0
    s_and_b32 s17, s17, 0xffff
    s_mov_b32 s18, 131072
    s_mov_b32 s19, 0x20000
    v_add_u32 v25, 0, v6
    v_add_u32 v26, 32768, v6
    v_add_u32 v27, 65536, v6
    v_add_u32 v28, 98304, v6
    v_lshl_add_u32 v7, v4, 3, v2
    v_lshlrev_b32 v7, 8, v7
    v_add_u32 v7, 98304, v7
    v_lshl_add_u32 v8, v3, 4, v7
    v_xor_b32 v9, 0, v2
    v_lshl_add_u32 v10, v9, 6, v8
    v_xor_b32 v9, 1, v2
    v_lshl_add_u32 v11, v9, 6, v8
    v_xor_b32 v9, 2, v2
    v_lshl_add_u32 v12, v9, 6, v8
    v_xor_b32 v9, 3, v2
    v_lshl_add_u32 v13, v9, 6, v8
    v_lshl_add_u32 v8, v3, 3, v7
    v_add_u32 v8, 8192, v8
    v_and_b32 v29, 1, v4
    v_lshl_add_u32 v29, v29, 2, v2
    s_and_b32 s97, s21, 1
    s_add_u32 s29, s97, 0
    v_xor_b32 v9, s29, v29
    v_lshl_add_u32 v14, v9, 5, v8
    s_add_u32 s29, s97, 1
    v_xor_b32 v9, s29, v29
    v_lshl_add_u32 v15, v9, 5, v8
    s_add_u32 s29, s97, 2
    v_xor_b32 v9, s29, v29
    v_lshl_add_u32 v16, v9, 5, v8
    s_add_u32 s29, s97, 3
    v_xor_b32 v9, s29, v29
    v_lshl_add_u32 v17, v9, 5, v8
    s_add_u32 s29, s97, 4
    v_xor_b32 v9, s29, v29
    v_lshl_add_u32 v18, v9, 5, v8
    s_add_u32 s29, s97, 5
    v_xor_b32 v9, s29, v29
    v_lshl_add_u32 v19, v9, 5, v8
    s_mul_i32 s29, s97, -6
    s_add_u32 s29, s29, 6
    v_xor_b32 v9, s29, v29
    v_lshl_add_u32 v20, v9, 5, v8
    s_lshl_b32 s3, s21, 19
    s_mov_b32 s8, s4
    s_mov_b32 s9, s5
    s_add_u32 s8, s8, s3
    s_addc_u32 s9, s9, 0
    s_and_b32 s9, s9, 0xffff
    s_mov_b32 s10, 524288
    s_mov_b32 s11, 0x20000
    s_mov_b32 s12, s6
    s_mov_b32 s13, s7
    s_add_u32 s12, s12, s3
    s_addc_u32 s13, s13, 0
    s_and_b32 s13, s13, 0xffff
    s_mov_b32 s14, 524288
    s_mov_b32 s15, 0x20000
    v_lshlrev_b32 v7, 8, v5
    v_add_u32 v9, 0, v4
    v_xor_b32 v9, v9, v5
    v_lshl_add_u32 v216, v9, 4, v7
    v_add_u32 v9, 4, v4
    v_xor_b32 v9, v9, v5
    v_lshl_add_u32 v217, v9, 4, v7
    v_add_u32 v9, 8, v4
    v_xor_b32 v9, v9, v5
    v_lshl_add_u32 v218, v9, 4, v7
    v_add_u32 v9, 12, v4
    v_xor_b32 v9, v9, v5
    v_lshl_add_u32 v219, v9, 4, v7
    v_lshl_add_u32 v7, v4, 2, v2
    v_lshlrev_b32 v7, 8, v7
    v_add_u32 v7, 65536, v7
    v_lshl_add_u32 v7, v3, 3, v7
    v_xor_b32 v9, 0, v29
    v_lshl_add_u32 v220, v9, 5, v7
    v_xor_b32 v9, 1, v29
    v_lshl_add_u32 v221, v9, 5, v7
    v_xor_b32 v9, 2, v29
    v_lshl_add_u32 v222, v9, 5, v7
    v_xor_b32 v9, 3, v29
    v_lshl_add_u32 v223, v9, 5, v7
    v_xor_b32 v9, 4, v29
    v_lshl_add_u32 v224, v9, 5, v7
    v_xor_b32 v9, 5, v29
    v_lshl_add_u32 v225, v9, 5, v7
    v_xor_b32 v9, 6, v29
    v_lshl_add_u32 v226, v9, 5, v7
    v_xor_b32 v9, 7, v29
    v_lshl_add_u32 v227, v9, 5, v7
    v_lshlrev_b32 v7, 8, v4
    v_add_u32 v7, s25, v7
    v_add_u32 v9, 0, v4
    v_xor_b32 v9, v9, v5
    v_lshl_add_u32 v228, v9, 4, v7
    v_add_u32 v9, 4, v4
    v_xor_b32 v9, v9, v5
    v_lshl_add_u32 v229, v9, 4, v7
    v_add_u32 v9, 8, v4
    v_xor_b32 v9, v9, v5
    v_lshl_add_u32 v230, v9, 4, v7
    v_add_u32 v9, 12, v4
    v_xor_b32 v9, v9, v5
    v_lshl_add_u32 v231, v9, 4, v7
    v_add_u32 v9, 0, v4
    v_lshlrev_b32 v9, 1, v9
    v_xor_b32 v9, v9, v5
    v_lshl_add_u32 v232, v9, 4, v7
    v_add_u32 v9, 4, v4
    v_lshlrev_b32 v9, 1, v9
    v_xor_b32 v9, v9, v5
    v_lshl_add_u32 v233, v9, 4, v7
    s_mov_b32 s40, 0
    s_mov_b32 s41, 0
    s_lshl_b32 s3, s22, 15
    v_and_b32 v156, 31, v1
    v_lshlrev_b32 v156, 10, v156
    v_add_u32 v156, s3, v156
    s_waitcnt vmcnt(0)
    v_readfirstlane_b32 s100, v159
    s_nop 3
    s_add_u32 s100, s100, 1
    s_or_b32 s100, s100, 0x80000000
    s_barrier
    s_cmp_eq_u32 s20, 0
    s_cbranch_scc0 k_ln_pub
    v_mov_b32 v7, s101
    v_mov_b32 v8, s100
    s_mov_b64 exec, 1
    global_store_dword v7, v8, s[98:99] offset:0 sc1
    s_mov_b64 exec, -1
k_ln_pub:
    v_accvgpr_write_b32 a0, 0
    v_accvgpr_write_b32 a1, 0
    v_accvgpr_write_b32 a2, 0
    v_accvgpr_write_b32 a3, 0
    v_accvgpr_write_b32 a4, 0
    v_accvgpr_write_b32 a5, 0
    v_accvgpr_write_b32 a6, 0
    v_accvgpr_write_b32 a7, 0
    v_accvgpr_write_b32 a8, 0
    v_accvgpr_write_b32 a9, 0
    v_accvgpr_write_b32 a10, 0
    v_accvgpr_write_b32 a11, 0
    v_accvgpr_write_b32 a12, 0
    v_accvgpr_write_b32 a13, 0
    v_accvgpr_write_b32 a14, 0
    v_accvgpr_write_b32 a15, 0
    v_accvgpr_write_b32 a16, 0
    v_accvgpr_write_b32 a17, 0
    v_accvgpr_write_b32 a18, 0
    v_accvgpr_write_b32 a19, 0
    v_accvgpr_write_b32 a20, 0
    v_accvgpr_write_b32 a21, 0
    v_accvgpr_write_b32 a22, 0
    v_accvgpr_write_b32 a23, 0
    v_accvgpr_write_b32 a24, 0
    v_accvgpr_write_b32 a25, 0
    v_accvgpr_write_b32 a26, 0
    v_accvgpr_write_b32 a27, 0
    v_accvgpr_write_b32 a28, 0
    v_accvgpr_write_b32 a29, 0
    v_accvgpr_write_b32 a30, 0
    v_accvgpr_write_b32 a31, 0
    v_accvgpr_write_b32 a32, 0
    v_accvgpr_write_b32 a33, 0
    v_accvgpr_write_b32 a34, 0
    v_accvgpr_write_b32 a35, 0
    v_accvgpr_write_b32 a36, 0
    v_accvgpr_write_b32 a37, 0
    v_accvgpr_write_b32 a38, 0
    v_accvgpr_write_b32 a39, 0
    v_accvgpr_write_b32 a40, 0
    v_accvgpr_write_b32 a41, 0
    v_accvgpr_write_b32 a42, 0
    v_accvgpr_write_b32 a43, 0
    v_accvgpr_write_b32 a44, 0
    v_accvgpr_write_b32 a45, 0
    v_accvgpr_write_b32 a46, 0
    v_accvgpr_write_b32 a47, 0
    v_accvgpr_write_b32 a48, 0
    v_accvgpr_write_b32 a49, 0
    v_accvgpr_write_b32 a50, 0
    v_accvgpr_write_b32 a51, 0
    v_accvgpr_write_b32 a52, 0
    v_accvgpr_write_b32 a53, 0
    v_accvgpr_write_b32 a54, 0
    v_accvgpr_write_b32 a55, 0
    v_accvgpr_write_b32 a56, 0
    v_accvgpr_write_b32 a57, 0
    v_accvgpr_write_b32 a58, 0
    v_accvgpr_write_b32 a59, 0
    v_accvgpr_write_b32 a60, 0
    v_accvgpr_write_b32 a61, 0
    v_accvgpr_write_b32 a62, 0
    v_accvgpr_write_b32 a63, 0
    v_accvgpr_write_b32 a64, 0
    v_accvgpr_write_b32 a65, 0
    v_accvgpr_write_b32 a66, 0
    v_accvgpr_write_b32 a67, 0
    v_accvgpr_write_b32 a68, 0
    v_accvgpr_write_b32 a69, 0
    v_accvgpr_write_b32 a70, 0
    v_accvgpr_write_b32 a71, 0
    v_accvgpr_write_b32 a72, 0
    v_accvgpr_write_b32 a73, 0
    v_accvgpr_write_b32 a74, 0
    v_accvgpr_write_b32 a75, 0
    v_accvgpr_write_b32 a76, 0
    v_accvgpr_write_b32 a77, 0
    v_accvgpr_write_b32 a78, 0
    v_accvgpr_write_b32 a79, 0
    v_accvgpr_write_b32 a80, 0
    v_accvgpr_write_b32 a81, 0
    v_accvgpr_write_b32 a82, 0
    v_accvgpr_write_b32 a83, 0
    v_accvgpr_write_b32 a84, 0
    v_accvgpr_write_b32 a85, 0
    v_accvgpr_write_b32 a86, 0
    v_accvgpr_write_b32 a87, 0
    v_accvgpr_write_b32 a88, 0
    v_accvgpr_write_b32 a89, 0
    v_accvgpr_write_b32 a90, 0
    v_accvgpr_write_b32 a91, 0
    v_accvgpr_write_b32 a92, 0
    v_accvgpr_write_b32 a93, 0
    v_accvgpr_write_b32 a94, 0
    v_accvgpr_write_b32 a95, 0
    v_accvgpr_write_b32 a96, 0
    v_accvgpr_write_b32 a97, 0
    v_accvgpr_write_b32 a98, 0
    v_accvgpr_write_b32 a99, 0
    v_accvgpr_write_b32 a100, 0
    v_accvgpr_write_b32 a101, 0
    v_accvgpr_write_b32 a102, 0
    v_accvgpr_write_b32 a103, 0
    v_accvgpr_write_b32 a104, 0
    v_accvgpr_write_b32 a105, 0
    v_accvgpr_write_b32 a106, 0
    v_accvgpr_write_b32 a107, 0
    v_accvgpr_write_b32 a108, 0
    v_accvgpr_write_b32 a109, 0
    v_accvgpr_write_b32 a110, 0
    v_accvgpr_write_b32 a111, 0
    v_accvgpr_write_b32 a112, 0
    v_accvgpr_write_b32 a113, 0
    v_accvgpr_write_b32 a114, 0
    v_accvgpr_write_b32 a115, 0
    v_accvgpr_write_b32 a116, 0
    v_accvgpr_write_b32 a117, 0
    v_accvgpr_write_b32 a118, 0
    v_accvgpr_write_b32 a119, 0
    v_accvgpr_write_b32 a120, 0
    v_accvgpr_write_b32 a121, 0
    v_accvgpr_write_b32 a122, 0
    v_accvgpr_write_b32 a123, 0
    v_accvgpr_write_b32 a124, 0
    v_accvgpr_write_b32 a125, 0
    v_accvgpr_write_b32 a126, 0
    v_accvgpr_write_b32 a127, 0
    v_accvgpr_write_b32 a128, 0
    v_accvgpr_write_b32 a129, 0
    v_accvgpr_write_b32 a130, 0
    v_accvgpr_write_b32 a131, 0
    v_accvgpr_write_b32 a132, 0
    v_accvgpr_write_b32 a133, 0
    v_accvgpr_write_b32 a134, 0
    v_accvgpr_write_b32 a135, 0
    v_accvgpr_write_b32 a136, 0
    v_accvgpr_write_b32 a137, 0
    v_accvgpr_write_b32 a138, 0
    v_accvgpr_write_b32 a139, 0
    v_accvgpr_write_b32 a140, 0
    v_accvgpr_write_b32 a141, 0
    v_accvgpr_write_b32 a142, 0
    v_accvgpr_write_b32 a143, 0
    v_accvgpr_write_b32 a144, 0
    v_accvgpr_write_b32 a145, 0
    v_accvgpr_write_b32 a146, 0
    v_accvgpr_write_b32 a147, 0
    v_accvgpr_write_b32 a148, 0
    v_accvgpr_write_b32 a149, 0
    v_accvgpr_write_b32 a150, 0
    v_accvgpr_write_b32 a151, 0
    v_accvgpr_write_b32 a152, 0
    v_accvgpr_write_b32 a153, 0
    v_accvgpr_write_b32 a154, 0
    v_accvgpr_write_b32 a155, 0
    v_accvgpr_write_b32 a156, 0
    v_accvgpr_write_b32 a157, 0
    v_accvgpr_write_b32 a158, 0
    v_accvgpr_write_b32 a159, 0
    v_accvgpr_write_b32 a160, 0
    v_accvgpr_write_b32 a161, 0
    v_accvgpr_write_b32 a162, 0
    v_accvgpr_write_b32 a163, 0
    v_accvgpr_write_b32 a164, 0
    v_accvgpr_write_b32 a165, 0
    v_accvgpr_write_b32 a166, 0
    v_accvgpr_write_b32 a167, 0
    v_accvgpr_write_b32 a168, 0
    v_accvgpr_write_b32 a169, 0
    v_accvgpr_write_b32 a170, 0
    v_accvgpr_write_b32 a171, 0
    v_accvgpr_write_b32 a172, 0
    v_accvgpr_write_b32 a173, 0
    v_accvgpr_write_b32 a174, 0
    v_accvgpr_write_b32 a175, 0
    v_accvgpr_write_b32 a176, 0
    v_accvgpr_write_b32 a177, 0
    v_accvgpr_write_b32 a178, 0
    v_accvgpr_write_b32 a179, 0
    v_accvgpr_write_b32 a180, 0
    v_accvgpr_write_b32 a181, 0
    v_accvgpr_write_b32 a182, 0
    v_accvgpr_write_b32 a183, 0
    v_accvgpr_write_b32 a184, 0
    v_accvgpr_write_b32 a185, 0
    v_accvgpr_write_b32 a186, 0
    v_accvgpr_write_b32 a187, 0
    v_accvgpr_write_b32 a188, 0
    v_accvgpr_write_b32 a189, 0
    v_accvgpr_write_b32 a190, 0
    v_accvgpr_write_b32 a191, 0
    v_accvgpr_write_b32 a192, 0
    v_accvgpr_write_b32 a193, 0
    v_accvgpr_write_b32 a194, 0
    v_accvgpr_write_b32 a195, 0
    v_accvgpr_write_b32 a196, 0
    v_accvgpr_write_b32 a197, 0
    v_accvgpr_write_b32 a198, 0
    v_accvgpr_write_b32 a199, 0
    v_accvgpr_write_b32 a200, 0
    v_accvgpr_write_b32 a201, 0
    v_accvgpr_write_b32 a202, 0
    v_accvgpr_write_b32 a203, 0
    v_accvgpr_write_b32 a204, 0
    v_accvgpr_write_b32 a205, 0
    v_accvgpr_write_b32 a206, 0
    v_accvgpr_write_b32 a207, 0
    v_accvgpr_write_b32 a208, 0
    v_accvgpr_write_b32 a209, 0
    v_accvgpr_write_b32 a210, 0
    v_accvgpr_write_b32 a211, 0
    v_accvgpr_write_b32 a212, 0
    v_accvgpr_write_b32 a213, 0
    v_accvgpr_write_b32 a214, 0
    v_accvgpr_write_b32 a215, 0
    v_accvgpr_write_b32 a216, 0
    v_accvgpr_write_b32 a217, 0
    v_accvgpr_write_b32 a218, 0
    v_accvgpr_write_b32 a219, 0
    v_accvgpr_write_b32 a220, 0
    v_accvgpr_write_b32 a221, 0
    v_accvgpr_write_b32 a222, 0
    v_accvgpr_write_b32 a223, 0
    v_accvgpr_write_b32 a224, 0
    v_accvgpr_write_b32 a225, 0
    v_accvgpr_write_b32 a226, 0
    v_accvgpr_write_b32 a227, 0
    v_accvgpr_write_b32 a228, 0
    v_accvgpr_write_b32 a229, 0
    v_accvgpr_write_b32 a230, 0
    v_accvgpr_write_b32 a231, 0
    v_accvgpr_write_b32 a232, 0
    v_accvgpr_write_b32 a233, 0
    v_accvgpr_write_b32 a234, 0
    v_accvgpr_write_b32 a235, 0
    v_accvgpr_write_b32 a236, 0
    v_accvgpr_write_b32 a237, 0
    v_accvgpr_write_b32 a238, 0
    v_accvgpr_write_b32 a239, 0
    s_cmp_eq_u32 s20, 0
    s_cbranch_scc0 k_ln_seen
    s_mov_b32 s3, 0
    global_load_dword v155, v156, s[98:99] offset:0 sc1
k_ln_wait:
    s_waitcnt vmcnt(0)
    v_cmp_ne_u32 vcc, s100, v155
    s_add_u32 s3, s3, 1
    s_cbranch_vccz k_ln_wait_ok
    s_cmp_gt_u32 s3, 0x40000
    s_cbranch_scc1 k_ln_wait_ok
    global_load_dword v155, v156, s[98:99] offset:0 sc1
    s_branch k_ln_wait
k_ln_wait_ok:
    s_cmp_eq_u32 s21, 0
    s_cbranch_scc0 k_ln_seen
    v_mov_b32 v8, s100
    s_mov_b64 exec, 1
    global_store_dword v158, v8, s[98:99] sc1
    s_mov_b64 exec, -1
k_ln_seen:
    s_barrier
    buffer_load_dwordx4 v[32:35], v25, s[16:19], s26 offen offset:0 sc1
    buffer_load_dwordx4 v[36:39], v26, s[16:19], s26 offen offset:0 sc1
    buffer_load_dwordx4 v[40:43], v27, s[16:19], s26 offen offset:0 sc1
    buffer_load_dwordx4 v[44:47], v28, s[16:19], s26 offen offset:0 sc1
    buffer_load_dwordx4 v[48:51], v25, s[16:19], s26 offen offset:1024 sc1
    buffer_load_dwordx4 v[52:55], v26, s[16:19], s26 offen offset:1024 sc1
    buffer_load_dwordx4 v[56:59], v27, s[16:19], s26 offen offset:1024 sc1
    buffer_load_dwordx4 v[60:63], v28, s[16:19], s26 offen offset:1024 sc1
    buffer_load_dwordx4 v[64:67], v25, s[16:19], s26 offen offset:2048 sc1
    buffer_load_dwordx4 v[68:71], v26, s[16:19], s26 offen offset:2048 sc1
    buffer_load_dwordx4 v[72:75], v27, s[16:19], s26 offen offset:2048 sc1
    buffer_load_dwordx4 v[76:79], v28, s[16:19], s26 offen offset:2048 sc1
    s_add_u32 m0, s23, 147456
    s_nop 0
    buffer_load_dwordx4 v21, s[52:55], s27 offen offset:0 lds
    buffer_load_dwordx4 v22, s[52:55], s27 offen offset:1024 lds
    s_add_u32 m0, s23, 155648
    s_nop 0
    buffer_load_dwordx4 v23, s[56:59], s24 offen offset:0 lds
    buffer_load_dwordx4 v24, s[56:59], s24 offen offset:1024 lds
    s_add_u32 s27, s27, 262144
    s_add_u32 s24, s24, 229376
    buffer_load_dword v31, v30, s[60:63], s96 offen
    s_mov_b32 s96, 0x40000000
    buffer_load_dword v31, v30, s[60:63], s96 offen
    buffer_load_dword v31, v30, s[60:63], s96 offen
    buffer_load_dword v31, v30, s[60:63], s96 offen
    buffer_load_dword v31, v30, s[60:63], s96 offen
    buffer_load_dword v31, v30, s[60:63], s96 offen
    buffer_load_dword v31, v30, s[60:63], s96 offen
    ds_read_b64_tr_b16 v[96:97], v10 offset:0
    ds_read_b64_tr_b16 v[98:99], v10 offset:1024
    ds_read_b64_tr_b16 v[100:101], v10 offset:8
    ds_read_b64_tr_b16 v[102:103], v10 offset:1032
    ds_read_b64_tr_b16 v[104:105], v11 offset:0
    ds_read_b64_tr_b16 v[106:107], v11 offset:1024
    ds_read_b64_tr_b16 v[108:109], v11 offset:8
    ds_read_b64_tr_b16 v[110:111], v11 offset:1032
    ds_read_b64_tr_b16 v[112:113], v12 offset:0
    ds_read_b64_tr_b16 v[114:115], v12 offset:1024
    ds_read_b64_tr_b16 v[116:117], v12 offset:8
    ds_read_b64_tr_b16 v[118:119], v12 offset:1032
    ds_read_b64_tr_b16 v[120:121], v13 offset:0
    ds_read_b64_tr_b16 v[122:123], v13 offset:1024
    ds_read_b64_tr_b16 v[124:125], v13 offset:8
    ds_read_b64_tr_b16 v[126:127], v13 offset:1032
    ds_read_b64_tr_b16 v[128:129], v14 offset:0
    ds_read_b64_tr_b16 v[130:131], v14 offset:1024
    ds_read_b64_tr_b16 v[132:133], v15 offset:0
    ds_read_b64_tr_b16 v[134:135], v15 offset:1024
    ds_read_b64_tr_b16 v[136:137], v16 offset:0
    ds_read_b64_tr_b16 v[138:139], v16 offset:1024
    ds_read_b64_tr_b16 v[140:141], v17 offset:0
    ds_read_b64_tr_b16 v[142:143], v17 offset:1024
    ds_read_b64_tr_b16 v[144:145], v18 offset:0
    ds_read_b64_tr_b16 v[146:147], v18 offset:1024
    ds_read_b64_tr_b16 v[148:149], v19 offset:0
    ds_read_b64_tr_b16 v[150:151], v19 offset:1024
    ds_read_b64_tr_b16 v[152:153], v20 offset:0
    ds_read_b64_tr_b16 v[154:155], v20 offset:1024
    s_mov_b32 s28, 0
k_p1_loop:
    s_waitcnt vmcnt(19) lgkmcnt(0)
    s_barrier
    v_mfma_f32_16x16x32_bf16 a[0:3], v[96:99], v[32:35], a[0:3]
    ds_read_b64_tr_b16 v[156:157], v10 offset:16384
    v_mfma_f32_16x16x32_bf16 a[4:7], v[96:99], v[36:39], a[4:7]
    ds_read_b64_tr_b16 v[158:159], v10 offset:17408
    v_mfma_f32_16x16x32_bf16 a[8:11], v[96:99], v[40:43], a[8:11]
    ds_read_b64_tr_b16 v[160:161], v10 offset:16392
    v_mfma_f32_16x16x32_bf16 a[12:15], v[96:99], v[44:47], a[12:15]
    ds_read_b64_tr_b16 v[162:163], v10 offset:17416
    v_mfma_f32_16x16x32_bf16 a[16:19], v[100:103], v[32:35], a[16:19]
    ds_read_b64_tr_b16 v[164:165], v11 offset:16384
    v_mfma_f32_16x16x32_bf16 a[20:23], v[100:103], v[36:39], a[20:23]
    ds_read_b64_tr_b16 v[166:167], v11 offset:17408
    v_mfma_f32_16x16x32_bf16 a[24:27], v[100:103], v[40:43], a[24:27]
    ds_read_b64_tr_b16 v[168:169], v11 offset:16392
    v_mfma_f32_16x16x32_bf16 a[28:31], v[100:103], v[44:47], a[28:31]
    ds_read_b64_tr_b16 v[170:171], v11 offset:17416
    v_mfma_f32_16x16x32_bf16 a[32:35], v[104:107], v[32:35], a[32:35]
    ds_read_b64_tr_b16 v[172:173], v12 offset:16384
    v_mfma_f32_16x16x32_bf16 a[36:39], v[104:107], v[36:39], a[36:39]
    ds_read_b64_tr_b16 v[174:175], v12 offset:17408
    v_mfma_f32_16x16x32_bf16 a[40:43], v[104:107], v[40:43], a[40:43]
    ds_read_b64_tr_b16 v[176:177], v12 offset:16392
    v_mfma_f32_16x16x32_bf16 a[44:47], v[104:107], v[44:47], a[44:47]
    ds_read_b64_tr_b16 v[178:179], v12 offset:17416
    v_mfma_f32_16x16x32_bf16 a[48:51], v[108:111], v[32:35], a[48:51]
    ds_read_b64_tr_b16 v[180:181], v13 offset:16384
    v_mfma_f32_16x16x32_bf16 a[52:55], v[108:111], v[36:39], a[52:55]
    ds_read_b64_tr_b16 v[182:183], v13 offset:17408
    v_mfma_f32_16x16x32_bf16 a[56:59], v[108:111], v[40:43], a[56:59]
    ds_read_b64_tr_b16 v[184:185], v13 offset:16392
    v_mfma_f32_16x16x32_bf16 a[60:63], v[108:111], v[44:47], a[60:63]
    ds_read_b64_tr_b16 v[186:187], v13 offset:17416
    v_mfma_f32_16x16x32_bf16 a[64:67], v[112:115], v[32:35], a[64:67]
    ds_read_b64_tr_b16 v[188:189], v14 offset:16384
    v_mfma_f32_16x16x32_bf16 a[68:71], v[112:115], v[36:39], a[68:71]
    ds_read_b64_tr_b16 v[190:191], v14 offset:17408
    v_mfma_f32_16x16x32_bf16 a[72:75], v[112:115], v[40:43], a[72:75]
    ds_read_b64_tr_b16 v[192:193], v15 offset:16384
    v_mfma_f32_16x16x32_bf16 a[76:79], v[112:115], v[44:47], a[76:79]
    ds_read_b64_tr_b16 v[194:195], v15 offset:17408
    v_mfma_f32_16x16x32_bf16 a[80:83], v[116:119], v[32:35], a[80:83]
    ds_read_b64_tr_b16 v[196:197], v16 offset:16384
    v_mfma_f32_16x16x32_bf16 a[84:87], v[116:119], v[36:39], a[84:87]
    ds_read_b64_tr_b16 v[198:199], v16 offset:17408
    v_mfma_f32_16x16x32_bf16 a[88:91], v[116:119], v[40:43], a[88:91]
    ds_read_b64_tr_b16 v[200:201], v17 offset:16384
    v_mfma_f32_16x16x32_bf16 a[92:95], v[116:119], v[44:47], a[92:95]
    ds_read_b64_tr_b16 v[202:203], v17 offset:17408
    v_mfma_f32_16x16x32_bf16 a[96:99], v[120:123], v[32:35], a[96:99]
    ds_read_b64_tr_b16 v[204:205], v18 offset:16384
    v_mfma_f32_16x16x32_bf16 a[100:103], v[120:123], v[36:39], a[100:103]
    ds_read_b64_tr_b16 v[206:207], v18 offset:17408
    v_mfma_f32_16x16x32_bf16 a[104:107], v[120:123], v[40:43], a[104:107]
    ds_read_b64_tr_b16 v[208:209], v19 offset:16384
    v_mfma_f32_16x16x32_bf16 a[108:111], v[120:123], v[44:47], a[108:111]
    ds_read_b64_tr_b16 v[210:211], v19 offset:17408
    v_mfma_f32_16x16x32_bf16 a[112:115], v[124:127], v[32:35], a[112:115]
    ds_read_b64_tr_b16 v[212:213], v20 offset:16384
    v_mfma_f32_16x16x32_bf16 a[116:119], v[124:127], v[36:39], a[116:119]
    ds_read_b64_tr_b16 v[214:215], v20 offset:17408
    v_mfma_f32_16x16x32_bf16 a[120:123], v[124:127], v[40:43], a[120:123]
    s_add_u32 m0, s23, 98304
    v_mfma_f32_16x16x32_bf16 a[124:127], v[124:127], v[44:47], a[124:127]
    buffer_load_dwordx4 v21, s[52:55], s27 offen offset:0 lds
    v_mfma_f32_16x16x32_bf16 a[128:131], v[128:131], v[32:35], a[128:131]
    v_mfma_f32_16x16x32_bf16 a[132:135], v[128:131], v[36:39], a[132:135]
    v_mfma_f32_16x16x32_bf16 a[136:139], v[128:131], v[40:43], a[136:139]
    buffer_load_dwordx4 v22, s[52:55], s27 offen offset:1024 lds
    v_mfma_f32_16x16x32_bf16 a[140:143], v[128:131], v[44:47], a[140:143]
    v_mfma_f32_16x16x32_bf16 a[144:147], v[132:135], v[32:35], a[144:147]
    s_add_u32 m0, s23, 106496
    v_mfma_f32_16x16x32_bf16 a[148:151], v[132:135], v[36:39], a[148:151]
    buffer_load_dwordx4 v23, s[56:59], s24 offen offset:0 lds
    v_mfma_f32_16x16x32_bf16 a[152:155], v[132:135], v[40:43], a[152:155]
    v_mfma_f32_16x16x32_bf16 a[156:159], v[132:135], v[44:47], a[156:159]
    v_mfma_f32_16x16x32_bf16 a[160:163], v[136:139], v[32:35], a[160:163]
    buffer_load_dwordx4 v24, s[56:59], s24 offen offset:1024 lds
    v_mfma_f32_16x16x32_bf16 a[164:167], v[136:139], v[36:39], a[164:167]
    s_add_u32 s27, s27, 262144
    s_add_u32 s24, s24, 229376
    v_mfma_f32_16x16x32_bf16 a[168:171], v[136:139], v[40:43], a[168:171]
    v_mfma_f32_16x16x32_bf16 a[172:175], v[136:139], v[44:47], a[172:175]
    buffer_load_dwordx4 v[80:83], v25, s[16:19], s26 offen offset:3072 sc1
    v_mfma_f32_16x16x32_bf16 a[176:179], v[140:143], v[32:35], a[176:179]
    v_mfma_f32_16x16x32_bf16 a[180:183], v[140:143], v[36:39], a[180:183]
    v_mfma_f32_16x16x32_bf16 a[184:187], v[140:143], v[40:43], a[184:187]
    buffer_load_dwordx4 v[84:87], v26, s[16:19], s26 offen offset:3072 sc1
    v_mfma_f32_16x16x32_bf16 a[188:191], v[140:143], v[44:47], a[188:191]
    v_mfma_f32_16x16x32_bf16 a[192:195], v[144:147], v[32:35], a[192:195]
    v_mfma_f32_16x16x32_bf16 a[196:199], v[144:147], v[36:39], a[196:199]
    buffer_load_dwordx4 v[88:91], v27, s[16:19], s26 offen offset:3072 sc1
    v_mfma_f32_16x16x32_bf16 a[200:203], v[144:147], v[40:43], a[200:203]
    v_mfma_f32_16x16x32_bf16 a[204:207], v[144:147], v[44:47], a[204:207]
    v_mfma_f32_16x16x32_bf16 a[208:211], v[148:151], v[32:35], a[208:211]
    buffer_load_dwordx4 v[92:95], v28, s[16:19], s26 offen offset:3072 sc1
    v_mfma_f32_16x16x32_bf16 a[212:215], v[148:151], v[36:39], a[212:215]
    s_add_u32 s26, s26, 4096
    v_mfma_f32_16x16x32_bf16 a[216:219], v[148:151], v[40:43], a[216:219]
    s_and_b32 s96, s95, 7
    s_cselect_b32 s96, 0x40000000, s94
    v_mfma_f32_16x16x32_bf16 a[220:223], v[148:151], v[44:47], a[220:223]
    buffer_load_dword v31, v30, s[60:63], s96 offen
    v_mfma_f32_16x16x32_bf16 a[224:227], v[152:155], v[32:35], a[224:227]
    s_add_u32 s94, s94, s93
    s_add_u32 s95, s95, 1
    v_mfma_f32_16x16x32_bf16 a[228:231], v[152:155], v[36:39], a[228:231]
    v_mfma_f32_16x16x32_bf16 a[232:235], v[152:155], v[40:43], a[232:235]
    v_mfma_f32_16x16x32_bf16 a[236:239], v[152:155], v[44:47], a[236:239]
    s_waitcnt vmcnt(19) lgkmcnt(0)
    s_barrier
    v_mfma_f32_16x16x32_bf16 a[0:3], v[156:159], v[48:51], a[0:3]
    ds_read_b64_tr_b16 v[96:97], v10 offset:32768
    v_mfma_f32_16x16x32_bf16 a[4:7], v[156:159], v[52:55], a[4:7]
    ds_read_b64_tr_b16 v[98:99], v10 offset:33792
    v_mfma_f32_16x16x32_bf16 a[8:11], v[156:159], v[56:59], a[8:11]
    ds_read_b64_tr_b16 v[100:101], v10 offset:32776
    v_mfma_f32_16x16x32_bf16 a[12:15], v[156:159], v[60:63], a[12:15]
    ds_read_b64_tr_b16 v[102:103], v10 offset:33800
    v_mfma_f32_16x16x32_bf16 a[16:19], v[160:163], v[48:51], a[16:19]
    ds_read_b64_tr_b16 v[104:105], v11 offset:32768
    v_mfma_f32_16x16x32_bf16 a[20:23], v[160:163], v[52:55], a[20:23]
    ds_read_b64_tr_b16 v[106:107], v11 offset:33792
    v_mfma_f32_16x16x32_bf16 a[24:27], v[160:163], v[56:59], a[24:27]
    ds_read_b64_tr_b16 v[108:109], v11 offset:32776
    v_mfma_f32_16x16x32_bf16 a[28:31], v[160:163], v[60:63], a[28:31]
    ds_read_b64_tr_b16 v[110:111], v11 offset:33800
    v_mfma_f32_16x16x32_bf16 a[32:35], v[164:167], v[48:51], a[32:35]
    ds_read_b64_tr_b16 v[112:113], v12 offset:32768
    v_mfma_f32_16x16x32_bf16 a[36:39], v[164:167], v[52:55], a[36:39]
    ds_read_b64_tr_b16 v[114:115], v12 offset:33792
    v_mfma_f32_16x16x32_bf16 a[40:43], v[164:167], v[56:59], a[40:43]
    ds_read_b64_tr_b16 v[116:117], v12 offset:32776
    v_mfma_f32_16x16x32_bf16 a[44:47], v[164:167], v[60:63], a[44:47]
    ds_read_b64_tr_b16 v[118:119], v12 offset:33800
    v_mfma_f32_16x16x32_bf16 a[48:51], v[168:171], v[48:51], a[48:51]
    ds_read_b64_tr_b16 v[120:121], v13 offset:32768
    v_mfma_f32_16x16x32_bf16 a[52:55], v[168:171], v[52:55], a[52:55]
    ds_read_b64_tr_b16 v[122:123], v13 offset:33792
    v_mfma_f32_16x16x32_bf16 a[56:59], v[168:171], v[56:59], a[56:59]
    ds_read_b64_tr_b16 v[124:125], v13 offset:32776
    v_mfma_f32_16x16x32_bf16 a[60:63], v[168:171], v[60:63], a[60:63]
    ds_read_b64_tr_b16 v[126:127], v13 offset:33800
    v_mfma_f32_16x16x32_bf16 a[64:67], v[172:175], v[48:51], a[64:67]
    ds_read_b64_tr_b16 v[128:129], v14 offset:32768
    v_mfma_f32_16x16x32_bf16 a[68:71], v[172:175], v[52:55], a[68:71]
    ds_read_b64_tr_b16 v[130:131], v14 offset:33792
    v_mfma_f32_16x16x32_bf16 a[72:75], v[172:175], v[56:59], a[72:75]
    ds_read_b64_tr_b16 v[132:133], v15 offset:32768
    v_mfma_f32_16x16x32_bf16 a[76:79], v[172:175], v[60:63], a[76:79]
    ds_read_b64_tr_b16 v[134:135], v15 offset:33792
    v_mfma_f32_16x16x32_bf16 a[80:83], v[176:179], v[48:51], a[80:83]
    ds_read_b64_tr_b16 v[136:137], v16 offset:32768
    v_mfma_f32_16x16x32_bf16 a[84:87], v[176:179], v[52:55], a[84:87]
    ds_read_b64_tr_b16 v[138:139], v16 offset:33792
    v_mfma_f32_16x16x32_bf16 a[88:91], v[176:179], v[56:59], a[88:91]
    ds_read_b64_tr_b16 v[140:141], v17 offset:32768
    v_mfma_f32_16x16x32_bf16 a[92:95], v[176:179], v[60:63], a[92:95]
    ds_read_b64_tr_b16 v[142:143], v17 offset:33792
    v_mfma_f32_16x16x32_bf16 a[96:99], v[180:183], v[48:51], a[96:99]
    ds_read_b64_tr_b16 v[144:145], v18 offset:32768
    v_mfma_f32_16x16x32_bf16 a[100:103], v[180:183], v[52:55], a[100:103]
    ds_read_b64_tr_b16 v[146:147], v18 offset:33792
    v_mfma_f32_16x16x32_bf16 a[104:107], v[180:183], v[56:59], a[104:107]
    ds_read_b64_tr_b16 v[148:149], v19 offset:32768
    v_mfma_f32_16x16x32_bf16 a[108:111], v[180:183], v[60:63], a[108:111]
    ds_read_b64_tr_b16 v[150:151], v19 offset:33792
    v_mfma_f32_16x16x32_bf16 a[112:115], v[184:187], v[48:51], a[112:115]
    ds_read_b64_tr_b16 v[152:153], v20 offset:32768
    v_mfma_f32_16x16x32_bf16 a[116:119], v[184:187], v[52:55], a[116:119]
    ds_read_b64_tr_b16 v[154:155], v20 offset:33792
    v_mfma_f32_16x16x32_bf16 a[120:123], v[184:187], v[56:59], a[120:123]
    s_add_u32 m0, s23, 114688
    v_mfma_f32_16x16x32_bf16 a[124:127], v[184:187], v[60:63], a[124:127]
    buffer_load_dwordx4 v21, s[52:55], s27 offen offset:0 lds
    v_mfma_f32_16x16x32_bf16 a[128:131], v[188:191], v[48:51], a[128:131]
    v_mfma_f32_16x16x32_bf16 a[132:135], v[188:191], v[52:55], a[132:135]
    v_mfma_f32_16x16x32_bf16 a[136:139], v[188:191], v[56:59], a[136:139]
    buffer_load_dwordx4 v22, s[52:55], s27 offen offset:1024 lds
    v_mfma_f32_16x16x32_bf16 a[140:143], v[188:191], v[60:63], a[140:143]
    v_mfma_f32_16x16x32_bf16 a[144:147], v[192:195], v[48:51], a[144:147]
    s_add_u32 m0, s23, 122880
    v_mfma_f32_16x16x32_bf16 a[148:151], v[192:195], v[52:55], a[148:151]
    buffer_load_dwordx4 v23, s[56:59], s24 offen offset:0 lds
    v_mfma_f32_16x16x32_bf16 a[152:155], v[192:195], v[56:59], a[152:155]
    v_mfma_f32_16x16x32_bf16 a[156:159], v[192:195], v[60:63], a[156:159]
    v_mfma_f32_16x16x32_bf16 a[160:163], v[196:199], v[48:51], a[160:163]
    buffer_load_dwordx4 v24, s[56:59], s24 offen offset:1024 lds
    v_mfma_f32_16x16x32_bf16 a[164:167], v[196:199], v[52:55], a[164:167]
    s_add_u32 s27, s27, 262144
    s_add_u32 s24, s24, 229376
    v_mfma_f32_16x16x32_bf16 a[168:171], v[196:199], v[56:59], a[168:171]
    v_mfma_f32_16x16x32_bf16 a[172:175], v[196:199], v[60:63], a[172:175]
    buffer_load_dwordx4 v[32:35], v25, s[16:19], s26 offen offset:0 sc1
    v_mfma_f32_16x16x32_bf16 a[176:179], v[200:203], v[48:51], a[176:179]
    v_mfma_f32_16x16x32_bf16 a[180:183], v[200:203], v[52:55], a[180:183]
    v_mfma_f32_16x16x32_bf16 a[184:187], v[200:203], v[56:59], a[184:187]
    buffer_load_dwordx4 v[36:39], v26, s[16:19], s26 offen offset:0 sc1
    v_mfma_f32_16x16x32_bf16 a[188:191], v[200:203], v[60:63], a[188:191]
    v_mfma_f32_16x16x32_bf16 a[192:195], v[204:207], v[48:51], a[192:195]
    v_mfma_f32_16x16x32_bf16 a[196:199], v[204:207], v[52:55], a[196:199]
    buffer_load_dwordx4 v[40:43], v27, s[16:19], s26 offen offset:0 sc1
    v_mfma_f32_16x16x32_bf16 a[200:203], v[204:207], v[56:59], a[200:203]
    v_mfma_f32_16x16x32_bf16 a[204:207], v[204:207], v[60:63], a[204:207]
    v_mfma_f32_16x16x32_bf16 a[208:211], v[208:211], v[48:51], a[208:211]
    buffer_load_dwordx4 v[44:47], v28, s[16:19], s26 offen offset:0 sc1
    v_mfma_f32_16x16x32_bf16 a[212:215], v[208:211], v[52:55], a[212:215]
    v_mfma_f32_16x16x32_bf16 a[216:219], v[208:211], v[56:59], a[216:219]
    s_and_b32 s96, s95, 7
    s_cselect_b32 s96, 0x40000000, s94
    v_mfma_f32_16x16x32_bf16 a[220:223], v[208:211], v[60:63], a[220:223]
    buffer_load_dword v31, v30, s[60:63], s96 offen
    v_mfma_f32_16x16x32_bf16 a[224:227], v[212:215], v[48:51], a[224:227]
    s_add_u32 s94, s94, s93
    s_add_u32 s95, s95, 1
    v_mfma_f32_16x16x32_bf16 a[228:231], v[212:215], v[52:55], a[228:231]
    s_cmp_lt_u32 s28, 4
    s_cselect_b32 s49, s48, 0x40000000
    v_mfma_f32_16x16x32_bf16 a[232:235], v[212:215], v[56:59], a[232:235]
    buffer_load_dwordx4 v[240:243], v6, s[44:47], s49 offen
    v_mfma_f32_16x16x32_bf16 a[236:239], v[212:215], v[60:63], a[236:239]
    s_add_u32 s48, s48, 16384
    s_waitcnt vmcnt(19) lgkmcnt(0)
    s_barrier
    v_mfma_f32_16x16x32_bf16 a[0:3], v[96:99], v[64:67], a[0:3]
    ds_read_b64_tr_b16 v[156:157], v10 offset:49152
    v_mfma_f32_16x16x32_bf16 a[4:7], v[96:99], v[68:71], a[4:7]
    ds_read_b64_tr_b16 v[158:159], v10 offset:50176
    v_mfma_f32_16x16x32_bf16 a[8:11], v[96:99], v[72:75], a[8:11]
    ds_read_b64_tr_b16 v[160:161], v10 offset:49160
    v_mfma_f32_16x16x32_bf16 a[12:15], v[96:99], v[76:79], a[12:15]
    ds_read_b64_tr_b16 v[162:163], v10 offset:50184
    v_mfma_f32_16x16x32_bf16 a[16:19], v[100:103], v[64:67], a[16:19]
    ds_read_b64_tr_b16 v[164:165], v11 offset:49152
    v_mfma_f32_16x16x32_bf16 a[20:23], v[100:103], v[68:71], a[20:23]
    ds_read_b64_tr_b16 v[166:167], v11 offset:50176
    v_mfma_f32_16x16x32_bf16 a[24:27], v[100:103], v[72:75], a[24:27]
    ds_read_b64_tr_b16 v[168:169], v11 offset:49160
    v_mfma_f32_16x16x32_bf16 a[28:31], v[100:103], v[76:79], a[28:31]
    ds_read_b64_tr_b16 v[170:171], v11 offset:50184
    v_mfma_f32_16x16x32_bf16 a[32:35], v[104:107], v[64:67], a[32:35]
    ds_read_b64_tr_b16 v[172:173], v12 offset:49152
    v_mfma_f32_16x16x32_bf16 a[36:39], v[104:107], v[68:71], a[36:39]
    ds_read_b64_tr_b16 v[174:175], v12 offset:50176
    v_mfma_f32_16x16x32_bf16 a[40:43], v[104:107], v[72:75], a[40:43]
    ds_read_b64_tr_b16 v[176:177], v12 offset:49160
    v_mfma_f32_16x16x32_bf16 a[44:47], v[104:107], v[76:79], a[44:47]
    ds_read_b64_tr_b16 v[178:179], v12 offset:50184
    v_mfma_f32_16x16x32_bf16 a[48:51], v[108:111], v[64:67], a[48:51]
    ds_read_b64_tr_b16 v[180:181], v13 offset:49152
    v_mfma_f32_16x16x32_bf16 a[52:55], v[108:111], v[68:71], a[52:55]
    ds_read_b64_tr_b16 v[182:183], v13 offset:50176
    v_mfma_f32_16x16x32_bf16 a[56:59], v[108:111], v[72:75], a[56:59]
    ds_read_b64_tr_b16 v[184:185], v13 offset:49160
    v_mfma_f32_16x16x32_bf16 a[60:63], v[108:111], v[76:79], a[60:63]
    ds_read_b64_tr_b16 v[186:187], v13 offset:50184
    v_mfma_f32_16x16x32_bf16 a[64:67], v[112:115], v[64:67], a[64:67]
    ds_read_b64_tr_b16 v[188:189], v14 offset:49152
    v_mfma_f32_16x16x32_bf16 a[68:71], v[112:115], v[68:71], a[68:71]
    ds_read_b64_tr_b16 v[190:191], v14 offset:50176
    v_mfma_f32_16x16x32_bf16 a[72:75], v[112:115], v[72:75], a[72:75]
    ds_read_b64_tr_b16 v[192:193], v15 offset:49152
    v_mfma_f32_16x16x32_bf16 a[76:79], v[112:115], v[76:79], a[76:79]
    ds_read_b64_tr_b16 v[194:195], v15 offset:50176
    v_mfma_f32_16x16x32_bf16 a[80:83], v[116:119], v[64:67], a[80:83]
    ds_read_b64_tr_b16 v[196:197], v16 offset:49152
    v_mfma_f32_16x16x32_bf16 a[84:87], v[116:119], v[68:71], a[84:87]
    ds_read_b64_tr_b16 v[198:199], v16 offset:50176
    v_mfma_f32_16x16x32_bf16 a[88:91], v[116:119], v[72:75], a[88:91]
    ds_read_b64_tr_b16 v[200:201], v17 offset:49152
    v_mfma_f32_16x16x32_bf16 a[92:95], v[116:119], v[76:79], a[92:95]
    ds_read_b64_tr_b16 v[202:203], v17 offset:50176
    v_mfma_f32_16x16x32_bf16 a[96:99], v[120:123], v[64:67], a[96:99]
    ds_read_b64_tr_b16 v[204:205], v18 offset:49152
    v_mfma_f32_16x16x32_bf16 a[100:103], v[120:123], v[68:71], a[100:103]
    ds_read_b64_tr_b16 v[206:207], v18 offset:50176
    v_mfma_f32_16x16x32_bf16 a[104:107], v[120:123], v[72:75], a[104:107]
    ds_read_b64_tr_b16 v[208:209], v19 offset:49152
    v_mfma_f32_16x16x32_bf16 a[108:111], v[120:123], v[76:79], a[108:111]
    ds_read_b64_tr_b16 v[210:211], v19 offset:50176
    v_mfma_f32_16x16x32_bf16 a[112:115], v[124:127], v[64:67], a[112:115]
    ds_read_b64_tr_b16 v[212:213], v20 offset:49152
    v_mfma_f32_16x16x32_bf16 a[116:119], v[124:127], v[68:71], a[116:119]
    ds_read_b64_tr_b16 v[214:215], v20 offset:50176
    v_mfma_f32_16x16x32_bf16 a[120:123], v[124:127], v[72:75], a[120:123]
    s_add_u32 m0, s23, 131072
    v_mfma_f32_16x16x32_bf16 a[124:127], v[124:127], v[76:79], a[124:127]
    buffer_load_dwordx4 v21, s[52:55], s27 offen offset:0 lds
    v_mfma_f32_16x16x32_bf16 a[128:131], v[128:131], v[64:67], a[128:131]
    v_mfma_f32_16x16x32_bf16 a[132:135], v[128:131], v[68:71], a[132:135]
    v_mfma_f32_16x16x32_bf16 a[136:139], v[128:131], v[72:75], a[136:139]
    buffer_load_dwordx4 v22, s[52:55], s27 offen offset:1024 lds
    v_mfma_f32_16x16x32_bf16 a[140:143], v[128:131], v[76:79], a[140:143]
    v_mfma_f32_16x16x32_bf16 a[144:147], v[132:135], v[64:67], a[144:147]
    s_add_u32 m0, s23, 139264
    v_mfma_f32_16x16x32_bf16 a[148:151], v[132:135], v[68:71], a[148:151]
    buffer_load_dwordx4 v23, s[56:59], s24 offen offset:0 lds
    v_mfma_f32_16x16x32_bf16 a[152:155], v[132:135], v[72:75], a[152:155]
    v_mfma_f32_16x16x32_bf16 a[156:159], v[132:135], v[76:79], a[156:159]
    v_mfma_f32_16x16x32_bf16 a[160:163], v[136:139], v[64:67], a[160:163]
    buffer_load_dwordx4 v24, s[56:59], s24 offen offset:1024 lds
    v_mfma_f32_16x16x32_bf16 a[164:167], v[136:139], v[68:71], a[164:167]
    s_add_u32 s27, s27, 262144
    s_add_u32 s24, s24, 229376
    v_mfma_f32_16x16x32_bf16 a[168:171], v[136:139], v[72:75], a[168:171]
    v_mfma_f32_16x16x32_bf16 a[172:175], v[136:139], v[76:79], a[172:175]
    buffer_load_dwordx4 v[48:51], v25, s[16:19], s26 offen offset:1024 sc1
    v_mfma_f32_16x16x32_bf16 a[176:179], v[140:143], v[64:67], a[176:179]
    v_mfma_f32_16x16x32_bf16 a[180:183], v[140:143], v[68:71], a[180:183]
    v_mfma_f32_16x16x32_bf16 a[184:187], v[140:143], v[72:75], a[184:187]
    buffer_load_dwordx4 v[52:55], v26, s[16:19], s26 offen offset:1024 sc1
    v_mfma_f32_16x16x32_bf16 a[188:191], v[140:143], v[76:79], a[188:191]
    v_mfma_f32_16x16x32_bf16 a[192:195], v[144:147], v[64:67], a[192:195]
    v_mfma_f32_16x16x32_bf16 a[196:199], v[144:147], v[68:71], a[196:199]
    buffer_load_dwordx4 v[56:59], v27, s[16:19], s26 offen offset:1024 sc1
    v_mfma_f32_16x16x32_bf16 a[200:203], v[144:147], v[72:75], a[200:203]
    v_mfma_f32_16x16x32_bf16 a[204:207], v[144:147], v[76:79], a[204:207]
    v_mfma_f32_16x16x32_bf16 a[208:211], v[148:151], v[64:67], a[208:211]
    buffer_load_dwordx4 v[60:63], v28, s[16:19], s26 offen offset:1024 sc1
    v_mfma_f32_16x16x32_bf16 a[212:215], v[148:151], v[68:71], a[212:215]
    v_mfma_f32_16x16x32_bf16 a[216:219], v[148:151], v[72:75], a[216:219]
    s_and_b32 s96, s95, 7
    s_cselect_b32 s96, 0x40000000, s94
    v_mfma_f32_16x16x32_bf16 a[220:223], v[148:151], v[76:79], a[220:223]
    buffer_load_dword v31, v30, s[60:63], s96 offen
    v_mfma_f32_16x16x32_bf16 a[224:227], v[152:155], v[64:67], a[224:227]
    s_add_u32 s94, s94, s93
    s_add_u32 s95, s95, 1
    v_mfma_f32_16x16x32_bf16 a[228:231], v[152:155], v[68:71], a[228:231]
    v_mfma_f32_16x16x32_bf16 a[232:235], v[152:155], v[72:75], a[232:235]
    v_mfma_f32_16x16x32_bf16 a[236:239], v[152:155], v[76:79], a[236:239]
    s_waitcnt vmcnt(19) lgkmcnt(0)
    s_barrier
    v_mfma_f32_16x16x32_bf16 a[0:3], v[156:159], v[80:83], a[0:3]
    ds_read_b64_tr_b16 v[96:97], v10 offset:0
    v_mfma_f32_16x16x32_bf16 a[4:7], v[156:159], v[84:87], a[4:7]
    ds_read_b64_tr_b16 v[98:99], v10 offset:1024
    v_mfma_f32_16x16x32_bf16 a[8:11], v[156:159], v[88:91], a[8:11]
    ds_read_b64_tr_b16 v[100:101], v10 offset:8
    v_mfma_f32_16x16x32_bf16 a[12:15], v[156:159], v[92:95], a[12:15]
    ds_read_b64_tr_b16 v[102:103], v10 offset:1032
    v_mfma_f32_16x16x32_bf16 a[16:19], v[160:163], v[80:83], a[16:19]
    ds_read_b64_tr_b16 v[104:105], v11 offset:0
    v_mfma_f32_16x16x32_bf16 a[20:23], v[160:163], v[84:87], a[20:23]
    ds_read_b64_tr_b16 v[106:107], v11 offset:1024
    v_mfma_f32_16x16x32_bf16 a[24:27], v[160:163], v[88:91], a[24:27]
    ds_read_b64_tr_b16 v[108:109], v11 offset:8
    v_mfma_f32_16x16x32_bf16 a[28:31], v[160:163], v[92:95], a[28:31]
    ds_read_b64_tr_b16 v[110:111], v11 offset:1032
    v_mfma_f32_16x16x32_bf16 a[32:35], v[164:167], v[80:83], a[32:35]
    ds_read_b64_tr_b16 v[112:113], v12 offset:0
    v_mfma_f32_16x16x32_bf16 a[36:39], v[164:167], v[84:87], a[36:39]
    ds_read_b64_tr_b16 v[114:115], v12 offset:1024
    v_mfma_f32_16x16x32_bf16 a[40:43], v[164:167], v[88:91], a[40:43]
    ds_read_b64_tr_b16 v[116:117], v12 offset:8
    v_mfma_f32_16x16x32_bf16 a[44:47], v[164:167], v[92:95], a[44:47]
    ds_read_b64_tr_b16 v[118:119], v12 offset:1032
    v_mfma_f32_16x16x32_bf16 a[48:51], v[168:171], v[80:83], a[48:51]
    ds_read_b64_tr_b16 v[120:121], v13 offset:0
    v_mfma_f32_16x16x32_bf16 a[52:55], v[168:171], v[84:87], a[52:55]
    ds_read_b64_tr_b16 v[122:123], v13 offset:1024
    v_mfma_f32_16x16x32_bf16 a[56:59], v[168:171], v[88:91], a[56:59]
    ds_read_b64_tr_b16 v[124:125], v13 offset:8
    v_mfma_f32_16x16x32_bf16 a[60:63], v[168:171], v[92:95], a[60:63]
    ds_read_b64_tr_b16 v[126:127], v13 offset:1032
    v_mfma_f32_16x16x32_bf16 a[64:67], v[172:175], v[80:83], a[64:67]
    ds_read_b64_tr_b16 v[128:129], v14 offset:0
    v_mfma_f32_16x16x32_bf16 a[68:71], v[172:175], v[84:87], a[68:71]
    ds_read_b64_tr_b16 v[130:131], v14 offset:1024
    v_mfma_f32_16x16x32_bf16 a[72:75], v[172:175], v[88:91], a[72:75]
    ds_read_b64_tr_b16 v[132:133], v15 offset:0
    v_mfma_f32_16x16x32_bf16 a[76:79], v[172:175], v[92:95], a[76:79]
    ds_read_b64_tr_b16 v[134:135], v15 offset:1024
    v_mfma_f32_16x16x32_bf16 a[80:83], v[176:179], v[80:83], a[80:83]
    ds_read_b64_tr_b16 v[136:137], v16 offset:0
    v_mfma_f32_16x16x32_bf16 a[84:87], v[176:179], v[84:87], a[84:87]
    ds_read_b64_tr_b16 v[138:139], v16 offset:1024
    v_mfma_f32_16x16x32_bf16 a[88:91], v[176:179], v[88:91], a[88:91]
    ds_read_b64_tr_b16 v[140:141], v17 offset:0
    v_mfma_f32_16x16x32_bf16 a[92:95], v[176:179], v[92:95], a[92:95]
    ds_read_b64_tr_b16 v[142:143], v17 offset:1024
    v_mfma_f32_16x16x32_bf16 a[96:99], v[180:183], v[80:83], a[96:99]
    ds_read_b64_tr_b16 v[144:145], v18 offset:0
    v_mfma_f32_16x16x32_bf16 a[100:103], v[180:183], v[84:87], a[100:103]
    ds_read_b64_tr_b16 v[146:147], v18 offset:1024
    v_mfma_f32_16x16x32_bf16 a[104:107], v[180:183], v[88:91], a[104:107]
    ds_read_b64_tr_b16 v[148:149], v19 offset:0
    v_mfma_f32_16x16x32_bf16 a[108:111], v[180:183], v[92:95], a[108:111]
    ds_read_b64_tr_b16 v[150:151], v19 offset:1024
    v_mfma_f32_16x16x32_bf16 a[112:115], v[184:187], v[80:83], a[112:115]
    ds_read_b64_tr_b16 v[152:153], v20 offset:0
    v_mfma_f32_16x16x32_bf16 a[116:119], v[184:187], v[84:87], a[116:119]
    ds_read_b64_tr_b16 v[154:155], v20 offset:1024
    v_mfma_f32_16x16x32_bf16 a[120:123], v[184:187], v[88:91], a[120:123]
    s_add_u32 m0, s23, 147456
    v_mfma_f32_16x16x32_bf16 a[124:127], v[184:187], v[92:95], a[124:127]
    buffer_load_dwordx4 v21, s[52:55], s27 offen offset:0 lds
    v_mfma_f32_16x16x32_bf16 a[128:131], v[188:191], v[80:83], a[128:131]
    v_mfma_f32_16x16x32_bf16 a[132:135], v[188:191], v[84:87], a[132:135]
    v_mfma_f32_16x16x32_bf16 a[136:139], v[188:191], v[88:91], a[136:139]
    buffer_load_dwordx4 v22, s[52:55], s27 offen offset:1024 lds
    v_mfma_f32_16x16x32_bf16 a[140:143], v[188:191], v[92:95], a[140:143]
    v_mfma_f32_16x16x32_bf16 a[144:147], v[192:195], v[80:83], a[144:147]
    s_add_u32 m0, s23, 155648
    v_mfma_f32_16x16x32_bf16 a[148:151], v[192:195], v[84:87], a[148:151]
    buffer_load_dwordx4 v23, s[56:59], s24 offen offset:0 lds
    v_mfma_f32_16x16x32_bf16 a[152:155], v[192:195], v[88:91], a[152:155]
    v_mfma_f32_16x16x32_bf16 a[156:159], v[192:195], v[92:95], a[156:159]
    v_mfma_f32_16x16x32_bf16 a[160:163], v[196:199], v[80:83], a[160:163]
    buffer_load_dwordx4 v24, s[56:59], s24 offen offset:1024 lds
    v_mfma_f32_16x16x32_bf16 a[164:167], v[196:199], v[84:87], a[164:167]
    s_add_u32 s27, s27, 262144
    s_add_u32 s24, s24, 229376
    v_mfma_f32_16x16x32_bf16 a[168:171], v[196:199], v[88:91], a[168:171]
    v_mfma_f32_16x16x32_bf16 a[172:175], v[196:199], v[92:95], a[172:175]
    buffer_load_dwordx4 v[64:67], v25, s[16:19], s26 offen offset:2048 sc1
    v_mfma_f32_16x16x32_bf16 a[176:179], v[200:203], v[80:83], a[176:179]
    v_mfma_f32_16x16x32_bf16 a[180:183], v[200:203], v[84:87], a[180:183]
    v_mfma_f32_16x16x32_bf16 a[184:187], v[200:203], v[88:91], a[184:187]
    buffer_load_dwordx4 v[68:71], v26, s[16:19], s26 offen offset:2048 sc1
    v_mfma_f32_16x16x32_bf16 a[188:191], v[200:203], v[92:95], a[188:191]
    v_mfma_f32_16x16x32_bf16 a[192:195], v[204:207], v[80:83], a[192:195]
    v_mfma_f32_16x16x32_bf16 a[196:199], v[204:207], v[84:87], a[196:199]
    buffer_load_dwordx4 v[72:75], v27, s[16:19], s26 offen offset:2048 sc1
    v_mfma_f32_16x16x32_bf16 a[200:203], v[204:207], v[88:91], a[200:203]
    v_mfma_f32_16x16x32_bf16 a[204:207], v[204:207], v[92:95], a[204:207]
    v_mfma_f32_16x16x32_bf16 a[208:211], v[208:211], v[80:83], a[208:211]
    buffer_load_dwordx4 v[76:79], v28, s[16:19], s26 offen offset:2048 sc1
    v_mfma_f32_16x16x32_bf16 a[212:215], v[208:211], v[84:87], a[212:215]
    v_mfma_f32_16x16x32_bf16 a[216:219], v[208:211], v[88:91], a[216:219]
    s_and_b32 s96, s95, 7
    s_cselect_b32 s96, 0x40000000, s94
    v_mfma_f32_16x16x32_bf16 a[220:223], v[208:211], v[92:95], a[220:223]
    buffer_load_dword v31, v30, s[60:63], s96 offen
    v_mfma_f32_16x16x32_bf16 a[224:227], v[212:215], v[80:83], a[224:227]
    s_add_u32 s94, s94, s93
    s_add_u32 s95, s95, 1
    v_mfma_f32_16x16x32_bf16 a[228:231], v[212:215], v[84:87], a[228:231]
    v_mfma_f32_16x16x32_bf16 a[232:235], v[212:215], v[88:91], a[232:235]
    v_mfma_f32_16x16x32_bf16 a[236:239], v[212:215], v[92:95], a[236:239]
    s_add_u32 s28, s28, 1
    s_cmp_lt_u32 s28, 7
    s_cbranch_scc1 k_p1_loop
    s_waitcnt vmcnt(19) lgkmcnt(0)
    s_barrier
    v_mfma_f32_16x16x32_bf16 a[0:3], v[96:99], v[32:35], a[0:3]
    ds_read_b64_tr_b16 v[156:157], v10 offset:16384
    v_mfma_f32_16x16x32_bf16 a[4:7], v[96:99], v[36:39], a[4:7]
    ds_read_b64_tr_b16 v[158:159], v10 offset:17408
    v_mfma_f32_16x16x32_bf16 a[8:11], v[96:99], v[40:43], a[8:11]
    ds_read_b64_tr_b16 v[160:161], v10 offset:16392
    v_mfma_f32_16x16x32_bf16 a[12:15], v[96:99], v[44:47], a[12:15]
    ds_read_b64_tr_b16 v[162:163], v10 offset:17416
    v_mfma_f32_16x16x32_bf16 a[16:19], v[100:103], v[32:35], a[16:19]
    ds_read_b64_tr_b16 v[164:165], v11 offset:16384
    v_mfma_f32_16x16x32_bf16 a[20:23], v[100:103], v[36:39], a[20:23]
    ds_read_b64_tr_b16 v[166:167], v11 offset:17408
    v_mfma_f32_16x16x32_bf16 a[24:27], v[100:103], v[40:43], a[24:27]
    ds_read_b64_tr_b16 v[168:169], v11 offset:16392
    v_mfma_f32_16x16x32_bf16 a[28:31], v[100:103], v[44:47], a[28:31]
    ds_read_b64_tr_b16 v[170:171], v11 offset:17416
    v_mfma_f32_16x16x32_bf16 a[32:35], v[104:107], v[32:35], a[32:35]
    ds_read_b64_tr_b16 v[172:173], v12 offset:16384
    v_mfma_f32_16x16x32_bf16 a[36:39], v[104:107], v[36:39], a[36:39]
    ds_read_b64_tr_b16 v[174:175], v12 offset:17408
    v_mfma_f32_16x16x32_bf16 a[40:43], v[104:107], v[40:43], a[40:43]
    ds_read_b64_tr_b16 v[176:177], v12 offset:16392
    v_mfma_f32_16x16x32_bf16 a[44:47], v[104:107], v[44:47], a[44:47]
    ds_read_b64_tr_b16 v[178:179], v12 offset:17416
    v_mfma_f32_16x16x32_bf16 a[48:51], v[108:111], v[32:35], a[48:51]
    ds_read_b64_tr_b16 v[180:181], v13 offset:16384
    v_mfma_f32_16x16x32_bf16 a[52:55], v[108:111], v[36:39], a[52:55]
    ds_read_b64_tr_b16 v[182:183], v13 offset:17408
    v_mfma_f32_16x16x32_bf16 a[56:59], v[108:111], v[40:43], a[56:59]
    ds_read_b64_tr_b16 v[184:185], v13 offset:16392
    v_mfma_f32_16x16x32_bf16 a[60:63], v[108:111], v[44:47], a[60:63]
    ds_read_b64_tr_b16 v[186:187], v13 offset:17416
    v_mfma_f32_16x16x32_bf16 a[64:67], v[112:115], v[32:35], a[64:67]
    ds_read_b64_tr_b16 v[188:189], v14 offset:16384
    v_mfma_f32_16x16x32_bf16 a[68:71], v[112:115], v[36:39], a[68:71]
    ds_read_b64_tr_b16 v[190:191], v14 offset:17408
    v_mfma_f32_16x16x32_bf16 a[72:75], v[112:115], v[40:43], a[72:75]
    ds_read_b64_tr_b16 v[192:193], v15 offset:16384
    v_mfma_f32_16x16x32_bf16 a[76:79], v[112:115], v[44:47], a[76:79]
    ds_read_b64_tr_b16 v[194:195], v15 offset:17408
    v_mfma_f32_16x16x32_bf16 a[80:83], v[116:119], v[32:35], a[80:83]
    ds_read_b64_tr_b16 v[196:197], v16 offset:16384
    v_mfma_f32_16x16x32_bf16 a[84:87], v[116:119], v[36:39], a[84:87]
    ds_read_b64_tr_b16 v[198:199], v16 offset:17408
    v_mfma_f32_16x16x32_bf16 a[88:91], v[116:119], v[40:43], a[88:91]
    ds_read_b64_tr_b16 v[200:201], v17 offset:16384
    v_mfma_f32_16x16x32_bf16 a[92:95], v[116:119], v[44:47], a[92:95]
    ds_read_b64_tr_b16 v[202:203], v17 offset:17408
    v_mfma_f32_16x16x32_bf16 a[96:99], v[120:123], v[32:35], a[96:99]
    ds_read_b64_tr_b16 v[204:205], v18 offset:16384
    v_mfma_f32_16x16x32_bf16 a[100:103], v[120:123], v[36:39], a[100:103]
    ds_read_b64_tr_b16 v[206:207], v18 offset:17408
    v_mfma_f32_16x16x32_bf16 a[104:107], v[120:123], v[40:43], a[104:107]
    ds_read_b64_tr_b16 v[208:209], v19 offset:16384
    v_mfma_f32_16x16x32_bf16 a[108:111], v[120:123], v[44:47], a[108:111]
    ds_read_b64_tr_b16 v[210:211], v19 offset:17408
    v_mfma_f32_16x16x32_bf16 a[112:115], v[124:127], v[32:35], a[112:115]
    ds_read_b64_tr_b16 v[212:213], v20 offset:16384
    v_mfma_f32_16x16x32_bf16 a[116:119], v[124:127], v[36:39], a[116:119]
    ds_read_b64_tr_b16 v[214:215], v20 offset:17408
    v_mfma_f32_16x16x32_bf16 a[120:123], v[124:127], v[40:43], a[120:123]
    v_mfma_f32_16x16x32_bf16 a[124:127], v[124:127], v[44:47], a[124:127]
    buffer_load_dwordx4 v[80:83], v25, s[16:19], s26 offen offset:3072 sc1
    v_mfma_f32_16x16x32_bf16 a[128:131], v[128:131], v[32:35], a[128:131]
    v_mfma_f32_16x16x32_bf16 a[132:135], v[128:131], v[36:39], a[132:135]
    v_mfma_f32_16x16x32_bf16 a[136:139], v[128:131], v[40:43], a[136:139]
    buffer_load_dwordx4 v[84:87], v26, s[16:19], s26 offen offset:3072 sc1
    v_mfma_f32_16x16x32_bf16 a[140:143], v[128:131], v[44:47], a[140:143]
    v_mfma_f32_16x16x32_bf16 a[144:147], v[132:135], v[32:35], a[144:147]
    v_mfma_f32_16x16x32_bf16 a[148:151], v[132:135], v[36:39], a[148:151]
    buffer_load_dwordx4 v[88:91], v27, s[16:19], s26 offen offset:3072 sc1
    v_mfma_f32_16x16x32_bf16 a[152:155], v[132:135], v[40:43], a[152:155]
    v_mfma_f32_16x16x32_bf16 a[156:159], v[132:135], v[44:47], a[156:159]
    v_mfma_f32_16x16x32_bf16 a[160:163], v[136:139], v[32:35], a[160:163]
    buffer_load_dwordx4 v[92:95], v28, s[16:19], s26 offen offset:3072 sc1
    v_mfma_f32_16x16x32_bf16 a[164:167], v[136:139], v[36:39], a[164:167]
    v_mfma_f32_16x16x32_bf16 a[168:171], v[136:139], v[40:43], a[168:171]
    s_add_u32 m0, s25, 0
    v_mfma_f32_16x16x32_bf16 a[172:175], v[136:139], v[44:47], a[172:175]
    buffer_load_dwordx4 v228, s[8:11], s40 offen offset:0 lds
    v_mfma_f32_16x16x32_bf16 a[176:179], v[140:143], v[32:35], a[176:179]
    v_mfma_f32_16x16x32_bf16 a[180:183], v[140:143], v[36:39], a[180:183]
    v_mfma_f32_16x16x32_bf16 a[184:187], v[140:143], v[40:43], a[184:187]
    buffer_load_dwordx4 v229, s[8:11], s40 offen offset:1024 lds
    v_mfma_f32_16x16x32_bf16 a[188:191], v[140:143], v[44:47], a[188:191]
    v_mfma_f32_16x16x32_bf16 a[192:195], v[144:147], v[32:35], a[192:195]
    v_mfma_f32_16x16x32_bf16 a[196:199], v[144:147], v[36:39], a[196:199]
    buffer_load_dwordx4 v230, s[8:11], s40 offen offset:2048 lds
    v_mfma_f32_16x16x32_bf16 a[200:203], v[144:147], v[40:43], a[200:203]
    v_mfma_f32_16x16x32_bf16 a[204:207], v[144:147], v[44:47], a[204:207]
    v_mfma_f32_16x16x32_bf16 a[208:211], v[148:151], v[32:35], a[208:211]
    buffer_load_dwordx4 v231, s[8:11], s40 offen offset:3072 lds
    v_mfma_f32_16x16x32_bf16 a[212:215], v[148:151], v[36:39], a[212:215]
    s_add_u32 s40, s40, 16384
    v_mfma_f32_16x16x32_bf16 a[216:219], v[148:151], v[40:43], a[216:219]
    s_add_u32 m0, s25, 16384
    v_mfma_f32_16x16x32_bf16 a[220:223], v[148:151], v[44:47], a[220:223]
    buffer_load_dwordx4 v228, s[8:11], s40 offen offset:0 lds
    v_mfma_f32_16x16x32_bf16 a[224:227], v[152:155], v[32:35], a[224:227]
    v_mfma_f32_16x16x32_bf16 a[228:231], v[152:155], v[36:39], a[228:231]
    v_mfma_f32_16x16x32_bf16 a[232:235], v[152:155], v[40:43], a[232:235]
    v_mfma_f32_16x16x32_bf16 a[236:239], v[152:155], v[44:47], a[236:239]
    s_waitcnt vmcnt(19) lgkmcnt(0)
    s_barrier
    v_mfma_f32_16x16x32_bf16 a[0:3], v[156:159], v[48:51], a[0:3]
    ds_read_b64_tr_b16 v[96:97], v10 offset:32768
    v_mfma_f32_16x16x32_bf16 a[4:7], v[156:159], v[52:55], a[4:7]
    ds_read_b64_tr_b16 v[98:99], v10 offset:33792
    v_mfma_f32_16x16x32_bf16 a[8:11], v[156:159], v[56:59], a[8:11]
    ds_read_b64_tr_b16 v[100:101], v10 offset:32776
    v_mfma_f32_16x16x32_bf16 a[12:15], v[156:159], v[60:63], a[12:15]
    ds_read_b64_tr_b16 v[102:103], v10 offset:33800
    v_mfma_f32_16x16x32_bf16 a[16:19], v[160:163], v[48:51], a[16:19]
    ds_read_b64_tr_b16 v[104:105], v11 offset:32768
    v_mfma_f32_16x16x32_bf16 a[20:23], v[160:163], v[52:55], a[20:23]
    ds_read_b64_tr_b16 v[106:107], v11 offset:33792
    v_mfma_f32_16x16x32_bf16 a[24:27], v[160:163], v[56:59], a[24:27]
    ds_read_b64_tr_b16 v[108:109], v11 offset:32776
    v_mfma_f32_16x16x32_bf16 a[28:31], v[160:163], v[60:63], a[28:31]
    ds_read_b64_tr_b16 v[110:111], v11 offset:33800
    v_mfma_f32_16x16x32_bf16 a[32:35], v[164:167], v[48:51], a[32:35]
    ds_read_b64_tr_b16 v[112:113], v12 offset:32768
    v_mfma_f32_16x16x32_bf16 a[36:39], v[164:167], v[52:55], a[36:39]
    ds_read_b64_tr_b16 v[114:115], v12 offset:33792
    v_mfma_f32_16x16x32_bf16 a[40:43], v[164:167], v[56:59], a[40:43]
    ds_read_b64_tr_b16 v[116:117], v12 offset:32776
    v_mfma_f32_16x16x32_bf16 a[44:47], v[164:167], v[60:63], a[44:47]
    ds_read_b64_tr_b16 v[118:119], v12 offset:33800
    v_mfma_f32_16x16x32_bf16 a[48:51], v[168:171], v[48:51], a[48:51]
    ds_read_b64_tr_b16 v[120:121], v13 offset:32768
    v_mfma_f32_16x16x32_bf16 a[52:55], v[168:171], v[52:55], a[52:55]
    ds_read_b64_tr_b16 v[122:123], v13 offset:33792
    v_mfma_f32_16x16x32_bf16 a[56:59], v[168:171], v[56:59], a[56:59]
    ds_read_b64_tr_b16 v[124:125], v13 offset:32776
    v_mfma_f32_16x16x32_bf16 a[60:63], v[168:171], v[60:63], a[60:63]
    ds_read_b64_tr_b16 v[126:127], v13 offset:33800
    v_mfma_f32_16x16x32_bf16 a[64:67], v[172:175], v[48:51], a[64:67]
    ds_read_b64_tr_b16 v[128:129], v14 offset:32768
    v_mfma_f32_16x16x32_bf16 a[68:71], v[172:175], v[52:55], a[68:71]
    ds_read_b64_tr_b16 v[130:131], v14 offset:33792
    v_mfma_f32_16x16x32_bf16 a[72:75], v[172:175], v[56:59], a[72:75]
    ds_read_b64_tr_b16 v[132:133], v15 offset:32768
    v_mfma_f32_16x16x32_bf16 a[76:79], v[172:175], v[60:63], a[76:79]
    ds_read_b64_tr_b16 v[134:135], v15 offset:33792
    v_mfma_f32_16x16x32_bf16 a[80:83], v[176:179], v[48:51], a[80:83]
    ds_read_b64_tr_b16 v[136:137], v16 offset:32768
    v_mfma_f32_16x16x32_bf16 a[84:87], v[176:179], v[52:55], a[84:87]
    ds_read_b64_tr_b16 v[138:139], v16 offset:33792
    v_mfma_f32_16x16x32_bf16 a[88:91], v[176:179], v[56:59], a[88:91]
    ds_read_b64_tr_b16 v[140:141], v17 offset:32768
    v_mfma_f32_16x16x32_bf16 a[92:95], v[176:179], v[60:63], a[92:95]
    ds_read_b64_tr_b16 v[142:143], v17 offset:33792
    v_mfma_f32_16x16x32_bf16 a[96:99], v[180:183], v[48:51], a[96:99]
    ds_read_b64_tr_b16 v[144:145], v18 offset:32768
    v_mfma_f32_16x16x32_bf16 a[100:103], v[180:183], v[52:55], a[100:103]
    ds_read_b64_tr_b16 v[146:147], v18 offset:33792
    v_mfma_f32_16x16x32_bf16 a[104:107], v[180:183], v[56:59], a[104:107]
    ds_read_b64_tr_b16 v[148:149], v19 offset:32768
    v_mfma_f32_16x16x32_bf16 a[108:111], v[180:183], v[60:63], a[108:111]
    ds_read_b64_tr_b16 v[150:151], v19 offset:33792
    v_mfma_f32_16x16x32_bf16 a[112:115], v[184:187], v[48:51], a[112:115]
    ds_read_b64_tr_b16 v[152:153], v20 offset:32768
    v_mfma_f32_16x16x32_bf16 a[116:119], v[184:187], v[52:55], a[116:119]
    ds_read_b64_tr_b16 v[154:155], v20 offset:33792
    v_mfma_f32_16x16x32_bf16 a[120:123], v[184:187], v[56:59], a[120:123]
    v_mfma_f32_16x16x32_bf16 a[124:127], v[184:187], v[60:63], a[124:127]
    buffer_load_dwordx4 v229, s[8:11], s40 offen offset:1024 lds
    v_mfma_f32_16x16x32_bf16 a[128:131], v[188:191], v[48:51], a[128:131]
    v_mfma_f32_16x16x32_bf16 a[132:135], v[188:191], v[52:55], a[132:135]
    v_mfma_f32_16x16x32_bf16 a[136:139], v[188:191], v[56:59], a[136:139]
    buffer_load_dwordx4 v230, s[8:11], s40 offen offset:2048 lds
    v_mfma_f32_16x16x32_bf16 a[140:143], v[188:191], v[60:63], a[140:143]
    v_mfma_f32_16x16x32_bf16 a[144:147], v[192:195], v[48:51], a[144:147]
    v_mfma_f32_16x16x32_bf16 a[148:151], v[192:195], v[52:55], a[148:151]
    buffer_load_dwordx4 v231, s[8:11], s40 offen offset:3072 lds
    v_mfma_f32_16x16x32_bf16 a[152:155], v[192:195], v[56:59], a[152:155]
    s_add_u32 s40, s40, 16384
    v_mfma_f32_16x16x32_bf16 a[156:159], v[192:195], v[60:63], a[156:159]
    s_add_u32 m0, s25, 65536
    v_mfma_f32_16x16x32_bf16 a[160:163], v[196:199], v[48:51], a[160:163]
    buffer_load_dwordx4 v232, s[12:15], s41 offen offset:0 lds
    v_mfma_f32_16x16x32_bf16 a[164:167], v[196:199], v[52:55], a[164:167]
    v_mfma_f32_16x16x32_bf16 a[168:171], v[196:199], v[56:59], a[168:171]
    v_mfma_f32_16x16x32_bf16 a[172:175], v[196:199], v[60:63], a[172:175]
    buffer_load_dwordx4 v233, s[12:15], s41 offen offset:1024 lds
    v_mfma_f32_16x16x32_bf16 a[176:179], v[200:203], v[48:51], a[176:179]
    v_mfma_f32_16x16x32_bf16 a[180:183], v[200:203], v[52:55], a[180:183]
    v_mfma_f32_16x16x32_bf16 a[184:187], v[200:203], v[56:59], a[184:187]
    buffer_load_dwordx4 v232, s[12:15], s41 offen offset:2048 lds
    v_mfma_f32_16x16x32_bf16 a[188:191], v[200:203], v[60:63], a[188:191]
    v_mfma_f32_16x16x32_bf16 a[192:195], v[204:207], v[48:51], a[192:195]
    v_mfma_f32_16x16x32_bf16 a[196:199], v[204:207], v[52:55], a[196:199]
    buffer_load_dwordx4 v233, s[12:15], s41 offen offset:3072 lds
    v_mfma_f32_16x16x32_bf16 a[200:203], v[204:207], v[56:59], a[200:203]
    s_add_u32 s41, s41, 16384
    v_mfma_f32_16x16x32_bf16 a[204:207], v[204:207], v[60:63], a[204:207]
    s_add_u32 m0, s25, 32768
    v_mfma_f32_16x16x32_bf16 a[208:211], v[208:211], v[48:51], a[208:211]
    buffer_load_dwordx4 v228, s[8:11], s40 offen offset:0 lds
    v_mfma_f32_16x16x32_bf16 a[212:215], v[208:211], v[52:55], a[212:215]
    v_mfma_f32_16x16x32_bf16 a[216:219], v[208:211], v[56:59], a[216:219]
    v_mfma_f32_16x16x32_bf16 a[220:223], v[208:211], v[60:63], a[220:223]
    buffer_load_dwordx4 v229, s[8:11], s40 offen offset:1024 lds
    v_mfma_f32_16x16x32_bf16 a[224:227], v[212:215], v[48:51], a[224:227]
    v_mfma_f32_16x16x32_bf16 a[228:231], v[212:215], v[52:55], a[228:231]
    v_mfma_f32_16x16x32_bf16 a[232:235], v[212:215], v[56:59], a[232:235]
    v_mfma_f32_16x16x32_bf16 a[236:239], v[212:215], v[60:63], a[236:239]
    s_waitcnt vmcnt(19) lgkmcnt(0)
    s_barrier
    v_mfma_f32_16x16x32_bf16 a[0:3], v[96:99], v[64:67], a[0:3]
    ds_read_b64_tr_b16 v[156:157], v10 offset:49152
    v_mfma_f32_16x16x32_bf16 a[4:7], v[96:99], v[68:71], a[4:7]
    ds_read_b64_tr_b16 v[158:159], v10 offset:50176
    v_mfma_f32_16x16x32_bf16 a[8:11], v[96:99], v[72:75], a[8:11]
    ds_read_b64_tr_b16 v[160:161], v10 offset:49160
    v_mfma_f32_16x16x32_bf16 a[12:15], v[96:99], v[76:79], a[12:15]
    ds_read_b64_tr_b16 v[162:163], v10 offset:50184
    v_mfma_f32_16x16x32_bf16 a[16:19], v[100:103], v[64:67], a[16:19]
    ds_read_b64_tr_b16 v[164:165], v11 offset:49152
    v_mfma_f32_16x16x32_bf16 a[20:23], v[100:103], v[68:71], a[20:23]
    ds_read_b64_tr_b16 v[166:167], v11 offset:50176
    v_mfma_f32_16x16x32_bf16 a[24:27], v[100:103], v[72:75], a[24:27]
    ds_read_b64_tr_b16 v[168:169], v11 offset:49160
    v_mfma_f32_16x16x32_bf16 a[28:31], v[100:103], v[76:79], a[28:31]
    ds_read_b64_tr_b16 v[170:171], v11 offset:50184
    v_mfma_f32_16x16x32_bf16 a[32:35], v[104:107], v[64:67], a[32:35]
    ds_read_b64_tr_b16 v[172:173], v12 offset:49152
    v_mfma_f32_16x16x32_bf16 a[36:39], v[104:107], v[68:71], a[36:39]
    ds_read_b64_tr_b16 v[174:175], v12 offset:50176
    v_mfma_f32_16x16x32_bf16 a[40:43], v[104:107], v[72:75], a[40:43]
    ds_read_b64_tr_b16 v[176:177], v12 offset:49160
    v_mfma_f32_16x16x32_bf16 a[44:47], v[104:107], v[76:79], a[44:47]
    ds_read_b64_tr_b16 v[178:179], v12 offset:50184
    v_mfma_f32_16x16x32_bf16 a[48:51], v[108:111], v[64:67], a[48:51]
    ds_read_b64_tr_b16 v[180:181], v13 offset:49152
    v_mfma_f32_16x16x32_bf16 a[52:55], v[108:111], v[68:71], a[52:55]
    ds_read_b64_tr_b16 v[182:183], v13 offset:50176
    v_mfma_f32_16x16x32_bf16 a[56:59], v[108:111], v[72:75], a[56:59]
    ds_read_b64_tr_b16 v[184:185], v13 offset:49160
    v_mfma_f32_16x16x32_bf16 a[60:63], v[108:111], v[76:79], a[60:63]
    ds_read_b64_tr_b16 v[186:187], v13 offset:50184
    v_mfma_f32_16x16x32_bf16 a[64:67], v[112:115], v[64:67], a[64:67]
    ds_read_b64_tr_b16 v[188:189], v14 offset:49152
    v_mfma_f32_16x16x32_bf16 a[68:71], v[112:115], v[68:71], a[68:71]
    ds_read_b64_tr_b16 v[190:191], v14 offset:50176
    v_mfma_f32_16x16x32_bf16 a[72:75], v[112:115], v[72:75], a[72:75]
    ds_read_b64_tr_b16 v[192:193], v15 offset:49152
    v_mfma_f32_16x16x32_bf16 a[76:79], v[112:115], v[76:79], a[76:79]
    ds_read_b64_tr_b16 v[194:195], v15 offset:50176
    v_mfma_f32_16x16x32_bf16 a[80:83], v[116:119], v[64:67], a[80:83]
    ds_read_b64_tr_b16 v[196:197], v16 offset:49152
    v_mfma_f32_16x16x32_bf16 a[84:87], v[116:119], v[68:71], a[84:87]
    ds_read_b64_tr_b16 v[198:199], v16 offset:50176
    v_mfma_f32_16x16x32_bf16 a[88:91], v[116:119], v[72:75], a[88:91]
    ds_read_b64_tr_b16 v[200:201], v17 offset:49152
    v_mfma_f32_16x16x32_bf16 a[92:95], v[116:119], v[76:79], a[92:95]
    ds_read_b64_tr_b16 v[202:203], v17 offset:50176
    v_mfma_f32_16x16x32_bf16 a[96:99], v[120:123], v[64:67], a[96:99]
    ds_read_b64_tr_b16 v[204:205], v18 offset:49152
    v_mfma_f32_16x16x32_bf16 a[100:103], v[120:123], v[68:71], a[100:103]
    ds_read_b64_tr_b16 v[206:207], v18 offset:50176
    v_mfma_f32_16x16x32_bf16 a[104:107], v[120:123], v[72:75], a[104:107]
    ds_read_b64_tr_b16 v[208:209], v19 offset:49152
    v_mfma_f32_16x16x32_bf16 a[108:111], v[120:123], v[76:79], a[108:111]
    ds_read_b64_tr_b16 v[210:211], v19 offset:50176
    v_mfma_f32_16x16x32_bf16 a[112:115], v[124:127], v[64:67], a[112:115]
    ds_read_b64_tr_b16 v[212:213], v20 offset:49152
    v_mfma_f32_16x16x32_bf16 a[116:119], v[124:127], v[68:71], a[116:119]
    ds_read_b64_tr_b16 v[214:215], v20 offset:50176
    v_mfma_f32_16x16x32_bf16 a[120:123], v[124:127], v[72:75], a[120:123]
    v_mfma_f32_16x16x32_bf16 a[124:127], v[124:127], v[76:79], a[124:127]
    buffer_load_dwordx4 v230, s[8:11], s40 offen offset:2048 lds
    v_mfma_f32_16x16x32_bf16 a[128:131], v[128:131], v[64:67], a[128:131]
    v_mfma_f32_16x16x32_bf16 a[132:135], v[128:131], v[68:71], a[132:135]
    v_mfma_f32_16x16x32_bf16 a[136:139], v[128:131], v[72:75], a[136:139]
    buffer_load_dwordx4 v231, s[8:11], s40 offen offset:3072 lds
    v_mfma_f32_16x16x32_bf16 a[140:143], v[128:131], v[76:79], a[140:143]
    s_add_u32 s40, s40, 16384
    v_mfma_f32_16x16x32_bf16 a[144:147], v[132:135], v[64:67], a[144:147]
    s_add_u32 m0, s25, 81920
    v_mfma_f32_16x16x32_bf16 a[148:151], v[132:135], v[68:71], a[148:151]
    buffer_load_dwordx4 v232, s[12:15], s41 offen offset:0 lds
    v_mfma_f32_16x16x32_bf16 a[152:155], v[132:135], v[72:75], a[152:155]
    v_mfma_f32_16x16x32_bf16 a[156:159], v[132:135], v[76:79], a[156:159]
    v_mfma_f32_16x16x32_bf16 a[160:163], v[136:139], v[64:67], a[160:163]
    buffer_load_dwordx4 v233, s[12:15], s41 offen offset:1024 lds
    v_mfma_f32_16x16x32_bf16 a[164:167], v[136:139], v[68:71], a[164:167]
    v_mfma_f32_16x16x32_bf16 a[168:171], v[136:139], v[72:75], a[168:171]
    v_mfma_f32_16x16x32_bf16 a[172:175], v[136:139], v[76:79], a[172:175]
    buffer_load_dwordx4 v232, s[12:15], s41 offen offset:2048 lds
    v_mfma_f32_16x16x32_bf16 a[176:179], v[140:143], v[64:67], a[176:179]
    v_mfma_f32_16x16x32_bf16 a[180:183], v[140:143], v[68:71], a[180:183]
    v_mfma_f32_16x16x32_bf16 a[184:187], v[140:143], v[72:75], a[184:187]
    buffer_load_dwordx4 v233, s[12:15], s41 offen offset:3072 lds
    v_mfma_f32_16x16x32_bf16 a[188:191], v[140:143], v[76:79], a[188:191]
    s_add_u32 s41, s41, 16384
    v_mfma_f32_16x16x32_bf16 a[192:195], v[144:147], v[64:67], a[192:195]
    s_add_u32 m0, s25, 49152
    v_mfma_f32_16x16x32_bf16 a[196:199], v[144:147], v[68:71], a[196:199]
    buffer_load_dwordx4 v228, s[8:11], s40 offen offset:0 lds
    v_mfma_f32_16x16x32_bf16 a[200:203], v[144:147], v[72:75], a[200:203]
    v_mfma_f32_16x16x32_bf16 a[204:207], v[144:147], v[76:79], a[204:207]
    v_mfma_f32_16x16x32_bf16 a[208:211], v[148:151], v[64:67], a[208:211]
    buffer_load_dwordx4 v229, s[8:11], s40 offen offset:1024 lds
    v_mfma_f32_16x16x32_bf16 a[212:215], v[148:151], v[68:71], a[212:215]
    v_mfma_f32_16x16x32_bf16 a[216:219], v[148:151], v[72:75], a[216:219]
    v_mfma_f32_16x16x32_bf16 a[220:223], v[148:151], v[76:79], a[220:223]
    buffer_load_dwordx4 v230, s[8:11], s40 offen offset:2048 lds
    v_mfma_f32_16x16x32_bf16 a[224:227], v[152:155], v[64:67], a[224:227]
    v_mfma_f32_16x16x32_bf16 a[228:231], v[152:155], v[68:71], a[228:231]
    v_mfma_f32_16x16x32_bf16 a[232:235], v[152:155], v[72:75], a[232:235]
    v_mfma_f32_16x16x32_bf16 a[236:239], v[152:155], v[76:79], a[236:239]
    s_waitcnt vmcnt(23) lgkmcnt(0)
    s_barrier
    v_mfma_f32_16x16x32_bf16 a[0:3], v[156:159], v[80:83], a[0:3]
    v_mfma_f32_16x16x32_bf16 a[4:7], v[156:159], v[84:87], a[4:7]
    v_mfma_f32_16x16x32_bf16 a[8:11], v[156:159], v[88:91], a[8:11]
    v_mfma_f32_16x16x32_bf16 a[12:15], v[156:159], v[92:95], a[12:15]
    v_mfma_f32_16x16x32_bf16 a[16:19], v[160:163], v[80:83], a[16:19]
    v_mfma_f32_16x16x32_bf16 a[20:23], v[160:163], v[84:87], a[20:23]
    v_mfma_f32_16x16x32_bf16 a[24:27], v[160:163], v[88:91], a[24:27]
    v_mfma_f32_16x16x32_bf16 a[28:31], v[160:163], v[92:95], a[28:31]
    v_mfma_f32_16x16x32_bf16 a[32:35], v[164:167], v[80:83], a[32:35]
    v_mfma_f32_16x16x32_bf16 a[36:39], v[164:167], v[84:87], a[36:39]
    v_mfma_f32_16x16x32_bf16 a[40:43], v[164:167], v[88:91], a[40:43]
    v_mfma_f32_16x16x32_bf16 a[44:47], v[164:167], v[92:95], a[44:47]
    v_mfma_f32_16x16x32_bf16 a[48:51], v[168:171], v[80:83], a[48:51]
    v_mfma_f32_16x16x32_bf16 a[52:55], v[168:171], v[84:87], a[52:55]
    v_mfma_f32_16x16x32_bf16 a[56:59], v[168:171], v[88:91], a[56:59]
    v_mfma_f32_16x16x32_bf16 a[60:63], v[168:171], v[92:95], a[60:63]
    v_mfma_f32_16x16x32_bf16 a[64:67], v[172:175], v[80:83], a[64:67]
    v_mfma_f32_16x16x32_bf16 a[68:71], v[172:175], v[84:87], a[68:71]
    v_mfma_f32_16x16x32_bf16 a[72:75], v[172:175], v[88:91], a[72:75]
    v_mfma_f32_16x16x32_bf16 a[76:79], v[172:175], v[92:95], a[76:79]
    v_mfma_f32_16x16x32_bf16 a[80:83], v[176:179], v[80:83], a[80:83]
    v_mfma_f32_16x16x32_bf16 a[84:87], v[176:179], v[84:87], a[84:87]
    v_mfma_f32_16x16x32_bf16 a[88:91], v[176:179], v[88:91], a[88:91]
    v_mfma_f32_16x16x32_bf16 a[92:95], v[176:179], v[92:95], a[92:95]
    v_mfma_f32_16x16x32_bf16 a[96:99], v[180:183], v[80:83], a[96:99]
    v_mfma_f32_16x16x32_bf16 a[100:103], v[180:183], v[84:87], a[100:103]
    v_mfma_f32_16x16x32_bf16 a[104:107], v[180:183], v[88:91], a[104:107]
    v_mfma_f32_16x16x32_bf16 a[108:111], v[180:183], v[92:95], a[108:111]
    v_mfma_f32_16x16x32_bf16 a[112:115], v[184:187], v[80:83], a[112:115]
    v_mfma_f32_16x16x32_bf16 a[116:119], v[184:187], v[84:87], a[116:119]
    v_mfma_f32_16x16x32_bf16 a[120:123], v[184:187], v[88:91], a[120:123]
    v_mfma_f32_16x16x32_bf16 a[124:127], v[184:187], v[92:95], a[124:127]
    buffer_load_dwordx4 v231, s[8:11], s40 offen offset:3072 lds
    v_mfma_f32_16x16x32_bf16 a[128:131], v[188:191], v[80:83], a[128:131]
    s_add_u32 s40, s40, 16384
    v_mfma_f32_16x16x32_bf16 a[132:135], v[188:191], v[84:87], a[132:135]
    v_mfma_f32_16x16x32_bf16 a[136:139], v[188:191], v[88:91], a[136:139]
    v_mfma_f32_16x16x32_bf16 a[140:143], v[188:191], v[92:95], a[140:143]
    v_mfma_f32_16x16x32_bf16 a[144:147], v[192:195], v[80:83], a[144:147]
    v_mfma_f32_16x16x32_bf16 a[148:151], v[192:195], v[84:87], a[148:151]
    v_mfma_f32_16x16x32_bf16 a[152:155], v[192:195], v[88:91], a[152:155]
    v_mfma_f32_16x16x32_bf16 a[156:159], v[192:195], v[92:95], a[156:159]
    v_mfma_f32_16x16x32_bf16 a[160:163], v[196:199], v[80:83], a[160:163]
    v_mfma_f32_16x16x32_bf16 a[164:167], v[196:199], v[84:87], a[164:167]
    v_mfma_f32_16x16x32_bf16 a[168:171], v[196:199], v[88:91], a[168:171]
    v_mfma_f32_16x16x32_bf16 a[172:175], v[196:199], v[92:95], a[172:175]
    v_mfma_f32_16x16x32_bf16 a[176:179], v[200:203], v[80:83], a[176:179]
    v_mfma_f32_16x16x32_bf16 a[180:183], v[200:203], v[84:87], a[180:183]
    v_mfma_f32_16x16x32_bf16 a[184:187], v[200:203], v[88:91], a[184:187]
    v_mfma_f32_16x16x32_bf16 a[188:191], v[200:203], v[92:95], a[188:191]
    v_mfma_f32_16x16x32_bf16 a[192:195], v[204:207], v[80:83], a[192:195]
    v_mfma_f32_16x16x32_bf16 a[196:199], v[204:207], v[84:87], a[196:199]
    v_mfma_f32_16x16x32_bf16 a[200:203], v[204:207], v[88:91], a[200:203]
    v_mfma_f32_16x16x32_bf16 a[204:207], v[204:207], v[92:95], a[204:207]
    v_mfma_f32_16x16x32_bf16 a[208:211], v[208:211], v[80:83], a[208:211]
    v_mfma_f32_16x16x32_bf16 a[212:215], v[208:211], v[84:87], a[212:215]
    v_mfma_f32_16x16x32_bf16 a[216:219], v[208:211], v[88:91], a[216:219]
    v_mfma_f32_16x16x32_bf16 a[220:223], v[208:211], v[92:95], a[220:223]
    v_mfma_f32_16x16x32_bf16 a[224:227], v[212:215], v[80:83], a[224:227]
    v_mfma_f32_16x16x32_bf16 a[228:231], v[212:215], v[84:87], a[228:231]
    v_mfma_f32_16x16x32_bf16 a[232:235], v[212:215], v[88:91], a[232:235]
    v_mfma_f32_16x16x32_bf16 a[236:239], v[212:215], v[92:95], a[236:239]
    s_mul_i32 s3, s33, 114688
    s_add_u32 s60, s34, 4194304
    s_addc_u32 s61, s35, 0
    s_add_u32 s60, s60, s3
    s_addc_u32 s61, s61, 0
    s_and_b32 s61, s61, 0xffff
    s_mov_b32 s62, 458752
    s_mov_b32 s63, 0x20000
    s_mul_i32 s93, s21, 7
    s_add_u32 s93, s93, s97
    s_lshl_b32 s93, s93, 9
    s_mul_i32 s94, s97, -4088
    s_add_u32 s94, s94, 3072
    s_add_u32 s94, s94, s93
    v_add_u32 v25, 0, v6
    v_add_u32 v26, 114688, v6
    v_add_u32 v27, 229376, v6
    v_add_u32 v28, 344064, v6
    s_load_dwordx2 s[46:47], s[0:1], 32
    s_load_dwordx2 s[50:51], s[0:1], 56
    s_lshl_b32 s3, s2, 2
    s_add_u32 s3, s3, s20
    s_waitcnt lgkmcnt(0)
    s_mov_b32 s52, s46
    s_mov_b32 s53, s47
    s_and_b32 s53, s53, 0xffff
    s_mov_b32 s54, 8388608
    s_mov_b32 s55, 0x20000
    s_mov_b32 s56, s50
    s_mov_b32 s57, s51
    s_and_b32 s57, s57, 0xffff
    s_mov_b32 s58, 7340032
    s_mov_b32 s59, 0x20000
    s_lshl_b32 s27, s3, 13
    s_mul_i32 s24, s3, 7168
    s_mov_b32 s30, 0xbfb8aa3b
    s_mov_b32 s31, 0xbfb8aa3b
    v_accvgpr_read_b32 v96, a128
    v_accvgpr_read_b32 v97, a129
    v_accvgpr_read_b32 v98, a130
    v_accvgpr_read_b32 v99, a131
    v_accvgpr_read_b32 v100, a132
    v_accvgpr_read_b32 v101, a133
    v_accvgpr_read_b32 v102, a134
    v_accvgpr_read_b32 v103, a135
    v_accvgpr_read_b32 v104, a136
    v_accvgpr_read_b32 v105, a137
    v_accvgpr_read_b32 v106, a138
    v_accvgpr_read_b32 v107, a139
    v_accvgpr_read_b32 v108, a140
    v_accvgpr_read_b32 v109, a141
    v_accvgpr_read_b32 v110, a142
    v_accvgpr_read_b32 v111, a143
    v_accvgpr_read_b32 v112, a144
    v_accvgpr_read_b32 v113, a145
    v_accvgpr_read_b32 v114, a146
    v_accvgpr_read_b32 v115, a147
    v_accvgpr_read_b32 v116, a148
    v_accvgpr_read_b32 v117, a149
    v_accvgpr_read_b32 v118, a150
    v_accvgpr_read_b32 v119, a151
    v_accvgpr_read_b32 v120, a152
    v_accvgpr_read_b32 v121, a153
    v_accvgpr_read_b32 v122, a154
    v_accvgpr_read_b32 v123, a155
    v_accvgpr_read_b32 v124, a156
    v_accvgpr_read_b32 v125, a157
    v_accvgpr_read_b32 v126, a158
    v_accvgpr_read_b32 v127, a159
    v_pk_mul_f32 v[128:129], v[96:97], s[30:31]
    v_pk_mul_f32 v[130:131], v[98:99], s[30:31]
    v_pk_mul_f32 v[132:133], v[100:101], s[30:31]
    v_pk_mul_f32 v[134:135], v[102:103], s[30:31]
    v_pk_mul_f32 v[136:137], v[104:105], s[30:31]
    v_pk_mul_f32 v[138:139], v[106:107], s[30:31]
    v_pk_mul_f32 v[140:141], v[108:109], s[30:31]
    v_pk_mul_f32 v[142:143], v[110:111], s[30:31]
    v_pk_mul_f32 v[144:145], v[112:113], s[30:31]
    v_pk_mul_f32 v[146:147], v[114:115], s[30:31]
    v_pk_mul_f32 v[148:149], v[116:117], s[30:31]
    v_pk_mul_f32 v[150:151], v[118:119], s[30:31]
    v_pk_mul_f32 v[152:153], v[120:121], s[30:31]
    v_pk_mul_f32 v[154:155], v[122:123], s[30:31]
    v_pk_mul_f32 v[156:157], v[124:125], s[30:31]
    v_pk_mul_f32 v[158:159], v[126:127], s[30:31]
    v_exp_f32 v128, v128
    v_exp_f32 v129, v129
    v_exp_f32 v130, v130
    v_exp_f32 v131, v131
    v_exp_f32 v132, v132
    v_exp_f32 v133, v133
    v_exp_f32 v134, v134
    v_exp_f32 v135, v135
    v_exp_f32 v136, v136
    v_exp_f32 v137, v137
    v_exp_f32 v138, v138
    v_exp_f32 v139, v139
    v_exp_f32 v140, v140
    v_exp_f32 v141, v141
    v_exp_f32 v142, v142
    v_exp_f32 v143, v143
    v_exp_f32 v144, v144
    v_exp_f32 v145, v145
    v_exp_f32 v146, v146
    v_exp_f32 v147, v147
    v_exp_f32 v148, v148
    v_exp_f32 v149, v149
    v_exp_f32 v150, v150
    v_exp_f32 v151, v151
    v_exp_f32 v152, v152
    v_exp_f32 v153, v153
    v_exp_f32 v154, v154
    v_exp_f32 v155, v155
    v_exp_f32 v156, v156
    v_exp_f32 v157, v157
    v_exp_f32 v158, v158
    v_exp_f32 v159, v159
    v_pk_add_f32 v[128:129], v[128:129], 1.0 op_sel_hi:[1,0]
    v_pk_add_f32 v[130:131], v[130:131], 1.0 op_sel_hi:[1,0]
    v_pk_add_f32 v[132:133], v[132:133], 1.0 op_sel_hi:[1,0]
    v_pk_add_f32 v[134:135], v[134:135], 1.0 op_sel_hi:[1,0]
    v_pk_add_f32 v[136:137], v[136:137], 1.0 op_sel_hi:[1,0]
    v_pk_add_f32 v[138:139], v[138:139], 1.0 op_sel_hi:[1,0]
    v_pk_add_f32 v[140:141], v[140:141], 1.0 op_sel_hi:[1,0]
    v_pk_add_f32 v[142:143], v[142:143], 1.0 op_sel_hi:[1,0]
    v_pk_add_f32 v[144:145], v[144:145], 1.0 op_sel_hi:[1,0]
    v_pk_add_f32 v[146:147], v[146:147], 1.0 op_sel_hi:[1,0]
    v_pk_add_f32 v[148:149], v[148:149], 1.0 op_sel_hi:[1,0]
    v_pk_add_f32 v[150:151], v[150:151], 1.0 op_sel_hi:[1,0]
    v_pk_add_f32 v[152:153], v[152:153], 1.0 op_sel_hi:[1,0]
    v_pk_add_f32 v[154:155], v[154:155], 1.0 op_sel_hi:[1,0]
    v_pk_add_f32 v[156:157], v[156:157], 1.0 op_sel_hi:[1,0]
    v_pk_add_f32 v[158:159], v[158:159], 1.0 op_sel_hi:[1,0]
    v_rcp_f32 v128, v128
    v_rcp_f32 v129, v129
    v_rcp_f32 v130, v130
    v_rcp_f32 v131, v131
    v_rcp_f32 v132, v132
    v_rcp_f32 v133, v133
    v_rcp_f32 v134, v134
    v_rcp_f32 v135, v135
    v_rcp_f32 v136, v136
    v_rcp_f32 v137, v137
    v_rcp_f32 v138, v138
    v_rcp_f32 v139, v139
    v_rcp_f32 v140, v140
    v_rcp_f32 v141, v141
    v_rcp_f32 v142, v142
    v_rcp_f32 v143, v143
    v_rcp_f32 v144, v144
    v_rcp_f32 v145, v145
    v_rcp_f32 v146, v146
    v_rcp_f32 v147, v147
    v_rcp_f32 v148, v148
    v_rcp_f32 v149, v149
    v_rcp_f32 v150, v150
    v_rcp_f32 v151, v151
    v_rcp_f32 v152, v152
    v_rcp_f32 v153, v153
    v_rcp_f32 v154, v154
    v_rcp_f32 v155, v155
    v_rcp_f32 v156, v156
    v_rcp_f32 v157, v157
    v_rcp_f32 v158, v158
    v_rcp_f32 v159, v159
    v_pk_mul_f32 v[96:97], v[96:97], v[128:129]
    v_pk_mul_f32 v[98:99], v[98:99], v[130:131]
    v_pk_mul_f32 v[100:101], v[100:101], v[132:133]
    v_pk_mul_f32 v[102:103], v[102:103], v[134:135]
    v_pk_mul_f32 v[104:105], v[104:105], v[136:137]
    v_pk_mul_f32 v[106:107], v[106:107], v[138:139]
    v_pk_mul_f32 v[108:109], v[108:109], v[140:141]
    v_pk_mul_f32 v[110:111], v[110:111], v[142:143]
    v_pk_mul_f32 v[112:113], v[112:113], v[144:145]
    v_pk_mul_f32 v[114:115], v[114:115], v[146:147]
    v_pk_mul_f32 v[116:117], v[116:117], v[148:149]
    v_pk_mul_f32 v[118:119], v[118:119], v[150:151]
    v_pk_mul_f32 v[120:121], v[120:121], v[152:153]
    v_pk_mul_f32 v[122:123], v[122:123], v[154:155]
    v_pk_mul_f32 v[124:125], v[124:125], v[156:157]
    v_pk_mul_f32 v[126:127], v[126:127], v[158:159]
    v_cvt_pk_bf16_f32 v160, v96, v97
    v_cvt_pk_bf16_f32 v161, v98, v99
    v_cvt_pk_bf16_f32 v162, v112, v113
    v_cvt_pk_bf16_f32 v163, v114, v115
    v_cvt_pk_bf16_f32 v164, v100, v101
    v_cvt_pk_bf16_f32 v165, v102, v103
    v_cvt_pk_bf16_f32 v166, v116, v117
    v_cvt_pk_bf16_f32 v167, v118, v119
    v_cvt_pk_bf16_f32 v168, v104, v105
    v_cvt_pk_bf16_f32 v169, v106, v107
    v_cvt_pk_bf16_f32 v170, v120, v121
    v_cvt_pk_bf16_f32 v171, v122, v123
    v_cvt_pk_bf16_f32 v172, v108, v109
    v_cvt_pk_bf16_f32 v173, v110, v111
    v_cvt_pk_bf16_f32 v174, v124, v125
    v_cvt_pk_bf16_f32 v175, v126, v127
    s_waitcnt vmcnt(0)
    buffer_store_dwordx4 v[160:163], v25, s[60:63], s93 offen offset:0 sc1
    buffer_store_dwordx4 v[164:167], v26, s[60:63], s93 offen offset:0 sc1
    buffer_store_dwordx4 v[168:171], v27, s[60:63], s93 offen offset:0 sc1
    buffer_store_dwordx4 v[172:175], v28, s[60:63], s93 offen offset:0 sc1
    v_accvgpr_read_b32 v96, a160
    v_accvgpr_read_b32 v97, a161
    v_accvgpr_read_b32 v98, a162
    v_accvgpr_read_b32 v99, a163
    v_accvgpr_read_b32 v100, a164
    v_accvgpr_read_b32 v101, a165
    v_accvgpr_read_b32 v102, a166
    v_accvgpr_read_b32 v103, a167
    v_accvgpr_read_b32 v104, a168
    v_accvgpr_read_b32 v105, a169
    v_accvgpr_read_b32 v106, a170
    v_accvgpr_read_b32 v107, a171
    v_accvgpr_read_b32 v108, a172
    v_accvgpr_read_b32 v109, a173
    v_accvgpr_read_b32 v110, a174
    v_accvgpr_read_b32 v111, a175
    v_accvgpr_read_b32 v112, a176
    v_accvgpr_read_b32 v113, a177
    v_accvgpr_read_b32 v114, a178
    v_accvgpr_read_b32 v115, a179
    v_accvgpr_read_b32 v116, a180
    v_accvgpr_read_b32 v117, a181
    v_accvgpr_read_b32 v118, a182
    v_accvgpr_read_b32 v119, a183
    v_accvgpr_read_b32 v120, a184
    v_accvgpr_read_b32 v121, a185
    v_accvgpr_read_b32 v122, a186
    v_accvgpr_read_b32 v123, a187
    v_accvgpr_read_b32 v124, a188
    v_accvgpr_read_b32 v125, a189
    v_accvgpr_read_b32 v126, a190
    v_accvgpr_read_b32 v127, a191
    v_pk_mul_f32 v[128:129], v[96:97], s[30:31]
    v_pk_mul_f32 v[130:131], v[98:99], s[30:31]
    v_pk_mul_f32 v[132:133], v[100:101], s[30:31]
    v_pk_mul_f32 v[134:135], v[102:103], s[30:31]
    v_pk_mul_f32 v[136:137], v[104:105], s[30:31]
    v_pk_mul_f32 v[138:139], v[106:107], s[30:31]
    v_pk_mul_f32 v[140:141], v[108:109], s[30:31]
    v_pk_mul_f32 v[142:143], v[110:111], s[30:31]
    v_pk_mul_f32 v[144:145], v[112:113], s[30:31]
    v_pk_mul_f32 v[146:147], v[114:115], s[30:31]
    v_pk_mul_f32 v[148:149], v[116:117], s[30:31]
    v_pk_mul_f32 v[150:151], v[118:119], s[30:31]
    v_pk_mul_f32 v[152:153], v[120:121], s[30:31]
    v_pk_mul_f32 v[154:155], v[122:123], s[30:31]
    v_pk_mul_f32 v[156:157], v[124:125], s[30:31]
    v_pk_mul_f32 v[158:159], v[126:127], s[30:31]
    v_exp_f32 v128, v128
    v_exp_f32 v129, v129
    v_exp_f32 v130, v130
    v_exp_f32 v131, v131
    v_exp_f32 v132, v132
    v_exp_f32 v133, v133
    v_exp_f32 v134, v134
    v_exp_f32 v135, v135
    v_exp_f32 v136, v136
    v_exp_f32 v137, v137
    v_exp_f32 v138, v138
    v_exp_f32 v139, v139
    v_exp_f32 v140, v140
    v_exp_f32 v141, v141
    v_exp_f32 v142, v142
    v_exp_f32 v143, v143
    v_exp_f32 v144, v144
    v_exp_f32 v145, v145
    v_exp_f32 v146, v146
    v_exp_f32 v147, v147
    v_exp_f32 v148, v148
    v_exp_f32 v149, v149
    v_exp_f32 v150, v150
    v_exp_f32 v151, v151
    v_exp_f32 v152, v152
    v_exp_f32 v153, v153
    v_exp_f32 v154, v154
    v_exp_f32 v155, v155
    v_exp_f32 v156, v156
    v_exp_f32 v157, v157
    v_exp_f32 v158, v158
    v_exp_f32 v159, v159
    v_pk_add_f32 v[128:129], v[128:129], 1.0 op_sel_hi:[1,0]
    v_pk_add_f32 v[130:131], v[130:131], 1.0 op_sel_hi:[1,0]
    v_pk_add_f32 v[132:133], v[132:133], 1.0 op_sel_hi:[1,0]
    v_pk_add_f32 v[134:135], v[134:135], 1.0 op_sel_hi:[1,0]
    v_pk_add_f32 v[136:137], v[136:137], 1.0 op_sel_hi:[1,0]
    v_pk_add_f32 v[138:139], v[138:139], 1.0 op_sel_hi:[1,0]
    v_pk_add_f32 v[140:141], v[140:141], 1.0 op_sel_hi:[1,0]
    v_pk_add_f32 v[142:143], v[142:143], 1.0 op_sel_hi:[1,0]
    v_pk_add_f32 v[144:145], v[144:145], 1.0 op_sel_hi:[1,0]
    v_pk_add_f32 v[146:147], v[146:147], 1.0 op_sel_hi:[1,0]
    v_pk_add_f32 v[148:149], v[148:149], 1.0 op_sel_hi:[1,0]
    v_pk_add_f32 v[150:151], v[150:151], 1.0 op_sel_hi:[1,0]
    v_pk_add_f32 v[152:153], v[152:153], 1.0 op_sel_hi:[1,0]
    v_pk_add_f32 v[154:155], v[154:155], 1.0 op_sel_hi:[1,0]
    v_pk_add_f32 v[156:157], v[156:157], 1.0 op_sel_hi:[1,0]
    v_pk_add_f32 v[158:159], v[158:159], 1.0 op_sel_hi:[1,0]
    v_rcp_f32 v128, v128
    v_rcp_f32 v129, v129
    v_rcp_f32 v130, v130
    v_rcp_f32 v131, v131
    v_rcp_f32 v132, v132
    v_rcp_f32 v133, v133
    v_rcp_f32 v134, v134
    v_rcp_f32 v135, v135
    v_rcp_f32 v136, v136
    v_rcp_f32 v137, v137
    v_rcp_f32 v138, v138
    v_rcp_f32 v139, v139
    v_rcp_f32 v140, v140
    v_rcp_f32 v141, v141
    v_rcp_f32 v142, v142
    v_rcp_f32 v143, v143
    v_rcp_f32 v144, v144
    v_rcp_f32 v145, v145
    v_rcp_f32 v146, v146
    v_rcp_f32 v147, v147
    v_rcp_f32 v148, v148
    v_rcp_f32 v149, v149
    v_rcp_f32 v150, v150
    v_rcp_f32 v151, v151
    v_rcp_f32 v152, v152
    v_rcp_f32 v153, v153
    v_rcp_f32 v154, v154
    v_rcp_f32 v155, v155
    v_rcp_f32 v156, v156
    v_rcp_f32 v157, v157
    v_rcp_f32 v158, v158
    v_rcp_f32 v159, v159
    v_pk_mul_f32 v[96:97], v[96:97], v[128:129]
    v_pk_mul_f32 v[98:99], v[98:99], v[130:131]
    v_pk_mul_f32 v[100:101], v[100:101], v[132:133]
    v_pk_mul_f32 v[102:103], v[102:103], v[134:135]
    v_pk_mul_f32 v[104:105], v[104:105], v[136:137]
    v_pk_mul_f32 v[106:107], v[106:107], v[138:139]
    v_pk_mul_f32 v[108:109], v[108:109], v[140:141]
    v_pk_mul_f32 v[110:111], v[110:111], v[142:143]
    v_pk_mul_f32 v[112:113], v[112:113], v[144:145]
    v_pk_mul_f32 v[114:115], v[114:115], v[146:147]
    v_pk_mul_f32 v[116:117], v[116:117], v[148:149]
    v_pk_mul_f32 v[118:119], v[118:119], v[150:151]
    v_pk_mul_f32 v[120:121], v[120:121], v[152:153]
    v_pk_mul_f32 v[122:123], v[122:123], v[154:155]
    v_pk_mul_f32 v[124:125], v[124:125], v[156:157]
    v_pk_mul_f32 v[126:127], v[126:127], v[158:159]
    v_cvt_pk_bf16_f32 v176, v96, v97
    v_cvt_pk_bf16_f32 v177, v98, v99
    v_cvt_pk_bf16_f32 v178, v112, v113
    v_cvt_pk_bf16_f32 v179, v114, v115
    v_cvt_pk_bf16_f32 v180, v100, v101
    v_cvt_pk_bf16_f32 v181, v102, v103
    v_cvt_pk_bf16_f32 v182, v116, v117
    v_cvt_pk_bf16_f32 v183, v118, v119
    v_cvt_pk_bf16_f32 v184, v104, v105
    v_cvt_pk_bf16_f32 v185, v106, v107
    v_cvt_pk_bf16_f32 v186, v120, v121
    v_cvt_pk_bf16_f32 v187, v122, v123
    v_cvt_pk_bf16_f32 v188, v108, v109
    v_cvt_pk_bf16_f32 v189, v110, v111
    v_cvt_pk_bf16_f32 v190, v124, v125
    v_cvt_pk_bf16_f32 v191, v126, v127
    buffer_store_dwordx4 v[176:179], v25, s[60:63], s93 offen offset:1024 sc1
    buffer_store_dwordx4 v[180:183], v26, s[60:63], s93 offen offset:1024 sc1
    buffer_store_dwordx4 v[184:187], v27, s[60:63], s93 offen offset:1024 sc1
    buffer_store_dwordx4 v[188:191], v28, s[60:63], s93 offen offset:1024 sc1
    v_accvgpr_read_b32 v96, a192
    v_accvgpr_read_b32 v97, a193
    v_accvgpr_read_b32 v98, a194
    v_accvgpr_read_b32 v99, a195
    v_accvgpr_read_b32 v100, a196
    v_accvgpr_read_b32 v101, a197
    v_accvgpr_read_b32 v102, a198
    v_accvgpr_read_b32 v103, a199
    v_accvgpr_read_b32 v104, a200
    v_accvgpr_read_b32 v105, a201
    v_accvgpr_read_b32 v106, a202
    v_accvgpr_read_b32 v107, a203
    v_accvgpr_read_b32 v108, a204
    v_accvgpr_read_b32 v109, a205
    v_accvgpr_read_b32 v110, a206
    v_accvgpr_read_b32 v111, a207
    v_accvgpr_read_b32 v112, a208
    v_accvgpr_read_b32 v113, a209
    v_accvgpr_read_b32 v114, a210
    v_accvgpr_read_b32 v115, a211
    v_accvgpr_read_b32 v116, a212
    v_accvgpr_read_b32 v117, a213
    v_accvgpr_read_b32 v118, a214
    v_accvgpr_read_b32 v119, a215
    v_accvgpr_read_b32 v120, a216
    v_accvgpr_read_b32 v121, a217
    v_accvgpr_read_b32 v122, a218
    v_accvgpr_read_b32 v123, a219
    v_accvgpr_read_b32 v124, a220
    v_accvgpr_read_b32 v125, a221
    v_accvgpr_read_b32 v126, a222
    v_accvgpr_read_b32 v127, a223
    v_pk_mul_f32 v[128:129], v[96:97], s[30:31]
    v_pk_mul_f32 v[130:131], v[98:99], s[30:31]
    v_pk_mul_f32 v[132:133], v[100:101], s[30:31]
    v_pk_mul_f32 v[134:135], v[102:103], s[30:31]
    v_pk_mul_f32 v[136:137], v[104:105], s[30:31]
    v_pk_mul_f32 v[138:139], v[106:107], s[30:31]
    v_pk_mul_f32 v[140:141], v[108:109], s[30:31]
    v_pk_mul_f32 v[142:143], v[110:111], s[30:31]
    v_pk_mul_f32 v[144:145], v[112:113], s[30:31]
    v_pk_mul_f32 v[146:147], v[114:115], s[30:31]
    v_pk_mul_f32 v[148:149], v[116:117], s[30:31]
    v_pk_mul_f32 v[150:151], v[118:119], s[30:31]
    v_pk_mul_f32 v[152:153], v[120:121], s[30:31]
    v_pk_mul_f32 v[154:155], v[122:123], s[30:31]
    v_pk_mul_f32 v[156:157], v[124:125], s[30:31]
    v_pk_mul_f32 v[158:159], v[126:127], s[30:31]
    v_exp_f32 v128, v128
    v_exp_f32 v129, v129
    v_exp_f32 v130, v130
    v_exp_f32 v131, v131
    v_exp_f32 v132, v132
    v_exp_f32 v133, v133
    v_exp_f32 v134, v134
    v_exp_f32 v135, v135
    v_exp_f32 v136, v136
    v_exp_f32 v137, v137
    v_exp_f32 v138, v138
    v_exp_f32 v139, v139
    v_exp_f32 v140, v140
    v_exp_f32 v141, v141
    v_exp_f32 v142, v142
    v_exp_f32 v143, v143
    v_exp_f32 v144, v144
    v_exp_f32 v145, v145
    v_exp_f32 v146, v146
    v_exp_f32 v147, v147
    v_exp_f32 v148, v148
    v_exp_f32 v149, v149
    v_exp_f32 v150, v150
    v_exp_f32 v151, v151
    v_exp_f32 v152, v152
    v_exp_f32 v153, v153
    v_exp_f32 v154, v154
    v_exp_f32 v155, v155
    v_exp_f32 v156, v156
    v_exp_f32 v157, v157
    v_exp_f32 v158, v158
    v_exp_f32 v159, v159
    v_pk_add_f32 v[128:129], v[128:129], 1.0 op_sel_hi:[1,0]
    v_pk_add_f32 v[130:131], v[130:131], 1.0 op_sel_hi:[1,0]
    v_pk_add_f32 v[132:133], v[132:133], 1.0 op_sel_hi:[1,0]
    v_pk_add_f32 v[134:135], v[134:135], 1.0 op_sel_hi:[1,0]
    v_pk_add_f32 v[136:137], v[136:137], 1.0 op_sel_hi:[1,0]
    v_pk_add_f32 v[138:139], v[138:139], 1.0 op_sel_hi:[1,0]
    v_pk_add_f32 v[140:141], v[140:141], 1.0 op_sel_hi:[1,0]
    v_pk_add_f32 v[142:143], v[142:143], 1.0 op_sel_hi:[1,0]
    v_pk_add_f32 v[144:145], v[144:145], 1.0 op_sel_hi:[1,0]
    v_pk_add_f32 v[146:147], v[146:147], 1.0 op_sel_hi:[1,0]
    v_pk_add_f32 v[148:149], v[148:149], 1.0 op_sel_hi:[1,0]
    v_pk_add_f32 v[150:151], v[150:151], 1.0 op_sel_hi:[1,0]
    v_pk_add_f32 v[152:153], v[152:153], 1.0 op_sel_hi:[1,0]
    v_pk_add_f32 v[154:155], v[154:155], 1.0 op_sel_hi:[1,0]
    v_pk_add_f32 v[156:157], v[156:157], 1.0 op_sel_hi:[1,0]
    v_pk_add_f32 v[158:159], v[158:159], 1.0 op_sel_hi:[1,0]
    v_rcp_f32 v128, v128
    v_rcp_f32 v129, v129
    v_rcp_f32 v130, v130
    v_rcp_f32 v131, v131
    v_rcp_f32 v132, v132
    v_rcp_f32 v133, v133
    v_rcp_f32 v134, v134
    v_rcp_f32 v135, v135
    v_rcp_f32 v136, v136
    v_rcp_f32 v137, v137
    v_rcp_f32 v138, v138
    v_rcp_f32 v139, v139
    v_rcp_f32 v140, v140
    v_rcp_f32 v141, v141
    v_rcp_f32 v142, v142
    v_rcp_f32 v143, v143
    v_rcp_f32 v144, v144
    v_rcp_f32 v145, v145
    v_rcp_f32 v146, v146
    v_rcp_f32 v147, v147
    v_rcp_f32 v148, v148
    v_rcp_f32 v149, v149
    v_rcp_f32 v150, v150
    v_rcp_f32 v151, v151
    v_rcp_f32 v152, v152
    v_rcp_f32 v153, v153
    v_rcp_f32 v154, v154
    v_rcp_f32 v155, v155
    v_rcp_f32 v156, v156
    v_rcp_f32 v157, v157
    v_rcp_f32 v158, v158
    v_rcp_f32 v159, v159
    v_pk_mul_f32 v[96:97], v[96:97], v[128:129]
    v_pk_mul_f32 v[98:99], v[98:99], v[130:131]
    v_pk_mul_f32 v[100:101], v[100:101], v[132:133]
    v_pk_mul_f32 v[102:103], v[102:103], v[134:135]
    v_pk_mul_f32 v[104:105], v[104:105], v[136:137]
    v_pk_mul_f32 v[106:107], v[106:107], v[138:139]
    v_pk_mul_f32 v[108:109], v[108:109], v[140:141]
    v_pk_mul_f32 v[110:111], v[110:111], v[142:143]
    v_pk_mul_f32 v[112:113], v[112:113], v[144:145]
    v_pk_mul_f32 v[114:115], v[114:115], v[146:147]
    v_pk_mul_f32 v[116:117], v[116:117], v[148:149]
    v_pk_mul_f32 v[118:119], v[118:119], v[150:151]
    v_pk_mul_f32 v[120:121], v[120:121], v[152:153]
    v_pk_mul_f32 v[122:123], v[122:123], v[154:155]
    v_pk_mul_f32 v[124:125], v[124:125], v[156:157]
    v_pk_mul_f32 v[126:127], v[126:127], v[158:159]
    v_cvt_pk_bf16_f32 v160, v96, v97
    v_cvt_pk_bf16_f32 v161, v98, v99
    v_cvt_pk_bf16_f32 v162, v112, v113
    v_cvt_pk_bf16_f32 v163, v114, v115
    v_cvt_pk_bf16_f32 v164, v100, v101
    v_cvt_pk_bf16_f32 v165, v102, v103
    v_cvt_pk_bf16_f32 v166, v116, v117
    v_cvt_pk_bf16_f32 v167, v118, v119
    v_cvt_pk_bf16_f32 v168, v104, v105
    v_cvt_pk_bf16_f32 v169, v106, v107
    v_cvt_pk_bf16_f32 v170, v120, v121
    v_cvt_pk_bf16_f32 v171, v122, v123
    v_cvt_pk_bf16_f32 v172, v108, v109
    v_cvt_pk_bf16_f32 v173, v110, v111
    v_cvt_pk_bf16_f32 v174, v124, v125
    v_cvt_pk_bf16_f32 v175, v126, v127
    buffer_store_dwordx4 v[160:163], v25, s[60:63], s93 offen offset:2048 sc1
    buffer_store_dwordx4 v[164:167], v26, s[60:63], s93 offen offset:2048 sc1
    buffer_store_dwordx4 v[168:171], v27, s[60:63], s93 offen offset:2048 sc1
    buffer_store_dwordx4 v[172:175], v28, s[60:63], s93 offen offset:2048 sc1
    v_accvgpr_read_b32 v96, a224
    v_accvgpr_read_b32 v97, a225
    v_accvgpr_read_b32 v98, a226
    v_accvgpr_read_b32 v99, a227
    v_accvgpr_read_b32 v100, a228
    v_accvgpr_read_b32 v101, a229
    v_accvgpr_read_b32 v102, a230
    v_accvgpr_read_b32 v103, a231
    v_accvgpr_read_b32 v104, a232
    v_accvgpr_read_b32 v105, a233
    v_accvgpr_read_b32 v106, a234
    v_accvgpr_read_b32 v107, a235
    v_accvgpr_read_b32 v108, a236
    v_accvgpr_read_b32 v109, a237
    v_accvgpr_read_b32 v110, a238
    v_accvgpr_read_b32 v111, a239
    v_pk_mul_f32 v[128:129], v[96:97], s[30:31]
    v_pk_mul_f32 v[130:131], v[98:99], s[30:31]
    v_pk_mul_f32 v[132:133], v[100:101], s[30:31]
    v_pk_mul_f32 v[134:135], v[102:103], s[30:31]
    v_pk_mul_f32 v[136:137], v[104:105], s[30:31]
    v_pk_mul_f32 v[138:139], v[106:107], s[30:31]
    v_pk_mul_f32 v[140:141], v[108:109], s[30:31]
    v_pk_mul_f32 v[142:143], v[110:111], s[30:31]
    v_exp_f32 v128, v128
    v_exp_f32 v129, v129
    v_exp_f32 v130, v130
    v_exp_f32 v131, v131
    v_exp_f32 v132, v132
    v_exp_f32 v133, v133
    v_exp_f32 v134, v134
    v_exp_f32 v135, v135
    v_exp_f32 v136, v136
    v_exp_f32 v137, v137
    v_exp_f32 v138, v138
    v_exp_f32 v139, v139
    v_exp_f32 v140, v140
    v_exp_f32 v141, v141
    v_exp_f32 v142, v142
    v_exp_f32 v143, v143
    v_pk_add_f32 v[128:129], v[128:129], 1.0 op_sel_hi:[1,0]
    v_pk_add_f32 v[130:131], v[130:131], 1.0 op_sel_hi:[1,0]
    v_pk_add_f32 v[132:133], v[132:133], 1.0 op_sel_hi:[1,0]
    v_pk_add_f32 v[134:135], v[134:135], 1.0 op_sel_hi:[1,0]
    v_pk_add_f32 v[136:137], v[136:137], 1.0 op_sel_hi:[1,0]
    v_pk_add_f32 v[138:139], v[138:139], 1.0 op_sel_hi:[1,0]
    v_pk_add_f32 v[140:141], v[140:141], 1.0 op_sel_hi:[1,0]
    v_pk_add_f32 v[142:143], v[142:143], 1.0 op_sel_hi:[1,0]
    v_rcp_f32 v128, v128
    v_rcp_f32 v129, v129
    v_rcp_f32 v130, v130
    v_rcp_f32 v131, v131
    v_rcp_f32 v132, v132
    v_rcp_f32 v133, v133
    v_rcp_f32 v134, v134
    v_rcp_f32 v135, v135
    v_rcp_f32 v136, v136
    v_rcp_f32 v137, v137
    v_rcp_f32 v138, v138
    v_rcp_f32 v139, v139
    v_rcp_f32 v140, v140
    v_rcp_f32 v141, v141
    v_rcp_f32 v142, v142
    v_rcp_f32 v143, v143
    v_pk_mul_f32 v[96:97], v[96:97], v[128:129]
    v_pk_mul_f32 v[98:99], v[98:99], v[130:131]
    v_pk_mul_f32 v[100:101], v[100:101], v[132:133]
    v_pk_mul_f32 v[102:103], v[102:103], v[134:135]
    v_pk_mul_f32 v[104:105], v[104:105], v[136:137]
    v_pk_mul_f32 v[106:107], v[106:107], v[138:139]
    v_pk_mul_f32 v[108:109], v[108:109], v[140:141]
    v_pk_mul_f32 v[110:111], v[110:111], v[142:143]
    v_cvt_pk_bf16_f32 v176, v96, v97
    v_cvt_pk_bf16_f32 v177, v98, v99
    v_cvt_pk_bf16_f32 v180, v100, v101
    v_cvt_pk_bf16_f32 v181, v102, v103
    v_cvt_pk_bf16_f32 v184, v104, v105
    v_cvt_pk_bf16_f32 v185, v106, v107
    v_cvt_pk_bf16_f32 v188, v108, v109
    v_cvt_pk_bf16_f32 v189, v110, v111
    buffer_store_dwordx2 v[176:177], v25, s[60:63], s94 offen sc1
    buffer_store_dwordx2 v[180:181], v26, s[60:63], s94 offen sc1
    buffer_store_dwordx2 v[184:185], v27, s[60:63], s94 offen sc1
    buffer_store_dwordx2 v[188:189], v28, s[60:63], s94 offen sc1
    s_mov_b32 s30, 0x3e0293ee
    s_mov_b32 s31, 0x3e0293ee
    v_accvgpr_read_b32 v96, a0
    v_accvgpr_read_b32 v97, a1
    v_accvgpr_read_b32 v98, a2
    v_accvgpr_read_b32 v99, a3
    v_accvgpr_read_b32 v100, a4
    v_accvgpr_read_b32 v101, a5
    v_accvgpr_read_b32 v102, a6
    v_accvgpr_read_b32 v103, a7
    v_accvgpr_read_b32 v104, a8
    v_accvgpr_read_b32 v105, a9
    v_accvgpr_read_b32 v106, a10
    v_accvgpr_read_b32 v107, a11
    v_accvgpr_read_b32 v108, a12
    v_accvgpr_read_b32 v109, a13
    v_accvgpr_read_b32 v110, a14
    v_accvgpr_read_b32 v111, a15
    v_accvgpr_read_b32 v112, a16
    v_accvgpr_read_b32 v113, a17
    v_accvgpr_read_b32 v114, a18
    v_accvgpr_read_b32 v115, a19
    v_accvgpr_read_b32 v116, a20
    v_accvgpr_read_b32 v117, a21
    v_accvgpr_read_b32 v118, a22
    v_accvgpr_read_b32 v119, a23
    v_accvgpr_read_b32 v120, a24
    v_accvgpr_read_b32 v121, a25
    v_accvgpr_read_b32 v122, a26
    v_accvgpr_read_b32 v123, a27
    v_accvgpr_read_b32 v124, a28
    v_accvgpr_read_b32 v125, a29
    v_accvgpr_read_b32 v126, a30
    v_accvgpr_read_b32 v127, a31
    v_pk_mul_f32 v[96:97], v[96:97], s[30:31]
    v_pk_mul_f32 v[98:99], v[98:99], s[30:31]
    v_pk_mul_f32 v[100:101], v[100:101], s[30:31]
    v_pk_mul_f32 v[102:103], v[102:103], s[30:31]
    v_pk_mul_f32 v[104:105], v[104:105], s[30:31]
    v_pk_mul_f32 v[106:107], v[106:107], s[30:31]
    v_pk_mul_f32 v[108:109], v[108:109], s[30:31]
    v_pk_mul_f32 v[110:111], v[110:111], s[30:31]
    v_pk_mul_f32 v[112:113], v[112:113], s[30:31]
    v_pk_mul_f32 v[114:115], v[114:115], s[30:31]
    v_pk_mul_f32 v[116:117], v[116:117], s[30:31]
    v_pk_mul_f32 v[118:119], v[118:119], s[30:31]
    v_pk_mul_f32 v[120:121], v[120:121], s[30:31]
    v_pk_mul_f32 v[122:123], v[122:123], s[30:31]
    v_pk_mul_f32 v[124:125], v[124:125], s[30:31]
    v_pk_mul_f32 v[126:127], v[126:127], s[30:31]
    v_cvt_pk_bf16_f32 v32, v96, v97
    v_cvt_pk_bf16_f32 v33, v98, v99
    v_cvt_pk_bf16_f32 v34, v112, v113
    v_cvt_pk_bf16_f32 v35, v114, v115
    v_cvt_pk_bf16_f32 v48, v100, v101
    v_cvt_pk_bf16_f32 v49, v102, v103
    v_cvt_pk_bf16_f32 v50, v116, v117
    v_cvt_pk_bf16_f32 v51, v118, v119
    v_cvt_pk_bf16_f32 v64, v104, v105
    v_cvt_pk_bf16_f32 v65, v106, v107
    v_cvt_pk_bf16_f32 v66, v120, v121
    v_cvt_pk_bf16_f32 v67, v122, v123
    v_cvt_pk_bf16_f32 v80, v108, v109
    v_cvt_pk_bf16_f32 v81, v110, v111
    v_cvt_pk_bf16_f32 v82, v124, v125
    v_cvt_pk_bf16_f32 v83, v126, v127
    v_accvgpr_read_b32 v128, a32
    v_accvgpr_read_b32 v129, a33
    v_accvgpr_read_b32 v130, a34
    v_accvgpr_read_b32 v131, a35
    v_accvgpr_read_b32 v132, a36
    v_accvgpr_read_b32 v133, a37
    v_accvgpr_read_b32 v134, a38
    v_accvgpr_read_b32 v135, a39
    v_accvgpr_read_b32 v136, a40
    v_accvgpr_read_b32 v137, a41
    v_accvgpr_read_b32 v138, a42
    v_accvgpr_read_b32 v139, a43
    v_accvgpr_read_b32 v140, a44
    v_accvgpr_read_b32 v141, a45
    v_accvgpr_read_b32 v142, a46
    v_accvgpr_read_b32 v143, a47
    v_accvgpr_read_b32 v144, a48
    v_accvgpr_read_b32 v145, a49
    v_accvgpr_read_b32 v146, a50
    v_accvgpr_read_b32 v147, a51
    v_accvgpr_read_b32 v148, a52
    v_accvgpr_read_b32 v149, a53
    v_accvgpr_read_b32 v150, a54
    v_accvgpr_read_b32 v151, a55
    v_accvgpr_read_b32 v152, a56
    v_accvgpr_read_b32 v153, a57
    v_accvgpr_read_b32 v154, a58
    v_accvgpr_read_b32 v155, a59
    v_accvgpr_read_b32 v156, a60
    v_accvgpr_read_b32 v157, a61
    v_accvgpr_read_b32 v158, a62
    v_accvgpr_read_b32 v159, a63
    v_pk_mul_f32 v[128:129], v[128:129], s[30:31]
    v_pk_mul_f32 v[130:131], v[130:131], s[30:31]
    v_pk_mul_f32 v[132:133], v[132:133], s[30:31]
    v_pk_mul_f32 v[134:135], v[134:135], s[30:31]
    v_pk_mul_f32 v[136:137], v[136:137], s[30:31]
    v_pk_mul_f32 v[138:139], v[138:139], s[30:31]
    v_pk_mul_f32 v[140:141], v[140:141], s[30:31]
    v_pk_mul_f32 v[142:143], v[142:143], s[30:31]
    v_pk_mul_f32 v[144:145], v[144:145], s[30:31]
    v_pk_mul_f32 v[146:147], v[146:147], s[30:31]
    v_pk_mul_f32 v[148:149], v[148:149], s[30:31]
    v_pk_mul_f32 v[150:151], v[150:151], s[30:31]
    v_pk_mul_f32 v[152:153], v[152:153], s[30:31]
    v_pk_mul_f32 v[154:155], v[154:155], s[30:31]
    v_pk_mul_f32 v[156:157], v[156:157], s[30:31]
    v_pk_mul_f32 v[158:159], v[158:159], s[30:31]
    v_cvt_pk_bf16_f32 v36, v128, v129
    v_cvt_pk_bf16_f32 v37, v130, v131
    v_cvt_pk_bf16_f32 v38, v144, v145
    v_cvt_pk_bf16_f32 v39, v146, v147
    v_cvt_pk_bf16_f32 v52, v132, v133
    v_cvt_pk_bf16_f32 v53, v134, v135
    v_cvt_pk_bf16_f32 v54, v148, v149
    v_cvt_pk_bf16_f32 v55, v150, v151
    v_cvt_pk_bf16_f32 v68, v136, v137
    v_cvt_pk_bf16_f32 v69, v138, v139
    v_cvt_pk_bf16_f32 v70, v152, v153
    v_cvt_pk_bf16_f32 v71, v154, v155
    v_cvt_pk_bf16_f32 v84, v140, v141
    v_cvt_pk_bf16_f32 v85, v142, v143
    v_cvt_pk_bf16_f32 v86, v156, v157
    v_cvt_pk_bf16_f32 v87, v158, v159
    v_accvgpr_read_b32 v96, a64
    v_accvgpr_read_b32 v97, a65
    v_accvgpr_read_b32 v98, a66
    v_accvgpr_read_b32 v99, a67
    v_accvgpr_read_b32 v100, a68
    v_accvgpr_read_b32 v101, a69
    v_accvgpr_read_b32 v102, a70
    v_accvgpr_read_b32 v103, a71
    v_accvgpr_read_b32 v104, a72
    v_accvgpr_read_b32 v105, a73
    v_accvgpr_read_b32 v106, a74
    v_accvgpr_read_b32 v107, a75
    v_accvgpr_read_b32 v108, a76
    v_accvgpr_read_b32 v109, a77
    v_accvgpr_read_b32 v110, a78
    v_accvgpr_read_b32 v111, a79
    v_accvgpr_read_b32 v112, a80
    v_accvgpr_read_b32 v113, a81
    v_accvgpr_read_b32 v114, a82
    v_accvgpr_read_b32 v115, a83
    v_accvgpr_read_b32 v116, a84
    v_accvgpr_read_b32 v117, a85
    v_accvgpr_read_b32 v118, a86
    v_accvgpr_read_b32 v119, a87
    v_accvgpr_read_b32 v120, a88
    v_accvgpr_read_b32 v121, a89
    v_accvgpr_read_b32 v122, a90
    v_accvgpr_read_b32 v123, a91
    v_accvgpr_read_b32 v124, a92
    v_accvgpr_read_b32 v125, a93
    v_accvgpr_read_b32 v126, a94
    v_accvgpr_read_b32 v127, a95
    v_pk_mul_f32 v[96:97], v[96:97], s[30:31]
    v_pk_mul_f32 v[98:99], v[98:99], s[30:31]
    v_pk_mul_f32 v[100:101], v[100:101], s[30:31]
    v_pk_mul_f32 v[102:103], v[102:103], s[30:31]
    v_pk_mul_f32 v[104:105], v[104:105], s[30:31]
    v_pk_mul_f32 v[106:107], v[106:107], s[30:31]
    v_pk_mul_f32 v[108:109], v[108:109], s[30:31]
    v_pk_mul_f32 v[110:111], v[110:111], s[30:31]
    v_pk_mul_f32 v[112:113], v[112:113], s[30:31]
    v_pk_mul_f32 v[114:115], v[114:115], s[30:31]
    v_pk_mul_f32 v[116:117], v[116:117], s[30:31]
    v_pk_mul_f32 v[118:119], v[118:119], s[30:31]
    v_pk_mul_f32 v[120:121], v[120:121], s[30:31]
    v_pk_mul_f32 v[122:123], v[122:123], s[30:31]
    v_pk_mul_f32 v[124:125], v[124:125], s[30:31]
    v_pk_mul_f32 v[126:127], v[126:127], s[30:31]
    v_cvt_pk_bf16_f32 v40, v96, v97
    v_cvt_pk_bf16_f32 v41, v98, v99
    v_cvt_pk_bf16_f32 v42, v112, v113
    v_cvt_pk_bf16_f32 v43, v114, v115
    v_cvt_pk_bf16_f32 v56, v100, v101
    v_cvt_pk_bf16_f32 v57, v102, v103
    v_cvt_pk_bf16_f32 v58, v116, v117
    v_cvt_pk_bf16_f32 v59, v118, v119
    v_cvt_pk_bf16_f32 v72, v104, v105
    v_cvt_pk_bf16_f32 v73, v106, v107
    v_cvt_pk_bf16_f32 v74, v120, v121
    v_cvt_pk_bf16_f32 v75, v122, v123
    v_cvt_pk_bf16_f32 v88, v108, v109
    v_cvt_pk_bf16_f32 v89, v110, v111
    v_cvt_pk_bf16_f32 v90, v124, v125
    v_cvt_pk_bf16_f32 v91, v126, v127
    v_accvgpr_read_b32 v128, a96
    v_accvgpr_read_b32 v129, a97
    v_accvgpr_read_b32 v130, a98
    v_accvgpr_read_b32 v131, a99
    v_accvgpr_read_b32 v132, a100
    v_accvgpr_read_b32 v133, a101
    v_accvgpr_read_b32 v134, a102
    v_accvgpr_read_b32 v135, a103
    v_accvgpr_read_b32 v136, a104
    v_accvgpr_read_b32 v137, a105
    v_accvgpr_read_b32 v138, a106
    v_accvgpr_read_b32 v139, a107
    v_accvgpr_read_b32 v140, a108
    v_accvgpr_read_b32 v141, a109
    v_accvgpr_read_b32 v142, a110
    v_accvgpr_read_b32 v143, a111
    v_accvgpr_read_b32 v144, a112
    v_accvgpr_read_b32 v145, a113
    v_accvgpr_read_b32 v146, a114
    v_accvgpr_read_b32 v147, a115
    v_accvgpr_read_b32 v148, a116
    v_accvgpr_read_b32 v149, a117
    v_accvgpr_read_b32 v150, a118
    v_accvgpr_read_b32 v151, a119
    v_accvgpr_read_b32 v152, a120
    v_accvgpr_read_b32 v153, a121
    v_accvgpr_read_b32 v154, a122
    v_accvgpr_read_b32 v155, a123
    v_accvgpr_read_b32 v156, a124
    v_accvgpr_read_b32 v157, a125
    v_accvgpr_read_b32 v158, a126
    v_accvgpr_read_b32 v159, a127
    v_pk_mul_f32 v[128:129], v[128:129], s[30:31]
    v_pk_mul_f32 v[130:131], v[130:131], s[30:31]
    v_pk_mul_f32 v[132:133], v[132:133], s[30:31]
    v_pk_mul_f32 v[134:135], v[134:135], s[30:31]
    v_pk_mul_f32 v[136:137], v[136:137], s[30:31]
    v_pk_mul_f32 v[138:139], v[138:139], s[30:31]
    v_pk_mul_f32 v[140:141], v[140:141], s[30:31]
    v_pk_mul_f32 v[142:143], v[142:143], s[30:31]
    v_pk_mul_f32 v[144:145], v[144:145], s[30:31]
    v_pk_mul_f32 v[146:147], v[146:147], s[30:31]
    v_pk_mul_f32 v[148:149], v[148:149], s[30:31]
    v_pk_mul_f32 v[150:151], v[150:151], s[30:31]
    v_pk_mul_f32 v[152:153], v[152:153], s[30:31]
    v_pk_mul_f32 v[154:155], v[154:155], s[30:31]
    v_pk_mul_f32 v[156:157], v[156:157], s[30:31]
    v_pk_mul_f32 v[158:159], v[158:159], s[30:31]
    v_cvt_pk_bf16_f32 v44, v128, v129
    v_cvt_pk_bf16_f32 v45, v130, v131
    v_cvt_pk_bf16_f32 v46, v144, v145
    v_cvt_pk_bf16_f32 v47, v146, v147
    v_cvt_pk_bf16_f32 v60, v132, v133
    v_cvt_pk_bf16_f32 v61, v134, v135
    v_cvt_pk_bf16_f32 v62, v148, v149
    v_cvt_pk_bf16_f32 v63, v150, v151
    v_cvt_pk_bf16_f32 v76, v136, v137
    v_cvt_pk_bf16_f32 v77, v138, v139
    v_cvt_pk_bf16_f32 v78, v152, v153
    v_cvt_pk_bf16_f32 v79, v154, v155
    v_cvt_pk_bf16_f32 v92, v140, v141
    v_cvt_pk_bf16_f32 v93, v142, v143
    v_cvt_pk_bf16_f32 v94, v156, v157
    v_cvt_pk_bf16_f32 v95, v158, v159
    s_lshl_b32 s3, s33, 7
    s_lshl_b32 s29, s21, 2
    s_add_u32 s3, s3, s29
    s_lshl_b32 s3, s3, 10
    s_sub_u32 s32, 16777216, s3
    s_add_u32 s36, s34, 20971520
    s_addc_u32 s37, s35, 0
    s_add_u32 s36, s36, s3
    s_addc_u32 s37, s37, 0
    s_and_b32 s37, s37, 0xffff
    s_mov_b32 s38, s32
    s_mov_b32 s39, 0x20000
    s_mov_b32 s93, 0
    s_mov_b32 s94, 131072
    s_mov_b32 s95, 262144
    s_mov_b32 s96, 393216
    s_barrier
    ds_read_b128 a[192:195], v216 offset:0
    ds_read_b128 a[196:199], v217 offset:0
    ds_read_b128 a[200:203], v218 offset:0
    ds_read_b128 a[204:207], v219 offset:0
    ds_read_b128 a[208:211], v216 offset:4096
    ds_read_b128 a[212:215], v217 offset:4096
    ds_read_b128 a[216:219], v218 offset:4096
    ds_read_b128 a[220:223], v219 offset:4096
    v_accvgpr_write_b32 a0, 0
    v_accvgpr_write_b32 a1, 0
    v_accvgpr_write_b32 a2, 0
    v_accvgpr_write_b32 a3, 0
    v_accvgpr_write_b32 a4, 0
    v_accvgpr_write_b32 a5, 0
    v_accvgpr_write_b32 a6, 0
    v_accvgpr_write_b32 a7, 0
    v_accvgpr_write_b32 a8, 0
    v_accvgpr_write_b32 a9, 0
    v_accvgpr_write_b32 a10, 0
    v_accvgpr_write_b32 a11, 0
    v_accvgpr_write_b32 a12, 0
    v_accvgpr_write_b32 a13, 0
    v_accvgpr_write_b32 a14, 0
    v_accvgpr_write_b32 a15, 0
    v_accvgpr_write_b32 a16, 0
    v_accvgpr_write_b32 a17, 0
    v_accvgpr_write_b32 a18, 0
    v_accvgpr_write_b32 a19, 0
    v_accvgpr_write_b32 a20, 0
    v_accvgpr_write_b32 a21, 0
    v_accvgpr_write_b32 a22, 0
    v_accvgpr_write_b32 a23, 0
    v_accvgpr_write_b32 a24, 0
    v_accvgpr_write_b32 a25, 0
    v_accvgpr_write_b32 a26, 0
    v_accvgpr_write_b32 a27, 0
    v_accvgpr_write_b32 a28, 0
    v_accvgpr_write_b32 a29, 0
    v_accvgpr_write_b32 a30, 0
    v_accvgpr_write_b32 a31, 0
    v_mov_b32 v208, 0
    v_mov_b32 v209, 0
    v_mov_b32 v210, 0
    v_mov_b32 v211, 0
    v_mov_b32 v7, 0x3f803f80
    v_accvgpr_write_b32 a128, 0
    v_accvgpr_write_b32 a129, 0
    v_accvgpr_write_b32 a130, 0
    v_accvgpr_write_b32 a131, 0
    v_accvgpr_write_b32 a132, 0
    v_accvgpr_write_b32 a133, 0
    v_accvgpr_write_b32 a134, 0
    v_accvgpr_write_b32 a135, 0
    v_accvgpr_write_b32 a136, 0
    v_accvgpr_write_b32 a137, 0
    v_accvgpr_write_b32 a138, 0
    v_accvgpr_write_b32 a139, 0
    v_accvgpr_write_b32 a140, 0
    v_accvgpr_write_b32 a141, 0
    v_accvgpr_write_b32 a142, 0
    v_accvgpr_write_b32 a143, 0
    v_accvgpr_write_b32 a144, v7
    v_accvgpr_write_b32 a145, v7
    v_accvgpr_write_b32 a146, v7
    v_accvgpr_write_b32 a147, v7
    s_waitcnt lgkmcnt(0)
    v_mfma_f32_16x16x32_bf16 v[96:99], a[192:195], v[32:35], 0
    v_accvgpr_write_b32 a32, 0
    v_accvgpr_write_b32 a33, 0
    v_accvgpr_write_b32 a34, 0
    v_mfma_f32_16x16x32_bf16 v[100:103], a[192:195], v[48:51], 0
    v_accvgpr_write_b32 a35, 0
    v_accvgpr_write_b32 a36, 0
    v_accvgpr_write_b32 a37, 0
    v_mfma_f32_16x16x32_bf16 v[104:107], a[192:195], v[64:67], 0
    v_accvgpr_write_b32 a38, 0
    v_accvgpr_write_b32 a39, 0
    v_accvgpr_write_b32 a40, 0
    v_mfma_f32_16x16x32_bf16 v[108:111], a[192:195], v[80:83], 0
    ds_read_b128 a[192:195], v216 offset:8192
    v_accvgpr_write_b32 a41, 0
    v_accvgpr_write_b32 a42, 0
    v_accvgpr_write_b32 a43, 0
    v_mfma_f32_16x16x32_bf16 v[96:99], a[196:199], v[36:39], v[96:99]
    v_accvgpr_write_b32 a44, 0
    v_accvgpr_write_b32 a45, 0
    v_accvgpr_write_b32 a46, 0
    v_mfma_f32_16x16x32_bf16 v[100:103], a[196:199], v[52:55], v[100:103]
    v_accvgpr_write_b32 a47, 0
    v_accvgpr_write_b32 a48, 0
    v_accvgpr_write_b32 a49, 0
    v_mfma_f32_16x16x32_bf16 v[104:107], a[196:199], v[68:71], v[104:107]
    v_accvgpr_write_b32 a50, 0
    v_accvgpr_write_b32 a51, 0
    v_accvgpr_write_b32 a52, 0
    v_mfma_f32_16x16x32_bf16 v[108:111], a[196:199], v[84:87], v[108:111]
    ds_read_b128 a[196:199], v217 offset:8192
    v_accvgpr_write_b32 a53, 0
    v_accvgpr_write_b32 a54, 0
    v_accvgpr_write_b32 a55, 0
    v_mfma_f32_16x16x32_bf16 v[96:99], a[200:203], v[40:43], v[96:99]
    v_accvgpr_write_b32 a56, 0
    v_accvgpr_write_b32 a57, 0
    v_accvgpr_write_b32 a58, 0
    v_mfma_f32_16x16x32_bf16 v[100:103], a[200:203], v[56:59], v[100:103]
    v_accvgpr_write_b32 a59, 0
    v_accvgpr_write_b32 a60, 0
    v_accvgpr_write_b32 a61, 0
    v_mfma_f32_16x16x32_bf16 v[104:107], a[200:203], v[72:75], v[104:107]
    v_accvgpr_write_b32 a62, 0
    v_accvgpr_write_b32 a63, 0
    v_accvgpr_write_b32 a64, 0
    v_mfma_f32_16x16x32_bf16 v[108:111], a[200:203], v[88:91], v[108:111]
    ds_read_b128 a[200:203], v218 offset:8192
    v_accvgpr_write_b32 a65, 0
    v_accvgpr_write_b32 a66, 0
    v_accvgpr_write_b32 a67, 0
    v_mfma_f32_16x16x32_bf16 v[96:99], a[204:207], v[44:47], v[96:99]
    v_accvgpr_write_b32 a68, 0
    v_accvgpr_write_b32 a69, 0
    v_accvgpr_write_b32 a70, 0
    v_mfma_f32_16x16x32_bf16 v[100:103], a[204:207], v[60:63], v[100:103]
    v_accvgpr_write_b32 a71, 0
    v_accvgpr_write_b32 a72, 0
    v_accvgpr_write_b32 a73, 0
    v_mfma_f32_16x16x32_bf16 v[104:107], a[204:207], v[76:79], v[104:107]
    v_accvgpr_write_b32 a74, 0
    v_accvgpr_write_b32 a75, 0
    v_accvgpr_write_b32 a76, 0
    v_mfma_f32_16x16x32_bf16 v[108:111], a[204:207], v[92:95], v[108:111]
    ds_read_b128 a[204:207], v219 offset:8192
    v_accvgpr_write_b32 a77, 0
    v_accvgpr_write_b32 a78, 0
    v_accvgpr_write_b32 a79, 0
    v_mfma_f32_16x16x32_bf16 v[112:115], a[208:211], v[32:35], 0
    v_accvgpr_write_b32 a80, 0
    v_accvgpr_write_b32 a81, 0
    v_accvgpr_write_b32 a82, 0
    v_mfma_f32_16x16x32_bf16 v[116:119], a[208:211], v[48:51], 0
    v_accvgpr_write_b32 a83, 0
    v_accvgpr_write_b32 a84, 0
    v_accvgpr_write_b32 a85, 0
    v_mfma_f32_16x16x32_bf16 v[120:123], a[208:211], v[64:67], 0
    v_accvgpr_write_b32 a86, 0
    v_accvgpr_write_b32 a87, 0
    v_accvgpr_write_b32 a88, 0
    v_mfma_f32_16x16x32_bf16 v[124:127], a[208:211], v[80:83], 0
    ds_read_b128 a[208:211], v216 offset:12288
    v_accvgpr_write_b32 a89, 0
    v_accvgpr_write_b32 a90, 0
    v_accvgpr_write_b32 a91, 0
    v_mfma_f32_16x16x32_bf16 v[112:115], a[212:215], v[36:39], v[112:115]
    v_accvgpr_write_b32 a92, 0
    v_accvgpr_write_b32 a93, 0
    v_accvgpr_write_b32 a94, 0
    v_mfma_f32_16x16x32_bf16 v[116:119], a[212:215], v[52:55], v[116:119]
    v_accvgpr_write_b32 a95, 0
    v_accvgpr_write_b32 a96, 0
    v_accvgpr_write_b32 a97, 0
    v_mfma_f32_16x16x32_bf16 v[120:123], a[212:215], v[68:71], v[120:123]
    v_accvgpr_write_b32 a98, 0
    v_accvgpr_write_b32 a99, 0
    v_accvgpr_write_b32 a100, 0
    v_mfma_f32_16x16x32_bf16 v[124:127], a[212:215], v[84:87], v[124:127]
    ds_read_b128 a[212:215], v217 offset:12288
    v_accvgpr_write_b32 a101, 0
    v_accvgpr_write_b32 a102, 0
    v_accvgpr_write_b32 a103, 0
    v_mfma_f32_16x16x32_bf16 v[112:115], a[216:219], v[40:43], v[112:115]
    v_accvgpr_write_b32 a104, 0
    v_accvgpr_write_b32 a105, 0
    v_accvgpr_write_b32 a106, 0
    v_mfma_f32_16x16x32_bf16 v[116:119], a[216:219], v[56:59], v[116:119]
    v_accvgpr_write_b32 a107, 0
    v_accvgpr_write_b32 a108, 0
    v_accvgpr_write_b32 a109, 0
    v_mfma_f32_16x16x32_bf16 v[120:123], a[216:219], v[72:75], v[120:123]
    v_accvgpr_write_b32 a110, 0
    v_accvgpr_write_b32 a111, 0
    v_accvgpr_write_b32 a112, 0
    v_mfma_f32_16x16x32_bf16 v[124:127], a[216:219], v[88:91], v[124:127]
    ds_read_b128 a[216:219], v218 offset:12288
    v_accvgpr_write_b32 a113, 0
    v_accvgpr_write_b32 a114, 0
    v_accvgpr_write_b32 a115, 0
    v_mfma_f32_16x16x32_bf16 v[112:115], a[220:223], v[44:47], v[112:115]
    v_accvgpr_write_b32 a116, 0
    v_accvgpr_write_b32 a117, 0
    v_accvgpr_write_b32 a118, 0
    v_mfma_f32_16x16x32_bf16 v[116:119], a[220:223], v[60:63], v[116:119]
    v_accvgpr_write_b32 a119, 0
    v_accvgpr_write_b32 a120, 0
    v_accvgpr_write_b32 a121, 0
    v_mfma_f32_16x16x32_bf16 v[120:123], a[220:223], v[76:79], v[120:123]
    v_accvgpr_write_b32 a122, 0
    v_accvgpr_write_b32 a123, 0
    v_accvgpr_write_b32 a124, 0
    v_mfma_f32_16x16x32_bf16 v[124:127], a[220:223], v[92:95], v[124:127]
    ds_read_b128 a[220:223], v219 offset:12288
    v_accvgpr_write_b32 a125, 0
    v_accvgpr_write_b32 a126, 0
    v_accvgpr_write_b32 a127, 0
    s_nop 7
    v_max3_f32 v212, v96, v97, v98
    v_max3_f32 v213, v100, v101, v102
    v_max3_f32 v214, v104, v105, v106
    v_max3_f32 v215, v108, v109, v110
    v_max3_f32 v212, v99, v112, v212
    v_max3_f32 v213, v103, v116, v213
    v_max3_f32 v214, v107, v120, v214
    v_max3_f32 v215, v111, v124, v215
    v_max3_f32 v212, v113, v114, v212
    v_max3_f32 v213, v117, v118, v213
    v_max3_f32 v214, v121, v122, v214
    v_max3_f32 v215, v125, v126, v215
    v_max_f32 v212, v115, v212
    v_max_f32 v213, v119, v213
    v_max_f32 v214, v123, v214
    v_max_f32 v215, v127, v215
    v_mov_b32 v234, v212
    v_mov_b32 v235, v213
    v_mov_b32 v236, v214
    v_mov_b32 v237, v215
    s_nop 1
    v_permlane16_swap_b32 v212, v234
    v_permlane16_swap_b32 v213, v235
    v_permlane16_swap_b32 v214, v236
    v_permlane16_swap_b32 v215, v237
    s_nop 1
    v_max_f32 v212, v212, v234
    v_max_f32 v213, v213, v235
    v_max_f32 v214, v214, v236
    v_max_f32 v215, v215, v237
    v_mov_b32 v234, v212
    v_mov_b32 v235, v213
    v_mov_b32 v236, v214
    v_mov_b32 v237, v215
    s_nop 1
    v_permlane32_swap_b32 v212, v234
    v_permlane32_swap_b32 v213, v235
    v_permlane32_swap_b32 v214, v236
    v_permlane32_swap_b32 v215, v237
    s_nop 1
    v_max_f32 v212, v212, v234
    v_max_f32 v213, v213, v235
    v_max_f32 v214, v214, v236
    v_max_f32 v215, v215, v237
    v_sub_f32 v212, 0xc2c00000, v212
    v_sub_f32 v213, 0xc2c00000, v213
    v_sub_f32 v214, 0xc2c00000, v214
    v_sub_f32 v215, 0xc2c00000, v215
    v_mov_b32 v192, v212
    v_mov_b32 v193, v212
    v_mov_b32 v194, v212
    v_mov_b32 v195, v212
    v_mov_b32 v196, v213
    v_mov_b32 v197, v213
    v_mov_b32 v198, v213
    v_mov_b32 v199, v213
    v_mov_b32 v200, v214
    v_mov_b32 v201, v214
    v_mov_b32 v202, v214
    v_mov_b32 v203, v214
    v_mov_b32 v204, v215
    v_mov_b32 v205, v215
    v_mov_b32 v206, v215
    v_mov_b32 v207, v215
    v_add_f32 v96, v96, v212
    v_add_f32 v97, v97, v212
    v_add_f32 v98, v98, v212
    v_add_f32 v99, v99, v212
    v_add_f32 v100, v100, v213
    v_add_f32 v101, v101, v213
    v_add_f32 v102, v102, v213
    v_add_f32 v103, v103, v213
    v_add_f32 v104, v104, v214
    v_add_f32 v105, v105, v214
    v_add_f32 v106, v106, v214
    v_add_f32 v107, v107, v214
    v_add_f32 v108, v108, v215
    v_add_f32 v109, v109, v215
    v_add_f32 v110, v110, v215
    v_add_f32 v111, v111, v215
    v_add_f32 v112, v112, v212
    v_add_f32 v113, v113, v212
    v_add_f32 v114, v114, v212
    v_add_f32 v115, v115, v212
    v_add_f32 v116, v116, v213
    v_add_f32 v117, v117, v213
    v_add_f32 v118, v118, v213
    v_add_f32 v119, v119, v213
    v_add_f32 v120, v120, v214
    v_add_f32 v121, v121, v214
    v_add_f32 v122, v122, v214
    v_add_f32 v123, v123, v214
    v_add_f32 v124, v124, v215
    v_add_f32 v125, v125, v215
    v_add_f32 v126, v126, v215
    v_add_f32 v127, v127, v215
    s_waitcnt lgkmcnt(0)
    v_mfma_f32_16x16x32_bf16 v[128:131], a[192:195], v[32:35], v[192:195]
    v_exp_f32 v96, v96
    v_mfma_f32_16x16x32_bf16 v[132:135], a[192:195], v[48:51], v[196:199]
    v_exp_f32 v97, v97
    v_mfma_f32_16x16x32_bf16 v[136:139], a[192:195], v[64:67], v[200:203]
    v_cvt_pk_bf16_f32 v160, v96, v97
    v_exp_f32 v98, v98
    v_mfma_f32_16x16x32_bf16 v[140:143], a[192:195], v[80:83], v[204:207]
    ds_read_b128 a[192:195], v216 offset:16384
    v_exp_f32 v99, v99
    v_mfma_f32_16x16x32_bf16 v[128:131], a[196:199], v[36:39], v[128:131]
    v_cvt_pk_bf16_f32 v161, v98, v99
    v_exp_f32 v100, v100
    v_mfma_f32_16x16x32_bf16 v[132:135], a[196:199], v[52:55], v[132:135]
    v_exp_f32 v101, v101
    v_mfma_f32_16x16x32_bf16 v[136:139], a[196:199], v[68:71], v[136:139]
    v_cvt_pk_bf16_f32 v164, v100, v101
    v_exp_f32 v102, v102
    v_mfma_f32_16x16x32_bf16 v[140:143], a[196:199], v[84:87], v[140:143]
    ds_read_b128 a[196:199], v217 offset:16384
    v_exp_f32 v103, v103
    v_mfma_f32_16x16x32_bf16 v[128:131], a[200:203], v[40:43], v[128:131]
    v_cvt_pk_bf16_f32 v165, v102, v103
    v_exp_f32 v104, v104
    v_mfma_f32_16x16x32_bf16 v[132:135], a[200:203], v[56:59], v[132:135]
    v_exp_f32 v105, v105
    v_mfma_f32_16x16x32_bf16 v[136:139], a[200:203], v[72:75], v[136:139]
    v_cvt_pk_bf16_f32 v168, v104, v105
    v_exp_f32 v106, v106
    v_mfma_f32_16x16x32_bf16 v[140:143], a[200:203], v[88:91], v[140:143]
    ds_read_b128 a[200:203], v218 offset:16384
    v_exp_f32 v107, v107
    v_mfma_f32_16x16x32_bf16 v[128:131], a[204:207], v[44:47], v[128:131]
    v_cvt_pk_bf16_f32 v169, v106, v107
    v_exp_f32 v108, v108
    v_mfma_f32_16x16x32_bf16 v[132:135], a[204:207], v[60:63], v[132:135]
    v_exp_f32 v109, v109
    v_mfma_f32_16x16x32_bf16 v[136:139], a[204:207], v[76:79], v[136:139]
    v_cvt_pk_bf16_f32 v172, v108, v109
    v_exp_f32 v110, v110
    v_mfma_f32_16x16x32_bf16 v[140:143], a[204:207], v[92:95], v[140:143]
    ds_read_b128 a[204:207], v219 offset:16384
    v_exp_f32 v111, v111
    v_mfma_f32_16x16x32_bf16 v[144:147], a[208:211], v[32:35], v[192:195]
    v_cvt_pk_bf16_f32 v173, v110, v111
    v_exp_f32 v112, v112
    v_mfma_f32_16x16x32_bf16 v[148:151], a[208:211], v[48:51], v[196:199]
    v_exp_f32 v113, v113
    v_mfma_f32_16x16x32_bf16 v[152:155], a[208:211], v[64:67], v[200:203]
    v_cvt_pk_bf16_f32 v162, v112, v113
    v_exp_f32 v114, v114
    v_mfma_f32_16x16x32_bf16 v[156:159], a[208:211], v[80:83], v[204:207]
    ds_read_b128 a[208:211], v216 offset:20480
    v_exp_f32 v115, v115
    v_mfma_f32_16x16x32_bf16 v[144:147], a[212:215], v[36:39], v[144:147]
    v_cvt_pk_bf16_f32 v163, v114, v115
    v_exp_f32 v116, v116
    v_mfma_f32_16x16x32_bf16 v[148:151], a[212:215], v[52:55], v[148:151]
    v_exp_f32 v117, v117
    v_mfma_f32_16x16x32_bf16 v[152:155], a[212:215], v[68:71], v[152:155]
    v_cvt_pk_bf16_f32 v166, v116, v117
    v_exp_f32 v118, v118
    v_mfma_f32_16x16x32_bf16 v[156:159], a[212:215], v[84:87], v[156:159]
    ds_read_b128 a[212:215], v217 offset:20480
    v_exp_f32 v119, v119
    v_mfma_f32_16x16x32_bf16 v[144:147], a[216:219], v[40:43], v[144:147]
    v_cvt_pk_bf16_f32 v167, v118, v119
    v_exp_f32 v120, v120
    v_mfma_f32_16x16x32_bf16 v[148:151], a[216:219], v[56:59], v[148:151]
    v_exp_f32 v121, v121
    v_mfma_f32_16x16x32_bf16 v[152:155], a[216:219], v[72:75], v[152:155]
    v_cvt_pk_bf16_f32 v170, v120, v121
    v_exp_f32 v122, v122
    v_mfma_f32_16x16x32_bf16 v[156:159], a[216:219], v[88:91], v[156:159]
    ds_read_b128 a[216:219], v218 offset:20480
    v_exp_f32 v123, v123
    v_mfma_f32_16x16x32_bf16 v[144:147], a[220:223], v[44:47], v[144:147]
    v_cvt_pk_bf16_f32 v171, v122, v123
    v_exp_f32 v124, v124
    v_mfma_f32_16x16x32_bf16 v[148:151], a[220:223], v[60:63], v[148:151]
    v_exp_f32 v125, v125
    v_mfma_f32_16x16x32_bf16 v[152:155], a[220:223], v[76:79], v[152:155]
    v_cvt_pk_bf16_f32 v174, v124, v125
    v_exp_f32 v126, v126
    v_mfma_f32_16x16x32_bf16 v[156:159], a[220:223], v[92:95], v[156:159]
    ds_read_b128 a[220:223], v219 offset:20480
    v_exp_f32 v127, v127
    s_mov_b32 s28, 0
    s_waitcnt vmcnt(0)
    s_barrier
    s_cmp_eq_u32 s20, 0
    s_cbranch_scc0 k_h_pub
    v_mov_b32 v7, s101
    v_mov_b32 v8, s100
    s_mov_b64 exec, 1
    global_store_dword v7, v8, s[98:99] offset:128 sc1
    s_mov_b64 exec, -1
k_h_pub:
    s_load_dwordx2 s[44:45], s[0:1], 72
    s_lshr_b32 s3, s2, 3
    s_add_u32 s3, s3, s20
    s_cmp_eq_u32 s3, 0
    s_cselect_b32 s48, 5, 99
    s_and_b32 s3, s2, 7
    s_lshl_b32 s3, s3, 2
    s_add_u32 s3, s3, 32
    v_mov_b32 v252, s3
    v_mov_b32 v253, 0
    v_mov_b32 v254, 1
    v_mov_b32 v255, -1
    v_mov_b32 v238, 0
    s_waitcnt lgkmcnt(0)
k_attn_loop:
    s_cmp_ge_u32 s28, s48
    s_cbranch_scc1 k_rank
k_rank_done:
    v_mfma_f32_16x16x32_bf16 v[96:99], a[192:195], v[32:35], v[192:195]
    ds_read_b64_tr_b16 a[224:225], v220 offset:0
    v_cvt_pk_bf16_f32 v175, v126, v127
    v_mfma_f32_16x16x32_bf16 v[100:103], a[192:195], v[48:51], v[196:199]
    v_exp_f32 v128, v128
    v_mfma_f32_16x16x32_bf16 v[104:107], a[192:195], v[64:67], v[200:203]
    ds_read_b64_tr_b16 a[226:227], v220 offset:4096
    v_mfma_f32_16x16x32_bf16 v[108:111], a[192:195], v[80:83], v[204:207]
    v_exp_f32 v129, v129
    v_mfma_f32_16x16x32_bf16 v[96:99], a[196:199], v[36:39], v[96:99]
    ds_read_b64_tr_b16 a[228:229], v221 offset:0
    v_cvt_pk_bf16_f32 v176, v128, v129
    v_mfma_f32_16x16x32_bf16 v[100:103], a[196:199], v[52:55], v[100:103]
    v_exp_f32 v130, v130
    v_mfma_f32_16x16x32_bf16 v[104:107], a[196:199], v[68:71], v[104:107]
    ds_read_b64_tr_b16 a[230:231], v221 offset:4096
    v_mfma_f32_16x16x32_bf16 v[108:111], a[196:199], v[84:87], v[108:111]
    v_exp_f32 v131, v131
    v_mfma_f32_16x16x32_bf16 v[96:99], a[200:203], v[40:43], v[96:99]
    ds_read_b64_tr_b16 a[232:233], v222 offset:0
    v_cvt_pk_bf16_f32 v177, v130, v131
    v_mfma_f32_16x16x32_bf16 v[100:103], a[200:203], v[56:59], v[100:103]
    v_exp_f32 v132, v132
    v_mfma_f32_16x16x32_bf16 v[104:107], a[200:203], v[72:75], v[104:107]
    ds_read_b64_tr_b16 a[234:235], v222 offset:4096
    v_mfma_f32_16x16x32_bf16 v[108:111], a[200:203], v[88:91], v[108:111]
    v_exp_f32 v133, v133
    v_mfma_f32_16x16x32_bf16 v[96:99], a[204:207], v[44:47], v[96:99]
    ds_read_b64_tr_b16 a[236:237], v223 offset:0
    v_cvt_pk_bf16_f32 v180, v132, v133
    v_mfma_f32_16x16x32_bf16 v[100:103], a[204:207], v[60:63], v[100:103]
    v_exp_f32 v134, v134
    v_mfma_f32_16x16x32_bf16 v[104:107], a[204:207], v[76:79], v[104:107]
    s_waitcnt lgkmcnt(7)
    ds_read_b64_tr_b16 a[238:239], v223 offset:4096
    v_mfma_f32_16x16x32_bf16 v[108:111], a[204:207], v[92:95], v[108:111]
    v_exp_f32 v135, v135
    v_mfma_f32_16x16x32_bf16 v[112:115], a[208:211], v[32:35], v[192:195]
    ds_read_b64_tr_b16 a[240:241], v224 offset:0
    v_cvt_pk_bf16_f32 v181, v134, v135
    v_mfma_f32_16x16x32_bf16 v[116:119], a[208:211], v[48:51], v[196:199]
    v_exp_f32 v136, v136
    v_mfma_f32_16x16x32_bf16 v[120:123], a[208:211], v[64:67], v[200:203]
    ds_read_b64_tr_b16 a[242:243], v224 offset:4096
    v_mfma_f32_16x16x32_bf16 v[124:127], a[208:211], v[80:83], v[204:207]
    v_exp_f32 v137, v137
    v_mfma_f32_16x16x32_bf16 v[112:115], a[212:215], v[36:39], v[112:115]
    ds_read_b64_tr_b16 a[244:245], v225 offset:0
    v_cvt_pk_bf16_f32 v184, v136, v137
    v_mfma_f32_16x16x32_bf16 v[116:119], a[212:215], v[52:55], v[116:119]
    v_exp_f32 v138, v138
    v_mfma_f32_16x16x32_bf16 v[120:123], a[212:215], v[68:71], v[120:123]
    ds_read_b64_tr_b16 a[246:247], v225 offset:4096
    v_mfma_f32_16x16x32_bf16 v[124:127], a[212:215], v[84:87], v[124:127]
    v_exp_f32 v139, v139
    v_mfma_f32_16x16x32_bf16 v[112:115], a[216:219], v[40:43], v[112:115]
    ds_read_b64_tr_b16 a[248:249], v226 offset:0
    v_cvt_pk_bf16_f32 v185, v138, v139
    v_mfma_f32_16x16x32_bf16 v[116:119], a[216:219], v[56:59], v[116:119]
    v_exp_f32 v140, v140
    v_mfma_f32_16x16x32_bf16 v[120:123], a[216:219], v[72:75], v[120:123]
    ds_read_b64_tr_b16 a[250:251], v226 offset:4096
    v_mfma_f32_16x16x32_bf16 v[124:127], a[216:219], v[88:91], v[124:127]
    v_exp_f32 v141, v141
    v_mfma_f32_16x16x32_bf16 v[112:115], a[220:223], v[44:47], v[112:115]
    ds_read_b64_tr_b16 a[252:253], v227 offset:0
    v_cvt_pk_bf16_f32 v188, v140, v141
    v_mfma_f32_16x16x32_bf16 v[116:119], a[220:223], v[60:63], v[116:119]
    v_exp_f32 v142, v142
    v_mfma_f32_16x16x32_bf16 v[120:123], a[220:223], v[76:79], v[120:123]
    s_waitcnt lgkmcnt(7)
    ds_read_b64_tr_b16 a[254:255], v227 offset:4096
    v_mfma_f32_16x16x32_bf16 v[124:127], a[220:223], v[92:95], v[124:127]
    v_exp_f32 v143, v143
    v_mfma_f32_16x16x32_bf16 a[0:3], a[224:227], v[160:163], a[0:3]
    s_add_u32 m0, s25, 98304
    ds_read_b128 a[192:195], v216 offset:24576
    v_cvt_pk_bf16_f32 v189, v142, v143
    v_mfma_f32_16x16x32_bf16 a[4:7], a[224:227], v[164:167], a[4:7]
    v_exp_f32 v144, v144
    v_mfma_f32_16x16x32_bf16 a[8:11], a[224:227], v[168:171], a[8:11]
    buffer_load_dwordx4 v232, s[12:15], s41 offen offset:0 lds
    v_mfma_f32_16x16x32_bf16 a[12:15], a[224:227], v[172:175], a[12:15]
    v_exp_f32 v145, v145
    v_mfma_f32_16x16x32_bf16 a[16:19], a[228:231], v[160:163], a[16:19]
    ds_read_b128 a[196:199], v217 offset:24576
    v_cvt_pk_bf16_f32 v178, v144, v145
    v_mfma_f32_16x16x32_bf16 a[20:23], a[228:231], v[164:167], a[20:23]
    v_exp_f32 v146, v146
    v_mfma_f32_16x16x32_bf16 a[24:27], a[228:231], v[168:171], a[24:27]
    v_mfma_f32_16x16x32_bf16 a[28:31], a[228:231], v[172:175], a[28:31]
    v_exp_f32 v147, v147
    v_mfma_f32_16x16x32_bf16 a[32:35], a[232:235], v[160:163], a[32:35]
    ds_read_b128 a[200:203], v218 offset:24576
    v_cvt_pk_bf16_f32 v179, v146, v147
    v_mfma_f32_16x16x32_bf16 a[36:39], a[232:235], v[164:167], a[36:39]
    v_exp_f32 v148, v148
    v_mfma_f32_16x16x32_bf16 a[40:43], a[232:235], v[168:171], a[40:43]
    buffer_load_dwordx4 v233, s[12:15], s41 offen offset:1024 lds
    v_mfma_f32_16x16x32_bf16 a[44:47], a[232:235], v[172:175], a[44:47]
    v_exp_f32 v149, v149
    v_mfma_f32_16x16x32_bf16 a[48:51], a[236:239], v[160:163], a[48:51]
    ds_read_b128 a[204:207], v219 offset:24576
    v_cvt_pk_bf16_f32 v182, v148, v149
    v_mfma_f32_16x16x32_bf16 a[52:55], a[236:239], v[164:167], a[52:55]
    v_exp_f32 v150, v150
    v_mfma_f32_16x16x32_bf16 a[56:59], a[236:239], v[168:171], a[56:59]
    s_waitcnt lgkmcnt(4)
    v_mfma_f32_16x16x32_bf16 a[60:63], a[236:239], v[172:175], a[60:63]
    v_exp_f32 v151, v151
    v_mfma_f32_16x16x32_bf16 a[64:67], a[240:243], v[160:163], a[64:67]
    ds_read_b128 a[208:211], v216 offset:28672
    v_cvt_pk_bf16_f32 v183, v150, v151
    v_mfma_f32_16x16x32_bf16 a[68:71], a[240:243], v[164:167], a[68:71]
    v_exp_f32 v152, v152
    v_mfma_f32_16x16x32_bf16 a[72:75], a[240:243], v[168:171], a[72:75]
    buffer_load_dwordx4 v232, s[12:15], s41 offen offset:2048 lds
    v_mfma_f32_16x16x32_bf16 a[76:79], a[240:243], v[172:175], a[76:79]
    v_exp_f32 v153, v153
    v_mfma_f32_16x16x32_bf16 a[80:83], a[244:247], v[160:163], a[80:83]
    ds_read_b128 a[212:215], v217 offset:28672
    v_cvt_pk_bf16_f32 v186, v152, v153
    v_mfma_f32_16x16x32_bf16 a[84:87], a[244:247], v[164:167], a[84:87]
    v_exp_f32 v154, v154
    v_mfma_f32_16x16x32_bf16 a[88:91], a[244:247], v[168:171], a[88:91]
    v_mfma_f32_16x16x32_bf16 a[92:95], a[244:247], v[172:175], a[92:95]
    v_exp_f32 v155, v155
    v_mfma_f32_16x16x32_bf16 a[96:99], a[248:251], v[160:163], a[96:99]
    ds_read_b128 a[216:219], v218 offset:28672
    v_cvt_pk_bf16_f32 v187, v154, v155
    v_mfma_f32_16x16x32_bf16 a[100:103], a[248:251], v[164:167], a[100:103]
    v_exp_f32 v156, v156
    v_mfma_f32_16x16x32_bf16 a[104:107], a[248:251], v[168:171], a[104:107]
    buffer_load_dwordx4 v233, s[12:15], s41 offen offset:3072 lds
    v_mfma_f32_16x16x32_bf16 a[108:111], a[248:251], v[172:175], a[108:111]
    v_exp_f32 v157, v157
    v_mfma_f32_16x16x32_bf16 a[112:115], a[252:255], v[160:163], a[112:115]
    ds_read_b128 a[220:223], v219 offset:28672
    v_cvt_pk_bf16_f32 v190, v156, v157
    v_mfma_f32_16x16x32_bf16 a[116:119], a[252:255], v[164:167], a[116:119]
    v_exp_f32 v158, v158
    v_mfma_f32_16x16x32_bf16 a[120:123], a[252:255], v[168:171], a[120:123]
    s_add_u32 s41, s41, 16384
    s_waitcnt lgkmcnt(4)
    v_mfma_f32_16x16x32_bf16 a[124:127], a[252:255], v[172:175], a[124:127]
    v_exp_f32 v159, v159
    v_mfma_f32_16x16x32_bf16 a[128:131], a[144:147], v[160:163], a[128:131]
    v_mfma_f32_16x16x32_bf16 a[132:135], a[144:147], v[164:167], a[132:135]
    v_mfma_f32_16x16x32_bf16 a[136:139], a[144:147], v[168:171], a[136:139]
    v_mfma_f32_16x16x32_bf16 a[140:143], a[144:147], v[172:175], a[140:143]
    v_mfma_f32_16x16x32_bf16 v[128:131], a[192:195], v[32:35], v[192:195]
    ds_read_b64_tr_b16 a[224:225], v220 offset:8192
    v_cvt_pk_bf16_f32 v191, v158, v159
    v_mfma_f32_16x16x32_bf16 v[132:135], a[192:195], v[48:51], v[196:199]
    v_exp_f32 v96, v96
    v_mfma_f32_16x16x32_bf16 v[136:139], a[192:195], v[64:67], v[200:203]
    ds_read_b64_tr_b16 a[226:227], v220 offset:12288
    v_mfma_f32_16x16x32_bf16 v[140:143], a[192:195], v[80:83], v[204:207]
    v_exp_f32 v97, v97
    v_mfma_f32_16x16x32_bf16 v[128:131], a[196:199], v[36:39], v[128:131]
    ds_read_b64_tr_b16 a[228:229], v221 offset:8192
    v_cvt_pk_bf16_f32 v160, v96, v97
    v_mfma_f32_16x16x32_bf16 v[132:135], a[196:199], v[52:55], v[132:135]
    v_exp_f32 v98, v98
    v_mfma_f32_16x16x32_bf16 v[136:139], a[196:199], v[68:71], v[136:139]
    ds_read_b64_tr_b16 a[230:231], v221 offset:12288
    v_mfma_f32_16x16x32_bf16 v[140:143], a[196:199], v[84:87], v[140:143]
    v_exp_f32 v99, v99
    v_mfma_f32_16x16x32_bf16 v[128:131], a[200:203], v[40:43], v[128:131]
    ds_read_b64_tr_b16 a[232:233], v222 offset:8192
    v_cvt_pk_bf16_f32 v161, v98, v99
    v_mfma_f32_16x16x32_bf16 v[132:135], a[200:203], v[56:59], v[132:135]
    v_exp_f32 v100, v100
    v_mfma_f32_16x16x32_bf16 v[136:139], a[200:203], v[72:75], v[136:139]
    ds_read_b64_tr_b16 a[234:235], v222 offset:12288
    v_mfma_f32_16x16x32_bf16 v[140:143], a[200:203], v[88:91], v[140:143]
    v_exp_f32 v101, v101
    v_mfma_f32_16x16x32_bf16 v[128:131], a[204:207], v[44:47], v[128:131]
    ds_read_b64_tr_b16 a[236:237], v223 offset:8192
    v_cvt_pk_bf16_f32 v164, v100, v101
    v_mfma_f32_16x16x32_bf16 v[132:135], a[204:207], v[60:63], v[132:135]
    v_exp_f32 v102, v102
    v_mfma_f32_16x16x32_bf16 v[136:139], a[204:207], v[76:79], v[136:139]
    s_waitcnt lgkmcnt(7)
    ds_read_b64_tr_b16 a[238:239], v223 offset:12288
    v_mfma_f32_16x16x32_bf16 v[140:143], a[204:207], v[92:95], v[140:143]
    v_exp_f32 v103, v103
    v_mfma_f32_16x16x32_bf16 v[144:147], a[208:211], v[32:35], v[192:195]
    ds_read_b64_tr_b16 a[240:241], v224 offset:8192
    v_cvt_pk_bf16_f32 v165, v102, v103
    v_mfma_f32_16x16x32_bf16 v[148:151], a[208:211], v[48:51], v[196:199]
    v_exp_f32 v104, v104
    v_mfma_f32_16x16x32_bf16 v[152:155], a[208:211], v[64:67], v[200:203]
    ds_read_b64_tr_b16 a[242:243], v224 offset:12288
    v_mfma_f32_16x16x32_bf16 v[156:159], a[208:211], v[80:83], v[204:207]
    v_exp_f32 v105, v105
    v_mfma_f32_16x16x32_bf16 v[144:147], a[212:215], v[36:39], v[144:147]
    ds_read_b64_tr_b16 a[244:245], v225 offset:8192
    v_cvt_pk_bf16_f32 v168, v104, v105
    v_mfma_f32_16x16x32_bf16 v[148:151], a[212:215], v[52:55], v[148:151]
    v_exp_f32 v106, v106
    v_mfma_f32_16x16x32_bf16 v[152:155], a[212:215], v[68:71], v[152:155]
    ds_read_b64_tr_b16 a[246:247], v225 offset:12288
    v_mfma_f32_16x16x32_bf16 v[156:159], a[212:215], v[84:87], v[156:159]
    v_exp_f32 v107, v107
    v_mfma_f32_16x16x32_bf16 v[144:147], a[216:219], v[40:43], v[144:147]
    ds_read_b64_tr_b16 a[248:249], v226 offset:8192
    v_cvt_pk_bf16_f32 v169, v106, v107
    v_mfma_f32_16x16x32_bf16 v[148:151], a[216:219], v[56:59], v[148:151]
    v_exp_f32 v108, v108
    v_mfma_f32_16x16x32_bf16 v[152:155], a[216:219], v[72:75], v[152:155]
    ds_read_b64_tr_b16 a[250:251], v226 offset:12288
    v_mfma_f32_16x16x32_bf16 v[156:159], a[216:219], v[88:91], v[156:159]
    v_exp_f32 v109, v109
    v_mfma_f32_16x16x32_bf16 v[144:147], a[220:223], v[44:47], v[144:147]
    ds_read_b64_tr_b16 a[252:253], v227 offset:8192
    v_cvt_pk_bf16_f32 v172, v108, v109
    v_mfma_f32_16x16x32_bf16 v[148:151], a[220:223], v[60:63], v[148:151]
    v_exp_f32 v110, v110
    v_mfma_f32_16x16x32_bf16 v[152:155], a[220:223], v[76:79], v[152:155]
    s_waitcnt vmcnt(8) lgkmcnt(7)
    ds_read_b64_tr_b16 a[254:255], v227 offset:12288
    v_mfma_f32_16x16x32_bf16 v[156:159], a[220:223], v[92:95], v[156:159]
    v_exp_f32 v111, v111
    s_barrier
    v_mfma_f32_16x16x32_bf16 a[0:3], a[224:227], v[176:179], a[0:3]
    s_add_u32 m0, s25, 0
    buffer_load_dwordx4 v[244:247], v6, s[52:55], s27 offen
    ds_read_b128 a[192:195], v216 offset:32768
    v_cvt_pk_bf16_f32 v173, v110, v111
    v_mfma_f32_16x16x32_bf16 a[4:7], a[224:227], v[180:183], a[4:7]
    v_exp_f32 v112, v112
    v_mfma_f32_16x16x32_bf16 a[8:11], a[224:227], v[184:187], a[8:11]
    buffer_load_dwordx4 v228, s[8:11], s40 offen offset:0 lds
    v_mfma_f32_16x16x32_bf16 a[12:15], a[224:227], v[188:191], a[12:15]
    v_exp_f32 v113, v113
    v_mfma_f32_16x16x32_bf16 a[16:19], a[228:231], v[176:179], a[16:19]
    ds_read_b128 a[196:199], v217 offset:32768
    v_cvt_pk_bf16_f32 v162, v112, v113
    v_mfma_f32_16x16x32_bf16 a[20:23], a[228:231], v[180:183], a[20:23]
    v_exp_f32 v114, v114
    v_mfma_f32_16x16x32_bf16 a[24:27], a[228:231], v[184:187], a[24:27]
    s_add_u32 s27, s27, 1024
    v_mfma_f32_16x16x32_bf16 a[28:31], a[228:231], v[188:191], a[28:31]
    v_exp_f32 v115, v115
    v_mfma_f32_16x16x32_bf16 a[32:35], a[232:235], v[176:179], a[32:35]
    ds_read_b128 a[200:203], v218 offset:32768
    v_cvt_pk_bf16_f32 v163, v114, v115
    v_mfma_f32_16x16x32_bf16 a[36:39], a[232:235], v[180:183], a[36:39]
    v_exp_f32 v116, v116
    v_mfma_f32_16x16x32_bf16 a[40:43], a[232:235], v[184:187], a[40:43]
    buffer_load_dwordx4 v229, s[8:11], s40 offen offset:1024 lds
    v_mfma_f32_16x16x32_bf16 a[44:47], a[232:235], v[188:191], a[44:47]
    v_exp_f32 v117, v117
    v_mfma_f32_16x16x32_bf16 a[48:51], a[236:239], v[176:179], a[48:51]
    ds_read_b128 a[204:207], v219 offset:32768
    v_cvt_pk_bf16_f32 v166, v116, v117
    v_mfma_f32_16x16x32_bf16 a[52:55], a[236:239], v[180:183], a[52:55]
    v_exp_f32 v118, v118
    v_mfma_f32_16x16x32_bf16 a[56:59], a[236:239], v[184:187], a[56:59]
    s_waitcnt lgkmcnt(4)
    v_mfma_f32_16x16x32_bf16 a[60:63], a[236:239], v[188:191], a[60:63]
    v_exp_f32 v119, v119
    v_mfma_f32_16x16x32_bf16 a[64:67], a[240:243], v[176:179], a[64:67]
    ds_read_b128 a[208:211], v216 offset:36864
    v_cvt_pk_bf16_f32 v167, v118, v119
    v_mfma_f32_16x16x32_bf16 a[68:71], a[240:243], v[180:183], a[68:71]
    v_exp_f32 v120, v120
    v_mfma_f32_16x16x32_bf16 a[72:75], a[240:243], v[184:187], a[72:75]
    buffer_load_dwordx4 v230, s[8:11], s40 offen offset:2048 lds
    v_mfma_f32_16x16x32_bf16 a[76:79], a[240:243], v[188:191], a[76:79]
    v_exp_f32 v121, v121
    v_mfma_f32_16x16x32_bf16 a[80:83], a[244:247], v[176:179], a[80:83]
    ds_read_b128 a[212:215], v217 offset:36864
    v_cvt_pk_bf16_f32 v170, v120, v121
    v_mfma_f32_16x16x32_bf16 a[84:87], a[244:247], v[180:183], a[84:87]
    v_exp_f32 v122, v122
    v_mfma_f32_16x16x32_bf16 a[88:91], a[244:247], v[184:187], a[88:91]
    v_mfma_f32_16x16x32_bf16 a[92:95], a[244:247], v[188:191], a[92:95]
    v_exp_f32 v123, v123
    v_mfma_f32_16x16x32_bf16 a[96:99], a[248:251], v[176:179], a[96:99]
    ds_read_b128 a[216:219], v218 offset:36864
    v_cvt_pk_bf16_f32 v171, v122, v123
    v_mfma_f32_16x16x32_bf16 a[100:103], a[248:251], v[180:183], a[100:103]
    v_exp_f32 v124, v124
    v_mfma_f32_16x16x32_bf16 a[104:107], a[248:251], v[184:187], a[104:107]
    buffer_load_dwordx4 v231, s[8:11], s40 offen offset:3072 lds
    v_mfma_f32_16x16x32_bf16 a[108:111], a[248:251], v[188:191], a[108:111]
    v_exp_f32 v125, v125
    v_mfma_f32_16x16x32_bf16 a[112:115], a[252:255], v[176:179], a[112:115]
    ds_read_b128 a[220:223], v219 offset:36864
    v_cvt_pk_bf16_f32 v174, v124, v125
    v_mfma_f32_16x16x32_bf16 a[116:119], a[252:255], v[180:183], a[116:119]
    v_exp_f32 v126, v126
    v_mfma_f32_16x16x32_bf16 a[120:123], a[252:255], v[184:187], a[120:123]
    s_add_u32 s40, s40, 16384
    s_waitcnt lgkmcnt(4)
    v_mfma_f32_16x16x32_bf16 a[124:127], a[252:255], v[188:191], a[124:127]
    v_exp_f32 v127, v127
    v_mfma_f32_16x16x32_bf16 a[128:131], a[144:147], v[176:179], a[128:131]
    v_mfma_f32_16x16x32_bf16 a[132:135], a[144:147], v[180:183], a[132:135]
    v_mfma_f32_16x16x32_bf16 a[136:139], a[144:147], v[184:187], a[136:139]
    v_mfma_f32_16x16x32_bf16 a[140:143], a[144:147], v[188:191], a[140:143]
    v_mfma_f32_16x16x32_bf16 v[96:99], a[192:195], v[32:35], v[192:195]
    ds_read_b64_tr_b16 a[224:225], v220 offset:16384
    v_cvt_pk_bf16_f32 v175, v126, v127
    v_mfma_f32_16x16x32_bf16 v[100:103], a[192:195], v[48:51], v[196:199]
    v_exp_f32 v128, v128
    v_mfma_f32_16x16x32_bf16 v[104:107], a[192:195], v[64:67], v[200:203]
    ds_read_b64_tr_b16 a[226:227], v220 offset:20480
    v_mfma_f32_16x16x32_bf16 v[108:111], a[192:195], v[80:83], v[204:207]
    v_exp_f32 v129, v129
    v_mfma_f32_16x16x32_bf16 v[96:99], a[196:199], v[36:39], v[96:99]
    ds_read_b64_tr_b16 a[228:229], v221 offset:16384
    v_cvt_pk_bf16_f32 v176, v128, v129
    v_mfma_f32_16x16x32_bf16 v[100:103], a[196:199], v[52:55], v[100:103]
    v_exp_f32 v130, v130
    v_mfma_f32_16x16x32_bf16 v[104:107], a[196:199], v[68:71], v[104:107]
    ds_read_b64_tr_b16 a[230:231], v221 offset:20480
    v_mfma_f32_16x16x32_bf16 v[108:111], a[196:199], v[84:87], v[108:111]
    v_exp_f32 v131, v131
    v_mfma_f32_16x16x32_bf16 v[96:99], a[200:203], v[40:43], v[96:99]
    ds_read_b64_tr_b16 a[232:233], v222 offset:16384
    v_cvt_pk_bf16_f32 v177, v130, v131
    v_mfma_f32_16x16x32_bf16 v[100:103], a[200:203], v[56:59], v[100:103]
    v_exp_f32 v132, v132
    v_mfma_f32_16x16x32_bf16 v[104:107], a[200:203], v[72:75], v[104:107]
    ds_read_b64_tr_b16 a[234:235], v222 offset:20480
    v_mfma_f32_16x16x32_bf16 v[108:111], a[200:203], v[88:91], v[108:111]
    v_exp_f32 v133, v133
    v_mfma_f32_16x16x32_bf16 v[96:99], a[204:207], v[44:47], v[96:99]
    ds_read_b64_tr_b16 a[236:237], v223 offset:16384
    v_cvt_pk_bf16_f32 v180, v132, v133
    v_mfma_f32_16x16x32_bf16 v[100:103], a[204:207], v[60:63], v[100:103]
    v_exp_f32 v134, v134
    v_mfma_f32_16x16x32_bf16 v[104:107], a[204:207], v[76:79], v[104:107]
    s_waitcnt lgkmcnt(7)
    ds_read_b64_tr_b16 a[238:239], v223 offset:20480
    v_mfma_f32_16x16x32_bf16 v[108:111], a[204:207], v[92:95], v[108:111]
    v_exp_f32 v135, v135
    v_mfma_f32_16x16x32_bf16 v[112:115], a[208:211], v[32:35], v[192:195]
    ds_read_b64_tr_b16 a[240:241], v224 offset:16384
    v_cvt_pk_bf16_f32 v181, v134, v135
    v_mfma_f32_16x16x32_bf16 v[116:119], a[208:211], v[48:51], v[196:199]
    v_exp_f32 v136, v136
    v_mfma_f32_16x16x32_bf16 v[120:123], a[208:211], v[64:67], v[200:203]
    ds_read_b64_tr_b16 a[242:243], v224 offset:20480
    v_mfma_f32_16x16x32_bf16 v[124:127], a[208:211], v[80:83], v[204:207]
    v_exp_f32 v137, v137
    v_mfma_f32_16x16x32_bf16 v[112:115], a[212:215], v[36:39], v[112:115]
    ds_read_b64_tr_b16 a[244:245], v225 offset:16384
    v_cvt_pk_bf16_f32 v184, v136, v137
    v_mfma_f32_16x16x32_bf16 v[116:119], a[212:215], v[52:55], v[116:119]
    v_exp_f32 v138, v138
    v_mfma_f32_16x16x32_bf16 v[120:123], a[212:215], v[68:71], v[120:123]
    ds_read_b64_tr_b16 a[246:247], v225 offset:20480
    v_mfma_f32_16x16x32_bf16 v[124:127], a[212:215], v[84:87], v[124:127]
    v_exp_f32 v139, v139
    v_mfma_f32_16x16x32_bf16 v[112:115], a[216:219], v[40:43], v[112:115]
    ds_read_b64_tr_b16 a[248:249], v226 offset:16384
    v_cvt_pk_bf16_f32 v185, v138, v139
    v_mfma_f32_16x16x32_bf16 v[116:119], a[216:219], v[56:59], v[116:119]
    v_exp_f32 v140, v140
    v_mfma_f32_16x16x32_bf16 v[120:123], a[216:219], v[72:75], v[120:123]
    ds_read_b64_tr_b16 a[250:251], v226 offset:20480
    v_mfma_f32_16x16x32_bf16 v[124:127], a[216:219], v[88:91], v[124:127]
    v_exp_f32 v141, v141
    v_mfma_f32_16x16x32_bf16 v[112:115], a[220:223], v[44:47], v[112:115]
    ds_read_b64_tr_b16 a[252:253], v227 offset:16384
    v_cvt_pk_bf16_f32 v188, v140, v141
    v_mfma_f32_16x16x32_bf16 v[116:119], a[220:223], v[60:63], v[116:119]
    v_exp_f32 v142, v142
    v_mfma_f32_16x16x32_bf16 v[120:123], a[220:223], v[76:79], v[120:123]
    s_waitcnt lgkmcnt(7)
    ds_read_b64_tr_b16 a[254:255], v227 offset:20480
    v_mfma_f32_16x16x32_bf16 v[124:127], a[220:223], v[92:95], v[124:127]
    v_exp_f32 v143, v143
    v_mfma_f32_16x16x32_bf16 a[0:3], a[224:227], v[160:163], a[0:3]
    s_add_u32 m0, s25, 114688
    ds_read_b128 a[192:195], v216 offset:40960
    v_cvt_pk_bf16_f32 v189, v142, v143
    v_mfma_f32_16x16x32_bf16 a[4:7], a[224:227], v[164:167], a[4:7]
    v_exp_f32 v144, v144
    v_mfma_f32_16x16x32_bf16 a[8:11], a[224:227], v[168:171], a[8:11]
    buffer_load_dwordx4 v232, s[12:15], s41 offen offset:0 lds
    v_mfma_f32_16x16x32_bf16 a[12:15], a[224:227], v[172:175], a[12:15]
    v_exp_f32 v145, v145
    v_mfma_f32_16x16x32_bf16 a[16:19], a[228:231], v[160:163], a[16:19]
    ds_read_b128 a[196:199], v217 offset:40960
    v_cvt_pk_bf16_f32 v178, v144, v145
    v_mfma_f32_16x16x32_bf16 a[20:23], a[228:231], v[164:167], a[20:23]
    v_exp_f32 v146, v146
    v_mfma_f32_16x16x32_bf16 a[24:27], a[228:231], v[168:171], a[24:27]
    v_mfma_f32_16x16x32_bf16 a[28:31], a[228:231], v[172:175], a[28:31]
    v_exp_f32 v147, v147
    v_mfma_f32_16x16x32_bf16 a[32:35], a[232:235], v[160:163], a[32:35]
    ds_read_b128 a[200:203], v218 offset:40960
    v_cvt_pk_bf16_f32 v179, v146, v147
    v_mfma_f32_16x16x32_bf16 a[36:39], a[232:235], v[164:167], a[36:39]
    v_exp_f32 v148, v148
    v_mfma_f32_16x16x32_bf16 a[40:43], a[232:235], v[168:171], a[40:43]
    buffer_load_dwordx4 v233, s[12:15], s41 offen offset:1024 lds
    v_mfma_f32_16x16x32_bf16 a[44:47], a[232:235], v[172:175], a[44:47]
    v_exp_f32 v149, v149
    v_mfma_f32_16x16x32_bf16 a[48:51], a[236:239], v[160:163], a[48:51]
    ds_read_b128 a[204:207], v219 offset:40960
    v_cvt_pk_bf16_f32 v182, v148, v149
    v_mfma_f32_16x16x32_bf16 a[52:55], a[236:239], v[164:167], a[52:55]
    v_exp_f32 v150, v150
    v_mfma_f32_16x16x32_bf16 a[56:59], a[236:239], v[168:171], a[56:59]
    s_waitcnt lgkmcnt(4)
    v_mfma_f32_16x16x32_bf16 a[60:63], a[236:239], v[172:175], a[60:63]
    v_exp_f32 v151, v151
    v_mfma_f32_16x16x32_bf16 a[64:67], a[240:243], v[160:163], a[64:67]
    ds_read_b128 a[208:211], v216 offset:45056
    v_cvt_pk_bf16_f32 v183, v150, v151
    v_mfma_f32_16x16x32_bf16 a[68:71], a[240:243], v[164:167], a[68:71]
    v_exp_f32 v152, v152
    v_mfma_f32_16x16x32_bf16 a[72:75], a[240:243], v[168:171], a[72:75]
    buffer_load_dwordx4 v232, s[12:15], s41 offen offset:2048 lds
    v_mfma_f32_16x16x32_bf16 a[76:79], a[240:243], v[172:175], a[76:79]
    v_exp_f32 v153, v153
    v_mfma_f32_16x16x32_bf16 a[80:83], a[244:247], v[160:163], a[80:83]
    ds_read_b128 a[212:215], v217 offset:45056
    v_cvt_pk_bf16_f32 v186, v152, v153
    v_mfma_f32_16x16x32_bf16 a[84:87], a[244:247], v[164:167], a[84:87]
    v_exp_f32 v154, v154
    v_mfma_f32_16x16x32_bf16 a[88:91], a[244:247], v[168:171], a[88:91]
    v_mfma_f32_16x16x32_bf16 a[92:95], a[244:247], v[172:175], a[92:95]
    v_exp_f32 v155, v155
    v_mfma_f32_16x16x32_bf16 a[96:99], a[248:251], v[160:163], a[96:99]
    ds_read_b128 a[216:219], v218 offset:45056
    v_cvt_pk_bf16_f32 v187, v154, v155
    v_mfma_f32_16x16x32_bf16 a[100:103], a[248:251], v[164:167], a[100:103]
    v_exp_f32 v156, v156
    v_mfma_f32_16x16x32_bf16 a[104:107], a[248:251], v[168:171], a[104:107]
    buffer_load_dwordx4 v233, s[12:15], s41 offen offset:3072 lds
    v_mfma_f32_16x16x32_bf16 a[108:111], a[248:251], v[172:175], a[108:111]
    v_exp_f32 v157, v157
    v_mfma_f32_16x16x32_bf16 a[112:115], a[252:255], v[160:163], a[112:115]
    ds_read_b128 a[220:223], v219 offset:45056
    v_cvt_pk_bf16_f32 v190, v156, v157
    v_mfma_f32_16x16x32_bf16 a[116:119], a[252:255], v[164:167], a[116:119]
    v_exp_f32 v158, v158
    v_mfma_f32_16x16x32_bf16 a[120:123], a[252:255], v[168:171], a[120:123]
    s_add_u32 s41, s41, 16384
    s_waitcnt lgkmcnt(4)
    v_mfma_f32_16x16x32_bf16 a[124:127], a[252:255], v[172:175], a[124:127]
    v_exp_f32 v159, v159
    v_mfma_f32_16x16x32_bf16 a[128:131], a[144:147], v[160:163], a[128:131]
    v_mfma_f32_16x16x32_bf16 a[132:135], a[144:147], v[164:167], a[132:135]
    v_mfma_f32_16x16x32_bf16 a[136:139], a[144:147], v[168:171], a[136:139]
    v_mfma_f32_16x16x32_bf16 a[140:143], a[144:147], v[172:175], a[140:143]
    v_mfma_f32_16x16x32_bf16 v[128:131], a[192:195], v[32:35], v[192:195]
    ds_read_b64_tr_b16 a[224:225], v220 offset:24576
    v_cvt_pk_bf16_f32 v191, v158, v159
    v_mfma_f32_16x16x32_bf16 v[132:135], a[192:195], v[48:51], v[196:199]
    v_exp_f32 v96, v96
    v_mfma_f32_16x16x32_bf16 v[136:139], a[192:195], v[64:67], v[200:203]
    ds_read_b64_tr_b16 a[226:227], v220 offset:28672
    v_mfma_f32_16x16x32_bf16 v[140:143], a[192:195], v[80:83], v[204:207]
    v_exp_f32 v97, v97
    v_mfma_f32_16x16x32_bf16 v[128:131], a[196:199], v[36:39], v[128:131]
    ds_read_b64_tr_b16 a[228:229], v221 offset:24576
    v_cvt_pk_bf16_f32 v160, v96, v97
    v_mfma_f32_16x16x32_bf16 v[132:135], a[196:199], v[52:55], v[132:135]
    v_exp_f32 v98, v98
    v_mfma_f32_16x16x32_bf16 v[136:139], a[196:199], v[68:71], v[136:139]
    ds_read_b64_tr_b16 a[230:231], v221 offset:28672
    v_mfma_f32_16x16x32_bf16 v[140:143], a[196:199], v[84:87], v[140:143]
    v_exp_f32 v99, v99
    v_mfma_f32_16x16x32_bf16 v[128:131], a[200:203], v[40:43], v[128:131]
    ds_read_b64_tr_b16 a[232:233], v222 offset:24576
    v_cvt_pk_bf16_f32 v161, v98, v99
    v_mfma_f32_16x16x32_bf16 v[132:135], a[200:203], v[56:59], v[132:135]
    v_exp_f32 v100, v100
    v_mfma_f32_16x16x32_bf16 v[136:139], a[200:203], v[72:75], v[136:139]
    ds_read_b64_tr_b16 a[234:235], v222 offset:28672
    v_mfma_f32_16x16x32_bf16 v[140:143], a[200:203], v[88:91], v[140:143]
    v_exp_f32 v101, v101
    v_mfma_f32_16x16x32_bf16 v[128:131], a[204:207], v[44:47], v[128:131]
    ds_read_b64_tr_b16 a[236:237], v223 offset:24576
    v_cvt_pk_bf16_f32 v164, v100, v101
    v_mfma_f32_16x16x32_bf16 v[132:135], a[204:207], v[60:63], v[132:135]
    v_exp_f32 v102, v102
    v_mfma_f32_16x16x32_bf16 v[136:139], a[204:207], v[76:79], v[136:139]
    s_waitcnt lgkmcnt(7)
    ds_read_b64_tr_b16 a[238:239], v223 offset:28672
    v_mfma_f32_16x16x32_bf16 v[140:143], a[204:207], v[92:95], v[140:143]
    v_exp_f32 v103, v103
    v_mfma_f32_16x16x32_bf16 v[144:147], a[208:211], v[32:35], v[192:195]
    ds_read_b64_tr_b16 a[240:241], v224 offset:24576
    v_cvt_pk_bf16_f32 v165, v102, v103
    v_mfma_f32_16x16x32_bf16 v[148:151], a[208:211], v[48:51], v[196:199]
    v_exp_f32 v104, v104
    v_mfma_f32_16x16x32_bf16 v[152:155], a[208:211], v[64:67], v[200:203]
    ds_read_b64_tr_b16 a[242:243], v224 offset:28672
    v_mfma_f32_16x16x32_bf16 v[156:159], a[208:211], v[80:83], v[204:207]
    v_exp_f32 v105, v105
    v_mfma_f32_16x16x32_bf16 v[144:147], a[212:215], v[36:39], v[144:147]
    ds_read_b64_tr_b16 a[244:245], v225 offset:24576
    v_cvt_pk_bf16_f32 v168, v104, v105
    v_mfma_f32_16x16x32_bf16 v[148:151], a[212:215], v[52:55], v[148:151]
    v_exp_f32 v106, v106
    v_mfma_f32_16x16x32_bf16 v[152:155], a[212:215], v[68:71], v[152:155]
    ds_read_b64_tr_b16 a[246:247], v225 offset:28672
    v_mfma_f32_16x16x32_bf16 v[156:159], a[212:215], v[84:87], v[156:159]
    v_exp_f32 v107, v107
    v_mfma_f32_16x16x32_bf16 v[144:147], a[216:219], v[40:43], v[144:147]
    ds_read_b64_tr_b16 a[248:249], v226 offset:24576
    v_cvt_pk_bf16_f32 v169, v106, v107
    v_mfma_f32_16x16x32_bf16 v[148:151], a[216:219], v[56:59], v[148:151]
    v_exp_f32 v108, v108
    v_mfma_f32_16x16x32_bf16 v[152:155], a[216:219], v[72:75], v[152:155]
    ds_read_b64_tr_b16 a[250:251], v226 offset:28672
    v_mfma_f32_16x16x32_bf16 v[156:159], a[216:219], v[88:91], v[156:159]
    v_exp_f32 v109, v109
    v_mfma_f32_16x16x32_bf16 v[144:147], a[220:223], v[44:47], v[144:147]
    ds_read_b64_tr_b16 a[252:253], v227 offset:24576
    v_cvt_pk_bf16_f32 v172, v108, v109
    v_mfma_f32_16x16x32_bf16 v[148:151], a[220:223], v[60:63], v[148:151]
    v_exp_f32 v110, v110
    v_mfma_f32_16x16x32_bf16 v[152:155], a[220:223], v[76:79], v[152:155]
    s_waitcnt vmcnt(9) lgkmcnt(7)
    ds_read_b64_tr_b16 a[254:255], v227 offset:28672
    v_mfma_f32_16x16x32_bf16 v[156:159], a[220:223], v[92:95], v[156:159]
    v_exp_f32 v111, v111
    s_barrier
    v_mfma_f32_16x16x32_bf16 a[0:3], a[224:227], v[176:179], a[0:3]
    s_add_u32 m0, s25, 16384
    global_load_dword v238, v252, s[44:45] sc1
    ds_read_b128 a[192:195], v216 offset:49152
    v_cvt_pk_bf16_f32 v173, v110, v111
    v_mfma_f32_16x16x32_bf16 a[4:7], a[224:227], v[180:183], a[4:7]
    v_exp_f32 v112, v112
    v_mfma_f32_16x16x32_bf16 a[8:11], a[224:227], v[184:187], a[8:11]
    buffer_load_dwordx4 v228, s[8:11], s40 offen offset:0 lds
    v_mfma_f32_16x16x32_bf16 a[12:15], a[224:227], v[188:191], a[12:15]
    v_exp_f32 v113, v113
    v_mfma_f32_16x16x32_bf16 a[16:19], a[228:231], v[176:179], a[16:19]
    ds_read_b128 a[196:199], v217 offset:49152
    v_cvt_pk_bf16_f32 v162, v112, v113
    v_mfma_f32_16x16x32_bf16 a[20:23], a[228:231], v[180:183], a[20:23]
    v_exp_f32 v114, v114
    v_mfma_f32_16x16x32_bf16 a[24:27], a[228:231], v[184:187], a[24:27]
    v_mfma_f32_16x16x32_bf16 a[28:31], a[228:231], v[188:191], a[28:31]
    v_exp_f32 v115, v115
    v_mfma_f32_16x16x32_bf16 a[32:35], a[232:235], v[176:179], a[32:35]
    ds_read_b128 a[200:203], v218 offset:49152
    v_cvt_pk_bf16_f32 v163, v114, v115
    v_mfma_f32_16x16x32_bf16 a[36:39], a[232:235], v[180:183], a[36:39]
    v_exp_f32 v116, v116
    v_mfma_f32_16x16x32_bf16 a[40:43], a[232:235], v[184:187], a[40:43]
    buffer_load_dwordx4 v229, s[8:11], s40 offen offset:1024 lds
    v_mfma_f32_16x16x32_bf16 a[44:47], a[232:235], v[188:191], a[44:47]
    v_exp_f32 v117, v117
    v_mfma_f32_16x16x32_bf16 a[48:51], a[236:239], v[176:179], a[48:51]
    ds_read_b128 a[204:207], v219 offset:49152
    v_cvt_pk_bf16_f32 v166, v116, v117
    v_mfma_f32_16x16x32_bf16 a[52:55], a[236:239], v[180:183], a[52:55]
    v_exp_f32 v118, v118
    v_mfma_f32_16x16x32_bf16 a[56:59], a[236:239], v[184:187], a[56:59]
    s_waitcnt lgkmcnt(4)
    v_mfma_f32_16x16x32_bf16 a[60:63], a[236:239], v[188:191], a[60:63]
    v_exp_f32 v119, v119
    v_mfma_f32_16x16x32_bf16 a[64:67], a[240:243], v[176:179], a[64:67]
    ds_read_b128 a[208:211], v216 offset:53248
    v_cvt_pk_bf16_f32 v167, v118, v119
    v_mfma_f32_16x16x32_bf16 a[68:71], a[240:243], v[180:183], a[68:71]
    v_exp_f32 v120, v120
    v_mfma_f32_16x16x32_bf16 a[72:75], a[240:243], v[184:187], a[72:75]
    buffer_load_dwordx4 v230, s[8:11], s40 offen offset:2048 lds
    v_mfma_f32_16x16x32_bf16 a[76:79], a[240:243], v[188:191], a[76:79]
    v_exp_f32 v121, v121
    v_mfma_f32_16x16x32_bf16 a[80:83], a[244:247], v[176:179], a[80:83]
    ds_read_b128 a[212:215], v217 offset:53248
    v_cvt_pk_bf16_f32 v170, v120, v121
    v_mfma_f32_16x16x32_bf16 a[84:87], a[244:247], v[180:183], a[84:87]
    v_exp_f32 v122, v122
    v_mfma_f32_16x16x32_bf16 a[88:91], a[244:247], v[184:187], a[88:91]
    v_mfma_f32_16x16x32_bf16 a[92:95], a[244:247], v[188:191], a[92:95]
    v_exp_f32 v123, v123
    v_mfma_f32_16x16x32_bf16 a[96:99], a[248:251], v[176:179], a[96:99]
    ds_read_b128 a[216:219], v218 offset:53248
    v_cvt_pk_bf16_f32 v171, v122, v123
    v_mfma_f32_16x16x32_bf16 a[100:103], a[248:251], v[180:183], a[100:103]
    v_exp_f32 v124, v124
    v_mfma_f32_16x16x32_bf16 a[104:107], a[248:251], v[184:187], a[104:107]
    buffer_load_dwordx4 v231, s[8:11], s40 offen offset:3072 lds
    v_mfma_f32_16x16x32_bf16 a[108:111], a[248:251], v[188:191], a[108:111]
    v_exp_f32 v125, v125
    v_mfma_f32_16x16x32_bf16 a[112:115], a[252:255], v[176:179], a[112:115]
    ds_read_b128 a[220:223], v219 offset:53248
    v_cvt_pk_bf16_f32 v174, v124, v125
    v_mfma_f32_16x16x32_bf16 a[116:119], a[252:255], v[180:183], a[116:119]
    v_exp_f32 v126, v126
    v_mfma_f32_16x16x32_bf16 a[120:123], a[252:255], v[184:187], a[120:123]
    s_add_u32 s40, s40, 16384
    s_waitcnt lgkmcnt(4)
    v_mfma_f32_16x16x32_bf16 a[124:127], a[252:255], v[188:191], a[124:127]
    v_exp_f32 v127, v127
    v_mfma_f32_16x16x32_bf16 a[128:131], a[144:147], v[176:179], a[128:131]
    v_mfma_f32_16x16x32_bf16 a[132:135], a[144:147], v[180:183], a[132:135]
    v_mfma_f32_16x16x32_bf16 a[136:139], a[144:147], v[184:187], a[136:139]
    v_mfma_f32_16x16x32_bf16 a[140:143], a[144:147], v[188:191], a[140:143]
    v_mfma_f32_16x16x32_bf16 v[96:99], a[192:195], v[32:35], v[192:195]
    ds_read_b64_tr_b16 a[224:225], v220 offset:32768
    v_cvt_pk_bf16_f32 v175, v126, v127
    v_mfma_f32_16x16x32_bf16 v[100:103], a[192:195], v[48:51], v[196:199]
    v_exp_f32 v128, v128
    v_mfma_f32_16x16x32_bf16 v[104:107], a[192:195], v[64:67], v[200:203]
    ds_read_b64_tr_b16 a[226:227], v220 offset:36864
    v_mfma_f32_16x16x32_bf16 v[108:111], a[192:195], v[80:83], v[204:207]
    v_exp_f32 v129, v129
    v_mfma_f32_16x16x32_bf16 v[96:99], a[196:199], v[36:39], v[96:99]
    ds_read_b64_tr_b16 a[228:229], v221 offset:32768
    v_cvt_pk_bf16_f32 v176, v128, v129
    v_mfma_f32_16x16x32_bf16 v[100:103], a[196:199], v[52:55], v[100:103]
    v_exp_f32 v130, v130
    v_mfma_f32_16x16x32_bf16 v[104:107], a[196:199], v[68:71], v[104:107]
    ds_read_b64_tr_b16 a[230:231], v221 offset:36864
    v_mfma_f32_16x16x32_bf16 v[108:111], a[196:199], v[84:87], v[108:111]
    v_exp_f32 v131, v131
    v_mfma_f32_16x16x32_bf16 v[96:99], a[200:203], v[40:43], v[96:99]
    ds_read_b64_tr_b16 a[232:233], v222 offset:32768
    v_cvt_pk_bf16_f32 v177, v130, v131
    v_mfma_f32_16x16x32_bf16 v[100:103], a[200:203], v[56:59], v[100:103]
    v_exp_f32 v132, v132
    v_mfma_f32_16x16x32_bf16 v[104:107], a[200:203], v[72:75], v[104:107]
    ds_read_b64_tr_b16 a[234:235], v222 offset:36864
    v_mfma_f32_16x16x32_bf16 v[108:111], a[200:203], v[88:91], v[108:111]
    v_exp_f32 v133, v133
    v_mfma_f32_16x16x32_bf16 v[96:99], a[204:207], v[44:47], v[96:99]
    ds_read_b64_tr_b16 a[236:237], v223 offset:32768
    v_cvt_pk_bf16_f32 v180, v132, v133
    v_mfma_f32_16x16x32_bf16 v[100:103], a[204:207], v[60:63], v[100:103]
    v_exp_f32 v134, v134
    v_mfma_f32_16x16x32_bf16 v[104:107], a[204:207], v[76:79], v[104:107]
    s_waitcnt lgkmcnt(7)
    ds_read_b64_tr_b16 a[238:239], v223 offset:36864
    v_mfma_f32_16x16x32_bf16 v[108:111], a[204:207], v[92:95], v[108:111]
    v_exp_f32 v135, v135
    v_mfma_f32_16x16x32_bf16 v[112:115], a[208:211], v[32:35], v[192:195]
    ds_read_b64_tr_b16 a[240:241], v224 offset:32768
    v_cvt_pk_bf16_f32 v181, v134, v135
    v_mfma_f32_16x16x32_bf16 v[116:119], a[208:211], v[48:51], v[196:199]
    v_exp_f32 v136, v136
    v_mfma_f32_16x16x32_bf16 v[120:123], a[208:211], v[64:67], v[200:203]
    ds_read_b64_tr_b16 a[242:243], v224 offset:36864
    v_mfma_f32_16x16x32_bf16 v[124:127], a[208:211], v[80:83], v[204:207]
    v_exp_f32 v137, v137
    v_mfma_f32_16x16x32_bf16 v[112:115], a[212:215], v[36:39], v[112:115]
    ds_read_b64_tr_b16 a[244:245], v225 offset:32768
    v_cvt_pk_bf16_f32 v184, v136, v137
    v_mfma_f32_16x16x32_bf16 v[116:119], a[212:215], v[52:55], v[116:119]
    v_exp_f32 v138, v138
    v_mfma_f32_16x16x32_bf16 v[120:123], a[212:215], v[68:71], v[120:123]
    ds_read_b64_tr_b16 a[246:247], v225 offset:36864
    v_mfma_f32_16x16x32_bf16 v[124:127], a[212:215], v[84:87], v[124:127]
    v_exp_f32 v139, v139
    v_mfma_f32_16x16x32_bf16 v[112:115], a[216:219], v[40:43], v[112:115]
    ds_read_b64_tr_b16 a[248:249], v226 offset:32768
    v_cvt_pk_bf16_f32 v185, v138, v139
    v_mfma_f32_16x16x32_bf16 v[116:119], a[216:219], v[56:59], v[116:119]
    v_exp_f32 v140, v140
    v_mfma_f32_16x16x32_bf16 v[120:123], a[216:219], v[72:75], v[120:123]
    ds_read_b64_tr_b16 a[250:251], v226 offset:36864
    v_mfma_f32_16x16x32_bf16 v[124:127], a[216:219], v[88:91], v[124:127]
    v_exp_f32 v141, v141
    v_mfma_f32_16x16x32_bf16 v[112:115], a[220:223], v[44:47], v[112:115]
    ds_read_b64_tr_b16 a[252:253], v227 offset:32768
    v_cvt_pk_bf16_f32 v188, v140, v141
    v_mfma_f32_16x16x32_bf16 v[116:119], a[220:223], v[60:63], v[116:119]
    v_exp_f32 v142, v142
    v_mfma_f32_16x16x32_bf16 v[120:123], a[220:223], v[76:79], v[120:123]
    s_waitcnt lgkmcnt(7)
    ds_read_b64_tr_b16 a[254:255], v227 offset:36864
    v_mfma_f32_16x16x32_bf16 v[124:127], a[220:223], v[92:95], v[124:127]
    v_exp_f32 v143, v143
    v_mfma_f32_16x16x32_bf16 a[0:3], a[224:227], v[160:163], a[0:3]
    s_add_u32 m0, s25, 65536
    ds_read_b128 a[192:195], v216 offset:57344
    v_cvt_pk_bf16_f32 v189, v142, v143
    v_mfma_f32_16x16x32_bf16 a[4:7], a[224:227], v[164:167], a[4:7]
    v_exp_f32 v144, v144
    v_mfma_f32_16x16x32_bf16 a[8:11], a[224:227], v[168:171], a[8:11]
    buffer_load_dwordx4 v232, s[12:15], s41 offen offset:0 lds
    v_mfma_f32_16x16x32_bf16 a[12:15], a[224:227], v[172:175], a[12:15]
    v_exp_f32 v145, v145
    v_mfma_f32_16x16x32_bf16 a[16:19], a[228:231], v[160:163], a[16:19]
    ds_read_b128 a[196:199], v217 offset:57344
    v_cvt_pk_bf16_f32 v178, v144, v145
    v_mfma_f32_16x16x32_bf16 a[20:23], a[228:231], v[164:167], a[20:23]
    v_exp_f32 v146, v146
    v_mfma_f32_16x16x32_bf16 a[24:27], a[228:231], v[168:171], a[24:27]
    v_mfma_f32_16x16x32_bf16 a[28:31], a[228:231], v[172:175], a[28:31]
    v_exp_f32 v147, v147
    v_mfma_f32_16x16x32_bf16 a[32:35], a[232:235], v[160:163], a[32:35]
    ds_read_b128 a[200:203], v218 offset:57344
    v_cvt_pk_bf16_f32 v179, v146, v147
    v_mfma_f32_16x16x32_bf16 a[36:39], a[232:235], v[164:167], a[36:39]
    v_exp_f32 v148, v148
    v_mfma_f32_16x16x32_bf16 a[40:43], a[232:235], v[168:171], a[40:43]
    buffer_load_dwordx4 v233, s[12:15], s41 offen offset:1024 lds
    v_mfma_f32_16x16x32_bf16 a[44:47], a[232:235], v[172:175], a[44:47]
    v_exp_f32 v149, v149
    v_mfma_f32_16x16x32_bf16 a[48:51], a[236:239], v[160:163], a[48:51]
    ds_read_b128 a[204:207], v219 offset:57344
    v_cvt_pk_bf16_f32 v182, v148, v149
    v_mfma_f32_16x16x32_bf16 a[52:55], a[236:239], v[164:167], a[52:55]
    v_exp_f32 v150, v150
    v_mfma_f32_16x16x32_bf16 a[56:59], a[236:239], v[168:171], a[56:59]
    s_waitcnt lgkmcnt(4)
    v_mfma_f32_16x16x32_bf16 a[60:63], a[236:239], v[172:175], a[60:63]
    v_exp_f32 v151, v151
    v_mfma_f32_16x16x32_bf16 a[64:67], a[240:243], v[160:163], a[64:67]
    ds_read_b128 a[208:211], v216 offset:61440
    v_cvt_pk_bf16_f32 v183, v150, v151
    v_mfma_f32_16x16x32_bf16 a[68:71], a[240:243], v[164:167], a[68:71]
    v_exp_f32 v152, v152
    v_mfma_f32_16x16x32_bf16 a[72:75], a[240:243], v[168:171], a[72:75]
    buffer_load_dwordx4 v232, s[12:15], s41 offen offset:2048 lds
    v_mfma_f32_16x16x32_bf16 a[76:79], a[240:243], v[172:175], a[76:79]
    v_exp_f32 v153, v153
    v_mfma_f32_16x16x32_bf16 a[80:83], a[244:247], v[160:163], a[80:83]
    ds_read_b128 a[212:215], v217 offset:61440
    v_cvt_pk_bf16_f32 v186, v152, v153
    v_mfma_f32_16x16x32_bf16 a[84:87], a[244:247], v[164:167], a[84:87]
    v_exp_f32 v154, v154
    v_mfma_f32_16x16x32_bf16 a[88:91], a[244:247], v[168:171], a[88:91]
    v_mfma_f32_16x16x32_bf16 a[92:95], a[244:247], v[172:175], a[92:95]
    v_exp_f32 v155, v155
    v_mfma_f32_16x16x32_bf16 a[96:99], a[248:251], v[160:163], a[96:99]
    ds_read_b128 a[216:219], v218 offset:61440
    v_cvt_pk_bf16_f32 v187, v154, v155
    v_mfma_f32_16x16x32_bf16 a[100:103], a[248:251], v[164:167], a[100:103]
    v_exp_f32 v156, v156
    v_mfma_f32_16x16x32_bf16 a[104:107], a[248:251], v[168:171], a[104:107]
    buffer_load_dwordx4 v233, s[12:15], s41 offen offset:3072 lds
    v_mfma_f32_16x16x32_bf16 a[108:111], a[248:251], v[172:175], a[108:111]
    v_exp_f32 v157, v157
    v_mfma_f32_16x16x32_bf16 a[112:115], a[252:255], v[160:163], a[112:115]
    ds_read_b128 a[220:223], v219 offset:61440
    v_cvt_pk_bf16_f32 v190, v156, v157
    v_mfma_f32_16x16x32_bf16 a[116:119], a[252:255], v[164:167], a[116:119]
    v_exp_f32 v158, v158
    v_mfma_f32_16x16x32_bf16 a[120:123], a[252:255], v[168:171], a[120:123]
    s_add_u32 s41, s41, 16384
    s_waitcnt lgkmcnt(4)
    v_mfma_f32_16x16x32_bf16 a[124:127], a[252:255], v[172:175], a[124:127]
    v_exp_f32 v159, v159
    v_mfma_f32_16x16x32_bf16 a[128:131], a[144:147], v[160:163], a[128:131]
    v_mfma_f32_16x16x32_bf16 a[132:135], a[144:147], v[164:167], a[132:135]
    v_mfma_f32_16x16x32_bf16 a[136:139], a[144:147], v[168:171], a[136:139]
    v_mfma_f32_16x16x32_bf16 a[140:143], a[144:147], v[172:175], a[140:143]
    v_mfma_f32_16x16x32_bf16 v[128:131], a[192:195], v[32:35], v[192:195]
    ds_read_b64_tr_b16 a[224:225], v220 offset:40960
    v_cvt_pk_bf16_f32 v191, v158, v159
    v_mfma_f32_16x16x32_bf16 v[132:135], a[192:195], v[48:51], v[196:199]
    v_exp_f32 v96, v96
    v_mfma_f32_16x16x32_bf16 v[136:139], a[192:195], v[64:67], v[200:203]
    ds_read_b64_tr_b16 a[226:227], v220 offset:45056
    v_mfma_f32_16x16x32_bf16 v[140:143], a[192:195], v[80:83], v[204:207]
    v_exp_f32 v97, v97
    v_mfma_f32_16x16x32_bf16 v[128:131], a[196:199], v[36:39], v[128:131]
    ds_read_b64_tr_b16 a[228:229], v221 offset:40960
    v_cvt_pk_bf16_f32 v160, v96, v97
    v_mfma_f32_16x16x32_bf16 v[132:135], a[196:199], v[52:55], v[132:135]
    v_exp_f32 v98, v98
    v_mfma_f32_16x16x32_bf16 v[136:139], a[196:199], v[68:71], v[136:139]
    ds_read_b64_tr_b16 a[230:231], v221 offset:45056
    v_mfma_f32_16x16x32_bf16 v[140:143], a[196:199], v[84:87], v[140:143]
    v_exp_f32 v99, v99
    v_mfma_f32_16x16x32_bf16 v[128:131], a[200:203], v[40:43], v[128:131]
    ds_read_b64_tr_b16 a[232:233], v222 offset:40960
    v_cvt_pk_bf16_f32 v161, v98, v99
    v_mfma_f32_16x16x32_bf16 v[132:135], a[200:203], v[56:59], v[132:135]
    v_exp_f32 v100, v100
    v_mfma_f32_16x16x32_bf16 v[136:139], a[200:203], v[72:75], v[136:139]
    ds_read_b64_tr_b16 a[234:235], v222 offset:45056
    v_mfma_f32_16x16x32_bf16 v[140:143], a[200:203], v[88:91], v[140:143]
    v_exp_f32 v101, v101
    v_mfma_f32_16x16x32_bf16 v[128:131], a[204:207], v[44:47], v[128:131]
    ds_read_b64_tr_b16 a[236:237], v223 offset:40960
    v_cvt_pk_bf16_f32 v164, v100, v101
    v_mfma_f32_16x16x32_bf16 v[132:135], a[204:207], v[60:63], v[132:135]
    v_exp_f32 v102, v102
    v_mfma_f32_16x16x32_bf16 v[136:139], a[204:207], v[76:79], v[136:139]
    s_waitcnt lgkmcnt(7)
    ds_read_b64_tr_b16 a[238:239], v223 offset:45056
    v_mfma_f32_16x16x32_bf16 v[140:143], a[204:207], v[92:95], v[140:143]
    v_exp_f32 v103, v103
    v_mfma_f32_16x16x32_bf16 v[144:147], a[208:211], v[32:35], v[192:195]
    ds_read_b64_tr_b16 a[240:241], v224 offset:40960
    v_cvt_pk_bf16_f32 v165, v102, v103
    v_mfma_f32_16x16x32_bf16 v[148:151], a[208:211], v[48:51], v[196:199]
    v_exp_f32 v104, v104
    v_mfma_f32_16x16x32_bf16 v[152:155], a[208:211], v[64:67], v[200:203]
    ds_read_b64_tr_b16 a[242:243], v224 offset:45056
    v_mfma_f32_16x16x32_bf16 v[156:159], a[208:211], v[80:83], v[204:207]
    v_exp_f32 v105, v105
    v_mfma_f32_16x16x32_bf16 v[144:147], a[212:215], v[36:39], v[144:147]
    ds_read_b64_tr_b16 a[244:245], v225 offset:40960
    v_cvt_pk_bf16_f32 v168, v104, v105
    v_mfma_f32_16x16x32_bf16 v[148:151], a[212:215], v[52:55], v[148:151]
    v_exp_f32 v106, v106
    v_mfma_f32_16x16x32_bf16 v[152:155], a[212:215], v[68:71], v[152:155]
    ds_read_b64_tr_b16 a[246:247], v225 offset:45056
    v_mfma_f32_16x16x32_bf16 v[156:159], a[212:215], v[84:87], v[156:159]
    v_exp_f32 v107, v107
    v_mfma_f32_16x16x32_bf16 v[144:147], a[216:219], v[40:43], v[144:147]
    ds_read_b64_tr_b16 a[248:249], v226 offset:40960
    v_cvt_pk_bf16_f32 v169, v106, v107
    v_mfma_f32_16x16x32_bf16 v[148:151], a[216:219], v[56:59], v[148:151]
    v_exp_f32 v108, v108
    v_mfma_f32_16x16x32_bf16 v[152:155], a[216:219], v[72:75], v[152:155]
    ds_read_b64_tr_b16 a[250:251], v226 offset:45056
    v_mfma_f32_16x16x32_bf16 v[156:159], a[216:219], v[88:91], v[156:159]
    v_exp_f32 v109, v109
    v_mfma_f32_16x16x32_bf16 v[144:147], a[220:223], v[44:47], v[144:147]
    ds_read_b64_tr_b16 a[252:253], v227 offset:40960
    v_cvt_pk_bf16_f32 v172, v108, v109
    v_mfma_f32_16x16x32_bf16 v[148:151], a[220:223], v[60:63], v[148:151]
    v_exp_f32 v110, v110
    v_mfma_f32_16x16x32_bf16 v[152:155], a[220:223], v[76:79], v[152:155]
    s_waitcnt vmcnt(9) lgkmcnt(7)
    ds_read_b64_tr_b16 a[254:255], v227 offset:45056
    v_mfma_f32_16x16x32_bf16 v[156:159], a[220:223], v[92:95], v[156:159]
    v_exp_f32 v111, v111
    s_barrier
    v_mfma_f32_16x16x32_bf16 a[0:3], a[224:227], v[176:179], a[0:3]
    s_add_u32 m0, s25, 32768
    buffer_load_dwordx4 v[248:251], v6, s[56:59], s24 offen
    ds_read_b128 a[192:195], v216 offset:0
    v_cvt_pk_bf16_f32 v173, v110, v111
    v_mfma_f32_16x16x32_bf16 a[4:7], a[224:227], v[180:183], a[4:7]
    v_exp_f32 v112, v112
    v_mfma_f32_16x16x32_bf16 a[8:11], a[224:227], v[184:187], a[8:11]
    buffer_load_dwordx4 v228, s[8:11], s40 offen offset:0 lds
    v_mfma_f32_16x16x32_bf16 a[12:15], a[224:227], v[188:191], a[12:15]
    v_exp_f32 v113, v113
    v_mfma_f32_16x16x32_bf16 a[16:19], a[228:231], v[176:179], a[16:19]
    ds_read_b128 a[196:199], v217 offset:0
    v_cvt_pk_bf16_f32 v162, v112, v113
    v_mfma_f32_16x16x32_bf16 a[20:23], a[228:231], v[180:183], a[20:23]
    v_exp_f32 v114, v114
    v_mfma_f32_16x16x32_bf16 a[24:27], a[228:231], v[184:187], a[24:27]
    s_add_u32 s24, s24, 1024
    v_mfma_f32_16x16x32_bf16 a[28:31], a[228:231], v[188:191], a[28:31]
    v_exp_f32 v115, v115
    v_mfma_f32_16x16x32_bf16 a[32:35], a[232:235], v[176:179], a[32:35]
    ds_read_b128 a[200:203], v218 offset:0
    v_cvt_pk_bf16_f32 v163, v114, v115
    v_mfma_f32_16x16x32_bf16 a[36:39], a[232:235], v[180:183], a[36:39]
    v_exp_f32 v116, v116
    v_mfma_f32_16x16x32_bf16 a[40:43], a[232:235], v[184:187], a[40:43]
    buffer_load_dwordx4 v229, s[8:11], s40 offen offset:1024 lds
    v_mfma_f32_16x16x32_bf16 a[44:47], a[232:235], v[188:191], a[44:47]
    v_exp_f32 v117, v117
    v_mfma_f32_16x16x32_bf16 a[48:51], a[236:239], v[176:179], a[48:51]
    ds_read_b128 a[204:207], v219 offset:0
    v_cvt_pk_bf16_f32 v166, v116, v117
    v_mfma_f32_16x16x32_bf16 a[52:55], a[236:239], v[180:183], a[52:55]
    v_exp_f32 v118, v118
    v_mfma_f32_16x16x32_bf16 a[56:59], a[236:239], v[184:187], a[56:59]
    s_waitcnt lgkmcnt(4)
    v_mfma_f32_16x16x32_bf16 a[60:63], a[236:239], v[188:191], a[60:63]
    v_exp_f32 v119, v119
    v_mfma_f32_16x16x32_bf16 a[64:67], a[240:243], v[176:179], a[64:67]
    ds_read_b128 a[208:211], v216 offset:4096
    v_cvt_pk_bf16_f32 v167, v118, v119
    v_mfma_f32_16x16x32_bf16 a[68:71], a[240:243], v[180:183], a[68:71]
    v_exp_f32 v120, v120
    v_mfma_f32_16x16x32_bf16 a[72:75], a[240:243], v[184:187], a[72:75]
    buffer_load_dwordx4 v230, s[8:11], s40 offen offset:2048 lds
    v_mfma_f32_16x16x32_bf16 a[76:79], a[240:243], v[188:191], a[76:79]
    v_exp_f32 v121, v121
    v_mfma_f32_16x16x32_bf16 a[80:83], a[244:247], v[176:179], a[80:83]
    ds_read_b128 a[212:215], v217 offset:4096
    v_cvt_pk_bf16_f32 v170, v120, v121
    v_mfma_f32_16x16x32_bf16 a[84:87], a[244:247], v[180:183], a[84:87]
    v_exp_f32 v122, v122
    v_mfma_f32_16x16x32_bf16 a[88:91], a[244:247], v[184:187], a[88:91]
    v_mfma_f32_16x16x32_bf16 a[92:95], a[244:247], v[188:191], a[92:95]
    v_exp_f32 v123, v123
    v_mfma_f32_16x16x32_bf16 a[96:99], a[248:251], v[176:179], a[96:99]
    ds_read_b128 a[216:219], v218 offset:4096
    v_cvt_pk_bf16_f32 v171, v122, v123
    v_mfma_f32_16x16x32_bf16 a[100:103], a[248:251], v[180:183], a[100:103]
    v_exp_f32 v124, v124
    v_mfma_f32_16x16x32_bf16 a[104:107], a[248:251], v[184:187], a[104:107]
    buffer_load_dwordx4 v231, s[8:11], s40 offen offset:3072 lds
    v_mfma_f32_16x16x32_bf16 a[108:111], a[248:251], v[188:191], a[108:111]
    v_exp_f32 v125, v125
    v_mfma_f32_16x16x32_bf16 a[112:115], a[252:255], v[176:179], a[112:115]
    ds_read_b128 a[220:223], v219 offset:4096
    v_cvt_pk_bf16_f32 v174, v124, v125
    v_mfma_f32_16x16x32_bf16 a[116:119], a[252:255], v[180:183], a[116:119]
    v_exp_f32 v126, v126
    v_mfma_f32_16x16x32_bf16 a[120:123], a[252:255], v[184:187], a[120:123]
    s_add_u32 s40, s40, 16384
    s_waitcnt lgkmcnt(4)
    v_mfma_f32_16x16x32_bf16 a[124:127], a[252:255], v[188:191], a[124:127]
    v_exp_f32 v127, v127
    v_mfma_f32_16x16x32_bf16 a[128:131], a[144:147], v[176:179], a[128:131]
    v_mfma_f32_16x16x32_bf16 a[132:135], a[144:147], v[180:183], a[132:135]
    v_mfma_f32_16x16x32_bf16 a[136:139], a[144:147], v[184:187], a[136:139]
    v_mfma_f32_16x16x32_bf16 a[140:143], a[144:147], v[188:191], a[140:143]
    s_cmp_eq_u32 s28, 7
    s_cbranch_scc1 k_attn_tail
    v_mfma_f32_16x16x32_bf16 v[96:99], a[192:195], v[32:35], v[192:195]
    ds_read_b64_tr_b16 a[224:225], v220 offset:49152
    v_cvt_pk_bf16_f32 v175, v126, v127
    v_mfma_f32_16x16x32_bf16 v[100:103], a[192:195], v[48:51], v[196:199]
    v_exp_f32 v128, v128
    v_mfma_f32_16x16x32_bf16 v[104:107], a[192:195], v[64:67], v[200:203]
    ds_read_b64_tr_b16 a[226:227], v220 offset:53248
    v_mfma_f32_16x16x32_bf16 v[108:111], a[192:195], v[80:83], v[204:207]
    v_exp_f32 v129, v129
    v_mfma_f32_16x16x32_bf16 v[96:99], a[196:199], v[36:39], v[96:99]
    ds_read_b64_tr_b16 a[228:229], v221 offset:49152
    v_cvt_pk_bf16_f32 v176, v128, v129
    v_mfma_f32_16x16x32_bf16 v[100:103], a[196:199], v[52:55], v[100:103]
    v_exp_f32 v130, v130
    v_mfma_f32_16x16x32_bf16 v[104:107], a[196:199], v[68:71], v[104:107]
    ds_read_b64_tr_b16 a[230:231], v221 offset:53248
    v_mfma_f32_16x16x32_bf16 v[108:111], a[196:199], v[84:87], v[108:111]
    v_exp_f32 v131, v131
    v_mfma_f32_16x16x32_bf16 v[96:99], a[200:203], v[40:43], v[96:99]
    ds_read_b64_tr_b16 a[232:233], v222 offset:49152
    v_cvt_pk_bf16_f32 v177, v130, v131
    v_mfma_f32_16x16x32_bf16 v[100:103], a[200:203], v[56:59], v[100:103]
    v_exp_f32 v132, v132
    v_mfma_f32_16x16x32_bf16 v[104:107], a[200:203], v[72:75], v[104:107]
    ds_read_b64_tr_b16 a[234:235], v222 offset:53248
    v_mfma_f32_16x16x32_bf16 v[108:111], a[200:203], v[88:91], v[108:111]
    v_exp_f32 v133, v133
    v_mfma_f32_16x16x32_bf16 v[96:99], a[204:207], v[44:47], v[96:99]
    ds_read_b64_tr_b16 a[236:237], v223 offset:49152
    v_cvt_pk_bf16_f32 v180, v132, v133
    v_mfma_f32_16x16x32_bf16 v[100:103], a[204:207], v[60:63], v[100:103]
    v_exp_f32 v134, v134
    v_mfma_f32_16x16x32_bf16 v[104:107], a[204:207], v[76:79], v[104:107]
    s_waitcnt lgkmcnt(7)
    ds_read_b64_tr_b16 a[238:239], v223 offset:53248
    v_mfma_f32_16x16x32_bf16 v[108:111], a[204:207], v[92:95], v[108:111]
    v_exp_f32 v135, v135
    v_mfma_f32_16x16x32_bf16 v[112:115], a[208:211], v[32:35], v[192:195]
    ds_read_b64_tr_b16 a[240:241], v224 offset:49152
    v_cvt_pk_bf16_f32 v181, v134, v135
    v_mfma_f32_16x16x32_bf16 v[116:119], a[208:211], v[48:51], v[196:199]
    v_exp_f32 v136, v136
    v_mfma_f32_16x16x32_bf16 v[120:123], a[208:211], v[64:67], v[200:203]
    ds_read_b64_tr_b16 a[242:243], v224 offset:53248
    v_mfma_f32_16x16x32_bf16 v[124:127], a[208:211], v[80:83], v[204:207]
    v_exp_f32 v137, v137
    v_mfma_f32_16x16x32_bf16 v[112:115], a[212:215], v[36:39], v[112:115]
    ds_read_b64_tr_b16 a[244:245], v225 offset:49152
    v_cvt_pk_bf16_f32 v184, v136, v137
    v_mfma_f32_16x16x32_bf16 v[116:119], a[212:215], v[52:55], v[116:119]
    v_exp_f32 v138, v138
    v_mfma_f32_16x16x32_bf16 v[120:123], a[212:215], v[68:71], v[120:123]
    ds_read_b64_tr_b16 a[246:247], v225 offset:53248
    v_mfma_f32_16x16x32_bf16 v[124:127], a[212:215], v[84:87], v[124:127]
    v_exp_f32 v139, v139
    v_mfma_f32_16x16x32_bf16 v[112:115], a[216:219], v[40:43], v[112:115]
    ds_read_b64_tr_b16 a[248:249], v226 offset:49152
    v_cvt_pk_bf16_f32 v185, v138, v139
    v_mfma_f32_16x16x32_bf16 v[116:119], a[216:219], v[56:59], v[116:119]
    v_exp_f32 v140, v140
    v_mfma_f32_16x16x32_bf16 v[120:123], a[216:219], v[72:75], v[120:123]
    ds_read_b64_tr_b16 a[250:251], v226 offset:53248
    v_mfma_f32_16x16x32_bf16 v[124:127], a[216:219], v[88:91], v[124:127]
    v_exp_f32 v141, v141
    v_mfma_f32_16x16x32_bf16 v[112:115], a[220:223], v[44:47], v[112:115]
    ds_read_b64_tr_b16 a[252:253], v227 offset:49152
    v_cvt_pk_bf16_f32 v188, v140, v141
    v_mfma_f32_16x16x32_bf16 v[116:119], a[220:223], v[60:63], v[116:119]
    v_exp_f32 v142, v142
    v_mfma_f32_16x16x32_bf16 v[120:123], a[220:223], v[76:79], v[120:123]
    s_waitcnt lgkmcnt(7)
    ds_read_b64_tr_b16 a[254:255], v227 offset:53248
    v_mfma_f32_16x16x32_bf16 v[124:127], a[220:223], v[92:95], v[124:127]
    v_exp_f32 v143, v143
    v_mfma_f32_16x16x32_bf16 a[0:3], a[224:227], v[160:163], a[0:3]
    s_add_u32 m0, s25, 81920
    ds_read_b128 a[192:195], v216 offset:8192
    v_cvt_pk_bf16_f32 v189, v142, v143
    v_mfma_f32_16x16x32_bf16 a[4:7], a[224:227], v[164:167], a[4:7]
    v_exp_f32 v144, v144
    v_mfma_f32_16x16x32_bf16 a[8:11], a[224:227], v[168:171], a[8:11]
    buffer_load_dwordx4 v232, s[12:15], s41 offen offset:0 lds
    v_mfma_f32_16x16x32_bf16 a[12:15], a[224:227], v[172:175], a[12:15]
    v_exp_f32 v145, v145
    v_mfma_f32_16x16x32_bf16 a[16:19], a[228:231], v[160:163], a[16:19]
    ds_read_b128 a[196:199], v217 offset:8192
    v_cvt_pk_bf16_f32 v178, v144, v145
    v_mfma_f32_16x16x32_bf16 a[20:23], a[228:231], v[164:167], a[20:23]
    v_exp_f32 v146, v146
    v_mfma_f32_16x16x32_bf16 a[24:27], a[228:231], v[168:171], a[24:27]
    v_mfma_f32_16x16x32_bf16 a[28:31], a[228:231], v[172:175], a[28:31]
    v_exp_f32 v147, v147
    v_mfma_f32_16x16x32_bf16 a[32:35], a[232:235], v[160:163], a[32:35]
    ds_read_b128 a[200:203], v218 offset:8192
    v_cvt_pk_bf16_f32 v179, v146, v147
    v_mfma_f32_16x16x32_bf16 a[36:39], a[232:235], v[164:167], a[36:39]
    v_exp_f32 v148, v148
    v_mfma_f32_16x16x32_bf16 a[40:43], a[232:235], v[168:171], a[40:43]
    buffer_load_dwordx4 v233, s[12:15], s41 offen offset:1024 lds
    v_mfma_f32_16x16x32_bf16 a[44:47], a[232:235], v[172:175], a[44:47]
    v_exp_f32 v149, v149
    v_mfma_f32_16x16x32_bf16 a[48:51], a[236:239], v[160:163], a[48:51]
    ds_read_b128 a[204:207], v219 offset:8192
    v_cvt_pk_bf16_f32 v182, v148, v149
    v_mfma_f32_16x16x32_bf16 a[52:55], a[236:239], v[164:167], a[52:55]
    v_exp_f32 v150, v150
    v_mfma_f32_16x16x32_bf16 a[56:59], a[236:239], v[168:171], a[56:59]
    s_waitcnt lgkmcnt(4)
    v_mfma_f32_16x16x32_bf16 a[60:63], a[236:239], v[172:175], a[60:63]
    v_exp_f32 v151, v151
    v_mfma_f32_16x16x32_bf16 a[64:67], a[240:243], v[160:163], a[64:67]
    ds_read_b128 a[208:211], v216 offset:12288
    v_cvt_pk_bf16_f32 v183, v150, v151
    v_mfma_f32_16x16x32_bf16 a[68:71], a[240:243], v[164:167], a[68:71]
    v_exp_f32 v152, v152
    v_mfma_f32_16x16x32_bf16 a[72:75], a[240:243], v[168:171], a[72:75]
    buffer_load_dwordx4 v232, s[12:15], s41 offen offset:2048 lds
    v_mfma_f32_16x16x32_bf16 a[76:79], a[240:243], v[172:175], a[76:79]
    v_exp_f32 v153, v153
    v_mfma_f32_16x16x32_bf16 a[80:83], a[244:247], v[160:163], a[80:83]
    ds_read_b128 a[212:215], v217 offset:12288
    v_cvt_pk_bf16_f32 v186, v152, v153
    v_mfma_f32_16x16x32_bf16 a[84:87], a[244:247], v[164:167], a[84:87]
    v_exp_f32 v154, v154
    v_mfma_f32_16x16x32_bf16 a[88:91], a[244:247], v[168:171], a[88:91]
    v_mfma_f32_16x16x32_bf16 a[92:95], a[244:247], v[172:175], a[92:95]
    v_exp_f32 v155, v155
    v_mfma_f32_16x16x32_bf16 a[96:99], a[248:251], v[160:163], a[96:99]
    ds_read_b128 a[216:219], v218 offset:12288
    v_cvt_pk_bf16_f32 v187, v154, v155
    v_mfma_f32_16x16x32_bf16 a[100:103], a[248:251], v[164:167], a[100:103]
    v_exp_f32 v156, v156
    v_mfma_f32_16x16x32_bf16 a[104:107], a[248:251], v[168:171], a[104:107]
    buffer_load_dwordx4 v233, s[12:15], s41 offen offset:3072 lds
    v_mfma_f32_16x16x32_bf16 a[108:111], a[248:251], v[172:175], a[108:111]
    v_exp_f32 v157, v157
    v_mfma_f32_16x16x32_bf16 a[112:115], a[252:255], v[160:163], a[112:115]
    ds_read_b128 a[220:223], v219 offset:12288
    v_cvt_pk_bf16_f32 v190, v156, v157
    v_mfma_f32_16x16x32_bf16 a[116:119], a[252:255], v[164:167], a[116:119]
    v_exp_f32 v158, v158
    v_mfma_f32_16x16x32_bf16 a[120:123], a[252:255], v[168:171], a[120:123]
    s_add_u32 s41, s41, 16384
    s_waitcnt lgkmcnt(4)
    v_mfma_f32_16x16x32_bf16 a[124:127], a[252:255], v[172:175], a[124:127]
    v_exp_f32 v159, v159
    v_mfma_f32_16x16x32_bf16 a[128:131], a[144:147], v[160:163], a[128:131]
    v_mfma_f32_16x16x32_bf16 a[132:135], a[144:147], v[164:167], a[132:135]
    v_mfma_f32_16x16x32_bf16 a[136:139], a[144:147], v[168:171], a[136:139]
    v_mfma_f32_16x16x32_bf16 a[140:143], a[144:147], v[172:175], a[140:143]
    v_mfma_f32_16x16x32_bf16 v[128:131], a[192:195], v[32:35], v[192:195]
    ds_read_b64_tr_b16 a[224:225], v220 offset:57344
    v_cvt_pk_bf16_f32 v191, v158, v159
    v_mfma_f32_16x16x32_bf16 v[132:135], a[192:195], v[48:51], v[196:199]
    v_exp_f32 v96, v96
    v_mfma_f32_16x16x32_bf16 v[136:139], a[192:195], v[64:67], v[200:203]
    ds_read_b64_tr_b16 a[226:227], v220 offset:61440
    v_mfma_f32_16x16x32_bf16 v[140:143], a[192:195], v[80:83], v[204:207]
    v_exp_f32 v97, v97
    v_mfma_f32_16x16x32_bf16 v[128:131], a[196:199], v[36:39], v[128:131]
    ds_read_b64_tr_b16 a[228:229], v221 offset:57344
    v_cvt_pk_bf16_f32 v160, v96, v97
    v_mfma_f32_16x16x32_bf16 v[132:135], a[196:199], v[52:55], v[132:135]
    v_exp_f32 v98, v98
    v_mfma_f32_16x16x32_bf16 v[136:139], a[196:199], v[68:71], v[136:139]
    ds_read_b64_tr_b16 a[230:231], v221 offset:61440
    v_mfma_f32_16x16x32_bf16 v[140:143], a[196:199], v[84:87], v[140:143]
    v_exp_f32 v99, v99
    v_mfma_f32_16x16x32_bf16 v[128:131], a[200:203], v[40:43], v[128:131]
    ds_read_b64_tr_b16 a[232:233], v222 offset:57344
    v_cvt_pk_bf16_f32 v161, v98, v99
    v_mfma_f32_16x16x32_bf16 v[132:135], a[200:203], v[56:59], v[132:135]
    v_exp_f32 v100, v100
    v_mfma_f32_16x16x32_bf16 v[136:139], a[200:203], v[72:75], v[136:139]
    ds_read_b64_tr_b16 a[234:235], v222 offset:61440
    v_mfma_f32_16x16x32_bf16 v[140:143], a[200:203], v[88:91], v[140:143]
    v_exp_f32 v101, v101
    v_mfma_f32_16x16x32_bf16 v[128:131], a[204:207], v[44:47], v[128:131]
    ds_read_b64_tr_b16 a[236:237], v223 offset:57344
    v_cvt_pk_bf16_f32 v164, v100, v101
    v_mfma_f32_16x16x32_bf16 v[132:135], a[204:207], v[60:63], v[132:135]
    v_exp_f32 v102, v102
    v_mfma_f32_16x16x32_bf16 v[136:139], a[204:207], v[76:79], v[136:139]
    s_waitcnt lgkmcnt(7)
    ds_read_b64_tr_b16 a[238:239], v223 offset:61440
    v_mfma_f32_16x16x32_bf16 v[140:143], a[204:207], v[92:95], v[140:143]
    v_exp_f32 v103, v103
    v_mfma_f32_16x16x32_bf16 v[144:147], a[208:211], v[32:35], v[192:195]
    ds_read_b64_tr_b16 a[240:241], v224 offset:57344
    v_cvt_pk_bf16_f32 v165, v102, v103
    v_mfma_f32_16x16x32_bf16 v[148:151], a[208:211], v[48:51], v[196:199]
    v_exp_f32 v104, v104
    v_mfma_f32_16x16x32_bf16 v[152:155], a[208:211], v[64:67], v[200:203]
    ds_read_b64_tr_b16 a[242:243], v224 offset:61440
    v_mfma_f32_16x16x32_bf16 v[156:159], a[208:211], v[80:83], v[204:207]
    v_exp_f32 v105, v105
    v_mfma_f32_16x16x32_bf16 v[144:147], a[212:215], v[36:39], v[144:147]
    ds_read_b64_tr_b16 a[244:245], v225 offset:57344
    v_cvt_pk_bf16_f32 v168, v104, v105
    v_mfma_f32_16x16x32_bf16 v[148:151], a[212:215], v[52:55], v[148:151]
    v_exp_f32 v106, v106
    v_mfma_f32_16x16x32_bf16 v[152:155], a[212:215], v[68:71], v[152:155]
    ds_read_b64_tr_b16 a[246:247], v225 offset:61440
    v_mfma_f32_16x16x32_bf16 v[156:159], a[212:215], v[84:87], v[156:159]
    v_exp_f32 v107, v107
    v_mfma_f32_16x16x32_bf16 v[144:147], a[216:219], v[40:43], v[144:147]
    ds_read_b64_tr_b16 a[248:249], v226 offset:57344
    v_cvt_pk_bf16_f32 v169, v106, v107
    v_mfma_f32_16x16x32_bf16 v[148:151], a[216:219], v[56:59], v[148:151]
    v_exp_f32 v108, v108
    v_mfma_f32_16x16x32_bf16 v[152:155], a[216:219], v[72:75], v[152:155]
    ds_read_b64_tr_b16 a[250:251], v226 offset:61440
    v_mfma_f32_16x16x32_bf16 v[156:159], a[216:219], v[88:91], v[156:159]
    v_exp_f32 v109, v109
    v_mfma_f32_16x16x32_bf16 v[144:147], a[220:223], v[44:47], v[144:147]
    ds_read_b64_tr_b16 a[252:253], v227 offset:57344
    v_cvt_pk_bf16_f32 v172, v108, v109
    v_mfma_f32_16x16x32_bf16 v[148:151], a[220:223], v[60:63], v[148:151]
    v_exp_f32 v110, v110
    v_mfma_f32_16x16x32_bf16 v[152:155], a[220:223], v[76:79], v[152:155]
    s_waitcnt vmcnt(9) lgkmcnt(7)
    ds_read_b64_tr_b16 a[254:255], v227 offset:61440
    v_mfma_f32_16x16x32_bf16 v[156:159], a[220:223], v[92:95], v[156:159]
    v_exp_f32 v111, v111
    s_barrier
    v_mfma_f32_16x16x32_bf16 a[0:3], a[224:227], v[176:179], a[0:3]
    s_add_u32 m0, s25, 49152
    ds_read_b128 a[192:195], v216 offset:16384
    v_cvt_pk_bf16_f32 v173, v110, v111
    v_mfma_f32_16x16x32_bf16 a[4:7], a[224:227], v[180:183], a[4:7]
    v_exp_f32 v112, v112
    v_mfma_f32_16x16x32_bf16 a[8:11], a[224:227], v[184:187], a[8:11]
    buffer_load_dwordx4 v228, s[8:11], s40 offen offset:0 lds
    v_mfma_f32_16x16x32_bf16 a[12:15], a[224:227], v[188:191], a[12:15]
    v_exp_f32 v113, v113
    v_mfma_f32_16x16x32_bf16 a[16:19], a[228:231], v[176:179], a[16:19]
    ds_read_b128 a[196:199], v217 offset:16384
    v_cvt_pk_bf16_f32 v162, v112, v113
    v_mfma_f32_16x16x32_bf16 a[20:23], a[228:231], v[180:183], a[20:23]
    v_exp_f32 v114, v114
    v_mfma_f32_16x16x32_bf16 a[24:27], a[228:231], v[184:187], a[24:27]
    v_mfma_f32_16x16x32_bf16 a[28:31], a[228:231], v[188:191], a[28:31]
    v_exp_f32 v115, v115
    v_mfma_f32_16x16x32_bf16 a[32:35], a[232:235], v[176:179], a[32:35]
    ds_read_b128 a[200:203], v218 offset:16384
    v_cvt_pk_bf16_f32 v163, v114, v115
    v_mfma_f32_16x16x32_bf16 a[36:39], a[232:235], v[180:183], a[36:39]
    v_exp_f32 v116, v116
    v_mfma_f32_16x16x32_bf16 a[40:43], a[232:235], v[184:187], a[40:43]
    buffer_load_dwordx4 v229, s[8:11], s40 offen offset:1024 lds
    v_mfma_f32_16x16x32_bf16 a[44:47], a[232:235], v[188:191], a[44:47]
    v_exp_f32 v117, v117
    v_mfma_f32_16x16x32_bf16 a[48:51], a[236:239], v[176:179], a[48:51]
    ds_read_b128 a[204:207], v219 offset:16384
    v_cvt_pk_bf16_f32 v166, v116, v117
    v_mfma_f32_16x16x32_bf16 a[52:55], a[236:239], v[180:183], a[52:55]
    v_exp_f32 v118, v118
    v_mfma_f32_16x16x32_bf16 a[56:59], a[236:239], v[184:187], a[56:59]
    s_waitcnt lgkmcnt(4)
    v_mfma_f32_16x16x32_bf16 a[60:63], a[236:239], v[188:191], a[60:63]
    v_exp_f32 v119, v119
    v_mfma_f32_16x16x32_bf16 a[64:67], a[240:243], v[176:179], a[64:67]
    ds_read_b128 a[208:211], v216 offset:20480
    v_cvt_pk_bf16_f32 v167, v118, v119
    v_mfma_f32_16x16x32_bf16 a[68:71], a[240:243], v[180:183], a[68:71]
    v_exp_f32 v120, v120
    v_mfma_f32_16x16x32_bf16 a[72:75], a[240:243], v[184:187], a[72:75]
    buffer_load_dwordx4 v230, s[8:11], s40 offen offset:2048 lds
    v_mfma_f32_16x16x32_bf16 a[76:79], a[240:243], v[188:191], a[76:79]
    v_exp_f32 v121, v121
    v_mfma_f32_16x16x32_bf16 a[80:83], a[244:247], v[176:179], a[80:83]
    ds_read_b128 a[212:215], v217 offset:20480
    v_cvt_pk_bf16_f32 v170, v120, v121
    v_mfma_f32_16x16x32_bf16 a[84:87], a[244:247], v[180:183], a[84:87]
    v_exp_f32 v122, v122
    v_mfma_f32_16x16x32_bf16 a[88:91], a[244:247], v[184:187], a[88:91]
    v_mfma_f32_16x16x32_bf16 a[92:95], a[244:247], v[188:191], a[92:95]
    v_exp_f32 v123, v123
    v_mfma_f32_16x16x32_bf16 a[96:99], a[248:251], v[176:179], a[96:99]
    ds_read_b128 a[216:219], v218 offset:20480
    v_cvt_pk_bf16_f32 v171, v122, v123
    v_mfma_f32_16x16x32_bf16 a[100:103], a[248:251], v[180:183], a[100:103]
    v_exp_f32 v124, v124
    v_mfma_f32_16x16x32_bf16 a[104:107], a[248:251], v[184:187], a[104:107]
    buffer_load_dwordx4 v231, s[8:11], s40 offen offset:3072 lds
    v_mfma_f32_16x16x32_bf16 a[108:111], a[248:251], v[188:191], a[108:111]
    v_exp_f32 v125, v125
    v_mfma_f32_16x16x32_bf16 a[112:115], a[252:255], v[176:179], a[112:115]
    ds_read_b128 a[220:223], v219 offset:20480
    v_cvt_pk_bf16_f32 v174, v124, v125
    v_mfma_f32_16x16x32_bf16 a[116:119], a[252:255], v[180:183], a[116:119]
    v_exp_f32 v126, v126
    v_mfma_f32_16x16x32_bf16 a[120:123], a[252:255], v[184:187], a[120:123]
    s_add_u32 s40, s40, 16384
    s_waitcnt lgkmcnt(4)
    v_mfma_f32_16x16x32_bf16 a[124:127], a[252:255], v[188:191], a[124:127]
    v_exp_f32 v127, v127
    v_mfma_f32_16x16x32_bf16 a[128:131], a[144:147], v[176:179], a[128:131]
    v_mfma_f32_16x16x32_bf16 a[132:135], a[144:147], v[180:183], a[132:135]
    v_mfma_f32_16x16x32_bf16 a[136:139], a[144:147], v[184:187], a[136:139]
    v_mfma_f32_16x16x32_bf16 a[140:143], a[144:147], v[188:191], a[140:143]
    s_add_u32 s28, s28, 1
    s_branch k_attn_loop
k_rank:
    s_mov_b64 exec, 1
    s_cmp_eq_u32 s48, 5
    s_cbranch_scc0 k_rank2
    global_atomic_add v255, v253, v254, s[44:45] sc0 sc1
    s_add_u32 s48, s48, 1
    s_mov_b64 exec, -1
    s_branch k_rank_done
k_rank2:
    v_readfirstlane_b32 s3, v255
    s_mov_b32 s48, 99
    s_cmp_eq_u32 s3, -1
    s_cbranch_scc0 k_rank3
    s_waitcnt vmcnt(0)
k_rank3:
    v_add_u32 v254, 1, v255
    global_store_dword v252, v254, s[44:45] sc1
    s_mov_b64 exec, -1
    s_branch k_rank_done
k_attn_tail:
    ds_read_b64_tr_b16 a[224:225], v220 offset:49152
    ds_read_b64_tr_b16 a[226:227], v220 offset:53248
    ds_read_b64_tr_b16 a[228:229], v221 offset:49152
    ds_read_b64_tr_b16 a[230:231], v221 offset:53248
    ds_read_b64_tr_b16 a[232:233], v222 offset:49152
    ds_read_b64_tr_b16 a[234:235], v222 offset:53248
    ds_read_b64_tr_b16 a[236:237], v223 offset:49152
    ds_read_b64_tr_b16 a[238:239], v223 offset:53248
    ds_read_b64_tr_b16 a[240:241], v224 offset:49152
    ds_read_b64_tr_b16 a[242:243], v224 offset:53248
    ds_read_b64_tr_b16 a[244:245], v225 offset:49152
    ds_read_b64_tr_b16 a[246:247], v225 offset:53248
    ds_read_b64_tr_b16 a[248:249], v226 offset:49152
    ds_read_b64_tr_b16 a[250:251], v226 offset:53248
    ds_read_b64_tr_b16 a[252:253], v227 offset:49152
    ds_read_b64_tr_b16 a[254:255], v227 offset:53248
    v_cvt_pk_bf16_f32 v175, v126, v127
    s_waitcnt lgkmcnt(0)
    v_mfma_f32_16x16x32_bf16 a[0:3], a[224:227], v[160:163], a[0:3]
    v_exp_f32 v128, v128
    v_mfma_f32_16x16x32_bf16 a[4:7], a[224:227], v[164:167], a[4:7]
    v_exp_f32 v129, v129
    v_mfma_f32_16x16x32_bf16 a[8:11], a[224:227], v[168:171], a[8:11]
    v_cvt_pk_bf16_f32 v176, v128, v129
    v_exp_f32 v130, v130
    v_mfma_f32_16x16x32_bf16 a[12:15], a[224:227], v[172:175], a[12:15]
    ds_read_b64_tr_b16 a[226:227], v220 offset:61440
    ds_read_b64_tr_b16 a[224:225], v220 offset:57344
    v_exp_f32 v131, v131
    v_mfma_f32_16x16x32_bf16 a[16:19], a[228:231], v[160:163], a[16:19]
    v_cvt_pk_bf16_f32 v177, v130, v131
    v_exp_f32 v132, v132
    v_mfma_f32_16x16x32_bf16 a[20:23], a[228:231], v[164:167], a[20:23]
    v_exp_f32 v133, v133
    v_mfma_f32_16x16x32_bf16 a[24:27], a[228:231], v[168:171], a[24:27]
    v_cvt_pk_bf16_f32 v180, v132, v133
    v_exp_f32 v134, v134
    v_mfma_f32_16x16x32_bf16 a[28:31], a[228:231], v[172:175], a[28:31]
    ds_read_b64_tr_b16 a[230:231], v221 offset:61440
    ds_read_b64_tr_b16 a[228:229], v221 offset:57344
    v_exp_f32 v135, v135
    v_mfma_f32_16x16x32_bf16 a[32:35], a[232:235], v[160:163], a[32:35]
    v_cvt_pk_bf16_f32 v181, v134, v135
    v_exp_f32 v136, v136
    v_mfma_f32_16x16x32_bf16 a[36:39], a[232:235], v[164:167], a[36:39]
    v_exp_f32 v137, v137
    v_mfma_f32_16x16x32_bf16 a[40:43], a[232:235], v[168:171], a[40:43]
    v_cvt_pk_bf16_f32 v184, v136, v137
    v_exp_f32 v138, v138
    v_mfma_f32_16x16x32_bf16 a[44:47], a[232:235], v[172:175], a[44:47]
    ds_read_b64_tr_b16 a[234:235], v222 offset:61440
    ds_read_b64_tr_b16 a[232:233], v222 offset:57344
    v_exp_f32 v139, v139
    v_mfma_f32_16x16x32_bf16 a[48:51], a[236:239], v[160:163], a[48:51]
    v_cvt_pk_bf16_f32 v185, v138, v139
    v_exp_f32 v140, v140
    v_mfma_f32_16x16x32_bf16 a[52:55], a[236:239], v[164:167], a[52:55]
    v_exp_f32 v141, v141
    v_mfma_f32_16x16x32_bf16 a[56:59], a[236:239], v[168:171], a[56:59]
    v_cvt_pk_bf16_f32 v188, v140, v141
    v_exp_f32 v142, v142
    v_mfma_f32_16x16x32_bf16 a[60:63], a[236:239], v[172:175], a[60:63]
    ds_read_b64_tr_b16 a[238:239], v223 offset:61440
    ds_read_b64_tr_b16 a[236:237], v223 offset:57344
    v_exp_f32 v143, v143
    v_mfma_f32_16x16x32_bf16 a[64:67], a[240:243], v[160:163], a[64:67]
    v_cvt_pk_bf16_f32 v189, v142, v143
    v_exp_f32 v144, v144
    v_mfma_f32_16x16x32_bf16 a[68:71], a[240:243], v[164:167], a[68:71]
    v_exp_f32 v145, v145
    v_mfma_f32_16x16x32_bf16 a[72:75], a[240:243], v[168:171], a[72:75]
    v_cvt_pk_bf16_f32 v178, v144, v145
    v_exp_f32 v146, v146
    v_mfma_f32_16x16x32_bf16 a[76:79], a[240:243], v[172:175], a[76:79]
    ds_read_b64_tr_b16 a[242:243], v224 offset:61440
    ds_read_b64_tr_b16 a[240:241], v224 offset:57344
    v_exp_f32 v147, v147
    v_mfma_f32_16x16x32_bf16 a[80:83], a[244:247], v[160:163], a[80:83]
    v_cvt_pk_bf16_f32 v179, v146, v147
    v_exp_f32 v148, v148
    v_mfma_f32_16x16x32_bf16 a[84:87], a[244:247], v[164:167], a[84:87]
    v_exp_f32 v149, v149
    v_mfma_f32_16x16x32_bf16 a[88:91], a[244:247], v[168:171], a[88:91]
    v_cvt_pk_bf16_f32 v182, v148, v149
    v_exp_f32 v150, v150
    v_mfma_f32_16x16x32_bf16 a[92:95], a[244:247], v[172:175], a[92:95]
    ds_read_b64_tr_b16 a[246:247], v225 offset:61440
    ds_read_b64_tr_b16 a[244:245], v225 offset:57344
    v_exp_f32 v151, v151
    v_mfma_f32_16x16x32_bf16 a[96:99], a[248:251], v[160:163], a[96:99]
    v_cvt_pk_bf16_f32 v183, v150, v151
    v_exp_f32 v152, v152
    v_mfma_f32_16x16x32_bf16 a[100:103], a[248:251], v[164:167], a[100:103]
    v_exp_f32 v153, v153
    v_mfma_f32_16x16x32_bf16 a[104:107], a[248:251], v[168:171], a[104:107]
    v_cvt_pk_bf16_f32 v186, v152, v153
    v_exp_f32 v154, v154
    v_mfma_f32_16x16x32_bf16 a[108:111], a[248:251], v[172:175], a[108:111]
    ds_read_b64_tr_b16 a[250:251], v226 offset:61440
    ds_read_b64_tr_b16 a[248:249], v226 offset:57344
    v_exp_f32 v155, v155
    v_mfma_f32_16x16x32_bf16 a[112:115], a[252:255], v[160:163], a[112:115]
    v_cvt_pk_bf16_f32 v187, v154, v155
    v_exp_f32 v156, v156
    v_mfma_f32_16x16x32_bf16 a[116:119], a[252:255], v[164:167], a[116:119]
    v_exp_f32 v157, v157
    v_mfma_f32_16x16x32_bf16 a[120:123], a[252:255], v[168:171], a[120:123]
    v_cvt_pk_bf16_f32 v190, v156, v157
    v_exp_f32 v158, v158
    v_mfma_f32_16x16x32_bf16 a[124:127], a[252:255], v[172:175], a[124:127]
    ds_read_b64_tr_b16 a[254:255], v227 offset:61440
    ds_read_b64_tr_b16 a[252:253], v227 offset:57344
    v_exp_f32 v159, v159
    v_mfma_f32_16x16x32_bf16 a[128:131], a[144:147], v[160:163], a[128:131]
    v_mfma_f32_16x16x32_bf16 a[132:135], a[144:147], v[164:167], a[132:135]
    v_mfma_f32_16x16x32_bf16 a[136:139], a[144:147], v[168:171], a[136:139]
    v_mfma_f32_16x16x32_bf16 a[140:143], a[144:147], v[172:175], a[140:143]
    s_nop 0
    v_cvt_pk_bf16_f32 v191, v158, v159
    s_waitcnt lgkmcnt(0)
    s_nop 0
    v_mfma_f32_16x16x32_bf16 a[128:131], a[144:147], v[176:179], a[128:131]
    v_mfma_f32_16x16x32_bf16 a[132:135], a[144:147], v[180:183], a[132:135]
    v_mfma_f32_16x16x32_bf16 a[136:139], a[144:147], v[184:187], a[136:139]
    v_mfma_f32_16x16x32_bf16 a[140:143], a[144:147], v[188:191], a[140:143]
    v_mfma_f32_16x16x32_bf16 a[0:3], a[224:227], v[176:179], a[0:3]
    v_mfma_f32_16x16x32_bf16 a[4:7], a[224:227], v[180:183], a[4:7]
    v_mfma_f32_16x16x32_bf16 a[8:11], a[224:227], v[184:187], a[8:11]
    v_mfma_f32_16x16x32_bf16 a[12:15], a[224:227], v[188:191], a[12:15]
    v_mfma_f32_16x16x32_bf16 a[16:19], a[228:231], v[176:179], a[16:19]
    v_mfma_f32_16x16x32_bf16 a[20:23], a[228:231], v[180:183], a[20:23]
    v_accvgpr_read_b32 v208, a128
    v_accvgpr_read_b32 v209, a132
    v_mfma_f32_16x16x32_bf16 a[24:27], a[228:231], v[184:187], a[24:27]
    v_accvgpr_read_b32 v210, a136
    v_accvgpr_read_b32 v211, a140
    v_mfma_f32_16x16x32_bf16 a[28:31], a[228:231], v[188:191], a[28:31]
    s_mov_b32 s29, 0x5d800000
    v_add_f32 v213, v208, v209
    v_add_f32 v214, v210, v211
    v_mfma_f32_16x16x32_bf16 a[32:35], a[232:235], v[176:179], a[32:35]
    v_add_f32 v212, v213, v214
    v_cmp_nge_f32 vcc, s29, v212
    v_mfma_f32_16x16x32_bf16 a[36:39], a[232:235], v[180:183], a[36:39]
    v_rcp_f32 v208, v208
    v_mfma_f32_16x16x32_bf16 a[40:43], a[232:235], v[184:187], a[40:43]
    v_rcp_f32 v209, v209
    v_mfma_f32_16x16x32_bf16 a[44:47], a[232:235], v[188:191], a[44:47]
    v_rcp_f32 v210, v210
    v_mfma_f32_16x16x32_bf16 a[48:51], a[236:239], v[176:179], a[48:51]
    v_rcp_f32 v211, v211
    v_mfma_f32_16x16x32_bf16 a[52:55], a[236:239], v[180:183], a[52:55]
    s_cmp_lg_u64 vcc, 0
    s_cselect_b32 s42, 1, 0
    v_mfma_f32_16x16x32_bf16 a[56:59], a[236:239], v[184:187], a[56:59]
    v_accvgpr_read_b32 v96, a0
    v_accvgpr_read_b32 v97, a1
    v_mfma_f32_16x16x32_bf16 a[60:63], a[236:239], v[188:191], a[60:63]
    v_accvgpr_read_b32 v98, a2
    v_accvgpr_read_b32 v99, a3
    v_mfma_f32_16x16x32_bf16 a[64:67], a[240:243], v[176:179], a[64:67]
    v_accvgpr_read_b32 v100, a4
    v_accvgpr_read_b32 v101, a5
    v_mfma_f32_16x16x32_bf16 a[68:71], a[240:243], v[180:183], a[68:71]
    v_accvgpr_read_b32 v102, a6
    v_accvgpr_read_b32 v103, a7
    v_mfma_f32_16x16x32_bf16 a[72:75], a[240:243], v[184:187], a[72:75]
    v_accvgpr_read_b32 v104, a8
    v_accvgpr_read_b32 v105, a9
    v_mfma_f32_16x16x32_bf16 a[76:79], a[240:243], v[188:191], a[76:79]
    v_accvgpr_read_b32 v106, a10
    v_accvgpr_read_b32 v107, a11
    v_mfma_f32_16x16x32_bf16 a[80:83], a[244:247], v[176:179], a[80:83]
    v_accvgpr_read_b32 v108, a12
    v_accvgpr_read_b32 v109, a13
    v_mfma_f32_16x16x32_bf16 a[84:87], a[244:247], v[180:183], a[84:87]
    v_accvgpr_read_b32 v110, a14
    v_accvgpr_read_b32 v111, a15
    v_mfma_f32_16x16x32_bf16 a[88:91], a[244:247], v[184:187], a[88:91]
    v_accvgpr_read_b32 v112, a16
    v_accvgpr_read_b32 v113, a17
    v_mfma_f32_16x16x32_bf16 a[92:95], a[244:247], v[188:191], a[92:95]
    v_accvgpr_read_b32 v114, a18
    v_accvgpr_read_b32 v115, a19
    v_mfma_f32_16x16x32_bf16 a[96:99], a[248:251], v[176:179], a[96:99]
    v_accvgpr_read_b32 v116, a20
    v_accvgpr_read_b32 v117, a21
    v_mfma_f32_16x16x32_bf16 a[100:103], a[248:251], v[180:183], a[100:103]
    v_accvgpr_read_b32 v118, a22
    v_accvgpr_read_b32 v119, a23
    v_mfma_f32_16x16x32_bf16 a[104:107], a[248:251], v[184:187], a[104:107]
    v_accvgpr_read_b32 v120, a24
    v_accvgpr_read_b32 v121, a25
    v_mfma_f32_16x16x32_bf16 a[108:111], a[248:251], v[188:191], a[108:111]
    v_accvgpr_read_b32 v122, a26
    v_accvgpr_read_b32 v123, a27
    v_mfma_f32_16x16x32_bf16 a[112:115], a[252:255], v[176:179], a[112:115]
    v_accvgpr_read_b32 v124, a28
    v_accvgpr_read_b32 v125, a29
    v_mfma_f32_16x16x32_bf16 a[116:119], a[252:255], v[180:183], a[116:119]
    v_accvgpr_read_b32 v126, a30
    v_accvgpr_read_b32 v127, a31
    v_mfma_f32_16x16x32_bf16 a[120:123], a[252:255], v[184:187], a[120:123]
    v_mfma_f32_16x16x32_bf16 a[124:127], a[252:255], v[188:191], a[124:127]
    v_pk_mul_f32 v[96:97], v[96:97], v[208:209] op_sel:[0,0] op_sel_hi:[1,0]
    v_pk_mul_f32 v[98:99], v[98:99], v[208:209] op_sel:[0,0] op_sel_hi:[1,0]
    v_pk_mul_f32 v[100:101], v[100:101], v[208:209] op_sel:[0,1] op_sel_hi:[1,1]
    v_pk_mul_f32 v[102:103], v[102:103], v[208:209] op_sel:[0,1] op_sel_hi:[1,1]
    v_pk_mul_f32 v[104:105], v[104:105], v[210:211] op_sel:[0,0] op_sel_hi:[1,0]
    v_pk_mul_f32 v[106:107], v[106:107], v[210:211] op_sel:[0,0] op_sel_hi:[1,0]
    v_pk_mul_f32 v[108:109], v[108:109], v[210:211] op_sel:[0,1] op_sel_hi:[1,1]
    v_pk_mul_f32 v[110:111], v[110:111], v[210:211] op_sel:[0,1] op_sel_hi:[1,1]
    v_pk_mul_f32 v[112:113], v[112:113], v[208:209] op_sel:[0,0] op_sel_hi:[1,0]
    v_pk_mul_f32 v[114:115], v[114:115], v[208:209] op_sel:[0,0] op_sel_hi:[1,0]
    v_pk_mul_f32 v[116:117], v[116:117], v[208:209] op_sel:[0,1] op_sel_hi:[1,1]
    v_pk_mul_f32 v[118:119], v[118:119], v[208:209] op_sel:[0,1] op_sel_hi:[1,1]
    v_pk_mul_f32 v[120:121], v[120:121], v[210:211] op_sel:[0,0] op_sel_hi:[1,0]
    v_pk_mul_f32 v[122:123], v[122:123], v[210:211] op_sel:[0,0] op_sel_hi:[1,0]
    v_pk_mul_f32 v[124:125], v[124:125], v[210:211] op_sel:[0,1] op_sel_hi:[1,1]
    v_pk_mul_f32 v[126:127], v[126:127], v[210:211] op_sel:[0,1] op_sel_hi:[1,1]
    v_cvt_pk_bf16_f32 v128, v96, v97
    v_cvt_pk_bf16_f32 v129, v98, v99
    v_cvt_pk_bf16_f32 v130, v112, v113
    v_cvt_pk_bf16_f32 v131, v114, v115
    buffer_store_dwordx4 v[128:131], v6, s[36:39], s93 offen offset:0 sc1
    v_cvt_pk_bf16_f32 v132, v100, v101
    v_cvt_pk_bf16_f32 v133, v102, v103
    v_cvt_pk_bf16_f32 v134, v116, v117
    v_cvt_pk_bf16_f32 v135, v118, v119
    buffer_store_dwordx4 v[132:135], v6, s[36:39], s94 offen offset:0 sc1
    v_cvt_pk_bf16_f32 v136, v104, v105
    v_cvt_pk_bf16_f32 v137, v106, v107
    v_cvt_pk_bf16_f32 v138, v120, v121
    v_cvt_pk_bf16_f32 v139, v122, v123
    buffer_store_dwordx4 v[136:139], v6, s[36:39], s95 offen offset:0 sc1
    v_cvt_pk_bf16_f32 v140, v108, v109
    v_cvt_pk_bf16_f32 v141, v110, v111
    v_cvt_pk_bf16_f32 v142, v124, v125
    v_cvt_pk_bf16_f32 v143, v126, v127
    buffer_store_dwordx4 v[140:143], v6, s[36:39], s96 offen offset:0 sc1
    s_branch k_attn_epi2
k_slow:
    s_waitcnt vmcnt(0) lgkmcnt(0)
    s_mov_b32 s42, 0
    v_accvgpr_write_b32 a0, 0
    v_accvgpr_write_b32 a1, 0
    v_accvgpr_write_b32 a2, 0
    v_accvgpr_write_b32 a3, 0
    v_accvgpr_write_b32 a4, 0
    v_accvgpr_write_b32 a5, 0
    v_accvgpr_write_b32 a6, 0
    v_accvgpr_write_b32 a7, 0
    v_accvgpr_write_b32 a8, 0
    v_accvgpr_write_b32 a9, 0
    v_accvgpr_write_b32 a10, 0
    v_accvgpr_write_b32 a11, 0
    v_accvgpr_write_b32 a12, 0
    v_accvgpr_write_b32 a13, 0
    v_accvgpr_write_b32 a14, 0
    v_accvgpr_write_b32 a15, 0
    v_accvgpr_write_b32 a16, 0
    v_accvgpr_write_b32 a17, 0
    v_accvgpr_write_b32 a18, 0
    v_accvgpr_write_b32 a19, 0
    v_accvgpr_write_b32 a20, 0
    v_accvgpr_write_b32 a21, 0
    v_accvgpr_write_b32 a22, 0
    v_accvgpr_write_b32 a23, 0
    v_accvgpr_write_b32 a24, 0
    v_accvgpr_write_b32 a25, 0
    v_accvgpr_write_b32 a26, 0
    v_accvgpr_write_b32 a27, 0
    v_accvgpr_write_b32 a28, 0
    v_accvgpr_write_b32 a29, 0
    v_accvgpr_write_b32 a30, 0
    v_accvgpr_write_b32 a31, 0
    v_accvgpr_write_b32 a32, 0
    v_accvgpr_write_b32 a33, 0
    v_accvgpr_write_b32 a34, 0
    v_accvgpr_write_b32 a35, 0
    v_accvgpr_write_b32 a36, 0
    v_accvgpr_write_b32 a37, 0
    v_accvgpr_write_b32 a38, 0
    v_accvgpr_write_b32 a39, 0
    v_accvgpr_write_b32 a40, 0
    v_accvgpr_write_b32 a41, 0
    v_accvgpr_write_b32 a42, 0
    v_accvgpr_write_b32 a43, 0
    v_accvgpr_write_b32 a44, 0
    v_accvgpr_write_b32 a45, 0
    v_accvgpr_write_b32 a46, 0
    v_accvgpr_write_b32 a47, 0
    v_accvgpr_write_b32 a48, 0
    v_accvgpr_write_b32 a49, 0
    v_accvgpr_write_b32 a50, 0
    v_accvgpr_write_b32 a51, 0
    v_accvgpr_write_b32 a52, 0
    v_accvgpr_write_b32 a53, 0
    v_accvgpr_write_b32 a54, 0
    v_accvgpr_write_b32 a55, 0
    v_accvgpr_write_b32 a56, 0
    v_accvgpr_write_b32 a57, 0
    v_accvgpr_write_b32 a58, 0
    v_accvgpr_write_b32 a59, 0
    v_accvgpr_write_b32 a60, 0
    v_accvgpr_write_b32 a61, 0
    v_accvgpr_write_b32 a62, 0
    v_accvgpr_write_b32 a63, 0
    v_accvgpr_write_b32 a64, 0
    v_accvgpr_write_b32 a65, 0
    v_accvgpr_write_b32 a66, 0
    v_accvgpr_write_b32 a67, 0
    v_accvgpr_write_b32 a68, 0
    v_accvgpr_write_b32 a69, 0
    v_accvgpr_write_b32 a70, 0
    v_accvgpr_write_b32 a71, 0
    v_accvgpr_write_b32 a72, 0
    v_accvgpr_write_b32 a73, 0
    v_accvgpr_write_b32 a74, 0
    v_accvgpr_write_b32 a75, 0
    v_accvgpr_write_b32 a76, 0
    v_accvgpr_write_b32 a77, 0
    v_accvgpr_write_b32 a78, 0
    v_accvgpr_write_b32 a79, 0
    v_accvgpr_write_b32 a80, 0
    v_accvgpr_write_b32 a81, 0
    v_accvgpr_write_b32 a82, 0
    v_accvgpr_write_b32 a83, 0
    v_accvgpr_write_b32 a84, 0
    v_accvgpr_write_b32 a85, 0
    v_accvgpr_write_b32 a86, 0
    v_accvgpr_write_b32 a87, 0
    v_accvgpr_write_b32 a88, 0
    v_accvgpr_write_b32 a89, 0
    v_accvgpr_write_b32 a90, 0
    v_accvgpr_write_b32 a91, 0
    v_accvgpr_write_b32 a92, 0
    v_accvgpr_write_b32 a93, 0
    v_accvgpr_write_b32 a94, 0
    v_accvgpr_write_b32 a95, 0
    v_accvgpr_write_b32 a96, 0
    v_accvgpr_write_b32 a97, 0
    v_accvgpr_write_b32 a98, 0
    v_accvgpr_write_b32 a99, 0
    v_accvgpr_write_b32 a100, 0
    v_accvgpr_write_b32 a101, 0
    v_accvgpr_write_b32 a102, 0
    v_accvgpr_write_b32 a103, 0
    v_accvgpr_write_b32 a104, 0
    v_accvgpr_write_b32 a105, 0
    v_accvgpr_write_b32 a106, 0
    v_accvgpr_write_b32 a107, 0
    v_accvgpr_write_b32 a108, 0
    v_accvgpr_write_b32 a109, 0
    v_accvgpr_write_b32 a110, 0
    v_accvgpr_write_b32 a111, 0
    v_accvgpr_write_b32 a112, 0
    v_accvgpr_write_b32 a113, 0
    v_accvgpr_write_b32 a114, 0
    v_accvgpr_write_b32 a115, 0
    v_accvgpr_write_b32 a116, 0
    v_accvgpr_write_b32 a117, 0
    v_accvgpr_write_b32 a118, 0
    v_accvgpr_write_b32 a119, 0
    v_accvgpr_write_b32 a120, 0
    v_accvgpr_write_b32 a121, 0
    v_accvgpr_write_b32 a122, 0
    v_accvgpr_write_b32 a123, 0
    v_accvgpr_write_b32 a124, 0
    v_accvgpr_write_b32 a125, 0
    v_accvgpr_write_b32 a126, 0
    v_accvgpr_write_b32 a127, 0
    v_mov_b32 v192, 0xff61b1e6
    v_mov_b32 v208, 0
    v_mov_b32 v193, 0xff61b1e6
    v_mov_b32 v209, 0
    v_mov_b32 v194, 0xff61b1e6
    v_mov_b32 v210, 0
    v_mov_b32 v195, 0xff61b1e6
    v_mov_b32 v211, 0
    s_mov_b32 s40, 0
    s_mov_b32 s41, 0
k_slow_loop:
    s_barrier
    s_add_u32 m0, s25, 0
    s_nop 0
    buffer_load_dwordx4 v228, s[8:11], s40 offen offset:0 lds
    buffer_load_dwordx4 v229, s[8:11], s40 offen offset:1024 lds
    buffer_load_dwordx4 v230, s[8:11], s40 offen offset:2048 lds
    buffer_load_dwordx4 v231, s[8:11], s40 offen offset:3072 lds
    s_add_u32 m0, s25, 65536
    s_nop 0
    buffer_load_dwordx4 v232, s[12:15], s41 offen offset:0 lds
    buffer_load_dwordx4 v233, s[12:15], s41 offen offset:1024 lds
    buffer_load_dwordx4 v232, s[12:15], s41 offen offset:2048 lds
    buffer_load_dwordx4 v233, s[12:15], s41 offen offset:3072 lds
    s_add_u32 s40, s40, 16384
    s_add_u32 s41, s41, 16384
    s_waitcnt vmcnt(0)
    s_barrier
    s_mov_b32 s43, 0
k_slow_half:
    ds_read_b128 a[192:195], v216 offset:0
    ds_read_b128 a[196:199], v217 offset:0
    ds_read_b128 a[200:203], v218 offset:0
    ds_read_b128 a[204:207], v219 offset:0
    ds_read_b128 a[208:211], v216 offset:4096
    ds_read_b128 a[212:215], v217 offset:4096
    ds_read_b128 a[216:219], v218 offset:4096
    ds_read_b128 a[220:223], v219 offset:4096
    ds_read_b64_tr_b16 a[224:225], v220 offset:0
    ds_read_b64_tr_b16 a[226:227], v220 offset:4096
    ds_read_b64_tr_b16 a[228:229], v221 offset:0
    ds_read_b64_tr_b16 a[230:231], v221 offset:4096
    ds_read_b64_tr_b16 a[232:233], v222 offset:0
    ds_read_b64_tr_b16 a[234:235], v222 offset:4096
    ds_read_b64_tr_b16 a[236:237], v223 offset:0
    ds_read_b64_tr_b16 a[238:239], v223 offset:4096
    ds_read_b64_tr_b16 a[240:241], v224 offset:0
    ds_read_b64_tr_b16 a[242:243], v224 offset:4096
    ds_read_b64_tr_b16 a[244:245], v225 offset:0
    ds_read_b64_tr_b16 a[246:247], v225 offset:4096
    ds_read_b64_tr_b16 a[248:249], v226 offset:0
    ds_read_b64_tr_b16 a[250:251], v226 offset:4096
    ds_read_b64_tr_b16 a[252:253], v227 offset:0
    ds_read_b64_tr_b16 a[254:255], v227 offset:4096
    s_waitcnt lgkmcnt(0)
    v_mfma_f32_16x16x32_bf16 v[96:99], a[192:195], v[32:35], 0
    v_mfma_f32_16x16x32_bf16 v[100:103], a[192:195], v[48:51], 0
    v_mfma_f32_16x16x32_bf16 v[104:107], a[192:195], v[64:67], 0
    v_mfma_f32_16x16x32_bf16 v[108:111], a[192:195], v[80:83], 0
    v_mfma_f32_16x16x32_bf16 v[96:99], a[196:199], v[36:39], v[96:99]
    v_mfma_f32_16x16x32_bf16 v[100:103], a[196:199], v[52:55], v[100:103]
    v_mfma_f32_16x16x32_bf16 v[104:107], a[196:199], v[68:71], v[104:107]
    v_mfma_f32_16x16x32_bf16 v[108:111], a[196:199], v[84:87], v[108:111]
    v_mfma_f32_16x16x32_bf16 v[96:99], a[200:203], v[40:43], v[96:99]
    v_mfma_f32_16x16x32_bf16 v[100:103], a[200:203], v[56:59], v[100:103]
    v_mfma_f32_16x16x32_bf16 v[104:107], a[200:203], v[72:75], v[104:107]
    v_mfma_f32_16x16x32_bf16 v[108:111], a[200:203], v[88:91], v[108:111]
    v_mfma_f32_16x16x32_bf16 v[96:99], a[204:207], v[44:47], v[96:99]
    v_mfma_f32_16x16x32_bf16 v[100:103], a[204:207], v[60:63], v[100:103]
    v_mfma_f32_16x16x32_bf16 v[104:107], a[204:207], v[76:79], v[104:107]
    v_mfma_f32_16x16x32_bf16 v[108:111], a[204:207], v[92:95], v[108:111]
    v_mfma_f32_16x16x32_bf16 v[112:115], a[208:211], v[32:35], 0
    v_mfma_f32_16x16x32_bf16 v[116:119], a[208:211], v[48:51], 0
    v_mfma_f32_16x16x32_bf16 v[120:123], a[208:211], v[64:67], 0
    v_mfma_f32_16x16x32_bf16 v[124:127], a[208:211], v[80:83], 0
    v_mfma_f32_16x16x32_bf16 v[112:115], a[212:215], v[36:39], v[112:115]
    v_mfma_f32_16x16x32_bf16 v[116:119], a[212:215], v[52:55], v[116:119]
    v_mfma_f32_16x16x32_bf16 v[120:123], a[212:215], v[68:71], v[120:123]
    v_mfma_f32_16x16x32_bf16 v[124:127], a[212:215], v[84:87], v[124:127]
    v_mfma_f32_16x16x32_bf16 v[112:115], a[216:219], v[40:43], v[112:115]
    v_mfma_f32_16x16x32_bf16 v[116:119], a[216:219], v[56:59], v[116:119]
    v_mfma_f32_16x16x32_bf16 v[120:123], a[216:219], v[72:75], v[120:123]
    v_mfma_f32_16x16x32_bf16 v[124:127], a[216:219], v[88:91], v[124:127]
    v_mfma_f32_16x16x32_bf16 v[112:115], a[220:223], v[44:47], v[112:115]
    v_mfma_f32_16x16x32_bf16 v[116:119], a[220:223], v[60:63], v[116:119]
    v_mfma_f32_16x16x32_bf16 v[120:123], a[220:223], v[76:79], v[120:123]
    v_mfma_f32_16x16x32_bf16 v[124:127], a[220:223], v[92:95], v[124:127]
    v_xor_b32 v216, 0x2000, v216
    v_xor_b32 v217, 0x2000, v217
    v_xor_b32 v218, 0x2000, v218
    v_xor_b32 v219, 0x2000, v219
    v_xor_b32 v220, 0x2000, v220
    v_xor_b32 v221, 0x2000, v221
    v_xor_b32 v222, 0x2000, v222
    v_xor_b32 v223, 0x2000, v223
    v_xor_b32 v224, 0x2000, v224
    v_xor_b32 v225, 0x2000, v225
    v_xor_b32 v226, 0x2000, v226
    v_xor_b32 v227, 0x2000, v227
    v_max3_f32 v212, v96, v97, v192
    v_max3_f32 v213, v100, v101, v193
    v_max3_f32 v214, v104, v105, v194
    v_max3_f32 v215, v108, v109, v195
    v_max3_f32 v212, v98, v99, v212
    v_max3_f32 v213, v102, v103, v213
    v_max3_f32 v214, v106, v107, v214
    v_max3_f32 v215, v110, v111, v215
    v_max3_f32 v212, v112, v113, v212
    v_max3_f32 v213, v116, v117, v213
    v_max3_f32 v214, v120, v121, v214
    v_max3_f32 v215, v124, v125, v215
    v_max3_f32 v212, v114, v115, v212
    v_max3_f32 v213, v118, v119, v213
    v_max3_f32 v214, v122, v123, v214
    v_max3_f32 v215, v126, v127, v215
    v_mov_b32 v234, v212
    v_mov_b32 v235, v213
    v_mov_b32 v236, v214
    v_mov_b32 v237, v215
    s_nop 1
    v_permlane16_swap_b32 v212, v234
    v_permlane16_swap_b32 v213, v235
    v_permlane16_swap_b32 v214, v236
    v_permlane16_swap_b32 v215, v237
    s_nop 1
    v_max_f32 v212, v212, v234
    v_max_f32 v213, v213, v235
    v_max_f32 v214, v214, v236
    v_max_f32 v215, v215, v237
    v_mov_b32 v234, v212
    v_mov_b32 v235, v213
    v_mov_b32 v236, v214
    v_mov_b32 v237, v215
    s_nop 1
    v_permlane32_swap_b32 v212, v234
    v_permlane32_swap_b32 v213, v235
    v_permlane32_swap_b32 v214, v236
    v_permlane32_swap_b32 v215, v237
    s_nop 1
    v_max_f32 v212, v212, v234
    v_max_f32 v213, v213, v235
    v_max_f32 v214, v214, v236
    v_max_f32 v215, v215, v237
    v_sub_f32 v240, v192, v212
    v_sub_f32 v241, v193, v213
    v_sub_f32 v242, v194, v214
    v_sub_f32 v243, v195, v215
    v_exp_f32 v240, v240
    v_exp_f32 v241, v241
    v_exp_f32 v242, v242
    v_exp_f32 v243, v243
    v_mov_b32 v192, v212
    v_mov_b32 v193, v213
    v_mov_b32 v194, v214
    v_mov_b32 v195, v215
    v_mul_f32 v208, v208, v240
    v_mul_f32 v209, v209, v241
    v_mul_f32 v210, v210, v242
    v_mul_f32 v211, v211, v243
    v_sub_f32 v96, v96, v212
    v_sub_f32 v97, v97, v212
    v_sub_f32 v98, v98, v212
    v_sub_f32 v99, v99, v212
    v_sub_f32 v100, v100, v213
    v_sub_f32 v101, v101, v213
    v_sub_f32 v102, v102, v213
    v_sub_f32 v103, v103, v213
    v_sub_f32 v104, v104, v214
    v_sub_f32 v105, v105, v214
    v_sub_f32 v106, v106, v214
    v_sub_f32 v107, v107, v214
    v_sub_f32 v108, v108, v215
    v_sub_f32 v109, v109, v215
    v_sub_f32 v110, v110, v215
    v_sub_f32 v111, v111, v215
    v_sub_f32 v112, v112, v212
    v_sub_f32 v113, v113, v212
    v_sub_f32 v114, v114, v212
    v_sub_f32 v115, v115, v212
    v_sub_f32 v116, v116, v213
    v_sub_f32 v117, v117, v213
    v_sub_f32 v118, v118, v213
    v_sub_f32 v119, v119, v213
    v_sub_f32 v120, v120, v214
    v_sub_f32 v121, v121, v214
    v_sub_f32 v122, v122, v214
    v_sub_f32 v123, v123, v214
    v_sub_f32 v124, v124, v215
    v_sub_f32 v125, v125, v215
    v_sub_f32 v126, v126, v215
    v_sub_f32 v127, v127, v215
    v_exp_f32 v96, v96
    v_exp_f32 v97, v97
    v_exp_f32 v98, v98
    v_exp_f32 v99, v99
    v_exp_f32 v100, v100
    v_exp_f32 v101, v101
    v_exp_f32 v102, v102
    v_exp_f32 v103, v103
    v_exp_f32 v104, v104
    v_exp_f32 v105, v105
    v_exp_f32 v106, v106
    v_exp_f32 v107, v107
    v_exp_f32 v108, v108
    v_exp_f32 v109, v109
    v_exp_f32 v110, v110
    v_exp_f32 v111, v111
    v_exp_f32 v112, v112
    v_exp_f32 v113, v113
    v_exp_f32 v114, v114
    v_exp_f32 v115, v115
    v_exp_f32 v116, v116
    v_exp_f32 v117, v117
    v_exp_f32 v118, v118
    v_exp_f32 v119, v119
    v_exp_f32 v120, v120
    v_exp_f32 v121, v121
    v_exp_f32 v122, v122
    v_exp_f32 v123, v123
    v_exp_f32 v124, v124
    v_exp_f32 v125, v125
    v_exp_f32 v126, v126
    v_exp_f32 v127, v127
    s_nop 0
    v_add_f32 v208, v208, v96
    v_add_f32 v208, v208, v97
    v_cvt_pk_bf16_f32 v160, v96, v97
    v_add_f32 v208, v208, v98
    v_add_f32 v208, v208, v99
    v_cvt_pk_bf16_f32 v161, v98, v99
    v_add_f32 v209, v209, v100
    v_add_f32 v209, v209, v101
    v_cvt_pk_bf16_f32 v164, v100, v101
    v_add_f32 v209, v209, v102
    v_add_f32 v209, v209, v103
    v_cvt_pk_bf16_f32 v165, v102, v103
    v_add_f32 v210, v210, v104
    v_add_f32 v210, v210, v105
    v_cvt_pk_bf16_f32 v168, v104, v105
    v_add_f32 v210, v210, v106
    v_add_f32 v210, v210, v107
    v_cvt_pk_bf16_f32 v169, v106, v107
    v_add_f32 v211, v211, v108
    v_add_f32 v211, v211, v109
    v_cvt_pk_bf16_f32 v172, v108, v109
    v_add_f32 v211, v211, v110
    v_add_f32 v211, v211, v111
    v_cvt_pk_bf16_f32 v173, v110, v111
    v_add_f32 v208, v208, v112
    v_add_f32 v208, v208, v113
    v_cvt_pk_bf16_f32 v162, v112, v113
    v_add_f32 v208, v208, v114
    v_add_f32 v208, v208, v115
    v_cvt_pk_bf16_f32 v163, v114, v115
    v_add_f32 v209, v209, v116
    v_add_f32 v209, v209, v117
    v_cvt_pk_bf16_f32 v166, v116, v117
    v_add_f32 v209, v209, v118
    v_add_f32 v209, v209, v119
    v_cvt_pk_bf16_f32 v167, v118, v119
    v_add_f32 v210, v210, v120
    v_add_f32 v210, v210, v121
    v_cvt_pk_bf16_f32 v170, v120, v121
    v_add_f32 v210, v210, v122
    v_add_f32 v210, v210, v123
    v_cvt_pk_bf16_f32 v171, v122, v123
    v_add_f32 v211, v211, v124
    v_add_f32 v211, v211, v125
    v_cvt_pk_bf16_f32 v174, v124, v125
    v_add_f32 v211, v211, v126
    v_add_f32 v211, v211, v127
    v_cvt_pk_bf16_f32 v175, v126, v127
    v_accvgpr_read_b32 v128, a0
    v_accvgpr_read_b32 v129, a1
    v_accvgpr_read_b32 v130, a2
    v_accvgpr_read_b32 v131, a3
    v_accvgpr_read_b32 v132, a4
    v_accvgpr_read_b32 v133, a5
    v_accvgpr_read_b32 v134, a6
    v_accvgpr_read_b32 v135, a7
    v_accvgpr_read_b32 v136, a8
    v_accvgpr_read_b32 v137, a9
    v_accvgpr_read_b32 v138, a10
    v_accvgpr_read_b32 v139, a11
    v_accvgpr_read_b32 v140, a12
    v_accvgpr_read_b32 v141, a13
    v_accvgpr_read_b32 v142, a14
    v_accvgpr_read_b32 v143, a15
    v_mul_f32 v128, v128, v240
    v_mul_f32 v129, v129, v240
    v_mul_f32 v130, v130, v240
    v_mul_f32 v131, v131, v240
    v_mul_f32 v132, v132, v241
    v_mul_f32 v133, v133, v241
    v_mul_f32 v134, v134, v241
    v_mul_f32 v135, v135, v241
    v_mul_f32 v136, v136, v242
    v_mul_f32 v137, v137, v242
    v_mul_f32 v138, v138, v242
    v_mul_f32 v139, v139, v242
    v_mul_f32 v140, v140, v243
    v_mul_f32 v141, v141, v243
    v_mul_f32 v142, v142, v243
    v_mul_f32 v143, v143, v243
    v_accvgpr_write_b32 a0, v128
    v_accvgpr_write_b32 a1, v129
    v_accvgpr_write_b32 a2, v130
    v_accvgpr_write_b32 a3, v131
    v_accvgpr_write_b32 a4, v132
    v_accvgpr_write_b32 a5, v133
    v_accvgpr_write_b32 a6, v134
    v_accvgpr_write_b32 a7, v135
    v_accvgpr_write_b32 a8, v136
    v_accvgpr_write_b32 a9, v137
    v_accvgpr_write_b32 a10, v138
    v_accvgpr_write_b32 a11, v139
    v_accvgpr_write_b32 a12, v140
    v_accvgpr_write_b32 a13, v141
    v_accvgpr_write_b32 a14, v142
    v_accvgpr_write_b32 a15, v143
    v_accvgpr_read_b32 v128, a16
    v_accvgpr_read_b32 v129, a17
    v_accvgpr_read_b32 v130, a18
    v_accvgpr_read_b32 v131, a19
    v_accvgpr_read_b32 v132, a20
    v_accvgpr_read_b32 v133, a21
    v_accvgpr_read_b32 v134, a22
    v_accvgpr_read_b32 v135, a23
    v_accvgpr_read_b32 v136, a24
    v_accvgpr_read_b32 v137, a25
    v_accvgpr_read_b32 v138, a26
    v_accvgpr_read_b32 v139, a27
    v_accvgpr_read_b32 v140, a28
    v_accvgpr_read_b32 v141, a29
    v_accvgpr_read_b32 v142, a30
    v_accvgpr_read_b32 v143, a31
    v_mul_f32 v128, v128, v240
    v_mul_f32 v129, v129, v240
    v_mul_f32 v130, v130, v240
    v_mul_f32 v131, v131, v240
    v_mul_f32 v132, v132, v241
    v_mul_f32 v133, v133, v241
    v_mul_f32 v134, v134, v241
    v_mul_f32 v135, v135, v241
    v_mul_f32 v136, v136, v242
    v_mul_f32 v137, v137, v242
    v_mul_f32 v138, v138, v242
    v_mul_f32 v139, v139, v242
    v_mul_f32 v140, v140, v243
    v_mul_f32 v141, v141, v243
    v_mul_f32 v142, v142, v243
    v_mul_f32 v143, v143, v243
    v_accvgpr_write_b32 a16, v128
    v_accvgpr_write_b32 a17, v129
    v_accvgpr_write_b32 a18, v130
    v_accvgpr_write_b32 a19, v131
    v_accvgpr_write_b32 a20, v132
    v_accvgpr_write_b32 a21, v133
    v_accvgpr_write_b32 a22, v134
    v_accvgpr_write_b32 a23, v135
    v_accvgpr_write_b32 a24, v136
    v_accvgpr_write_b32 a25, v137
    v_accvgpr_write_b32 a26, v138
    v_accvgpr_write_b32 a27, v139
    v_accvgpr_write_b32 a28, v140
    v_accvgpr_write_b32 a29, v141
    v_accvgpr_write_b32 a30, v142
    v_accvgpr_write_b32 a31, v143
    v_accvgpr_read_b32 v128, a32
    v_accvgpr_read_b32 v129, a33
    v_accvgpr_read_b32 v130, a34
    v_accvgpr_read_b32 v131, a35
    v_accvgpr_read_b32 v132, a36
    v_accvgpr_read_b32 v133, a37
    v_accvgpr_read_b32 v134, a38
    v_accvgpr_read_b32 v135, a39
    v_accvgpr_read_b32 v136, a40
    v_accvgpr_read_b32 v137, a41
    v_accvgpr_read_b32 v138, a42
    v_accvgpr_read_b32 v139, a43
    v_accvgpr_read_b32 v140, a44
    v_accvgpr_read_b32 v141, a45
    v_accvgpr_read_b32 v142, a46
    v_accvgpr_read_b32 v143, a47
    v_mul_f32 v128, v128, v240
    v_mul_f32 v129, v129, v240
    v_mul_f32 v130, v130, v240
    v_mul_f32 v131, v131, v240
    v_mul_f32 v132, v132, v241
    v_mul_f32 v133, v133, v241
    v_mul_f32 v134, v134, v241
    v_mul_f32 v135, v135, v241
    v_mul_f32 v136, v136, v242
    v_mul_f32 v137, v137, v242
    v_mul_f32 v138, v138, v242
    v_mul_f32 v139, v139, v242
    v_mul_f32 v140, v140, v243
    v_mul_f32 v141, v141, v243
    v_mul_f32 v142, v142, v243
    v_mul_f32 v143, v143, v243
    v_accvgpr_write_b32 a32, v128
    v_accvgpr_write_b32 a33, v129
    v_accvgpr_write_b32 a34, v130
    v_accvgpr_write_b32 a35, v131
    v_accvgpr_write_b32 a36, v132
    v_accvgpr_write_b32 a37, v133
    v_accvgpr_write_b32 a38, v134
    v_accvgpr_write_b32 a39, v135
    v_accvgpr_write_b32 a40, v136
    v_accvgpr_write_b32 a41, v137
    v_accvgpr_write_b32 a42, v138
    v_accvgpr_write_b32 a43, v139
    v_accvgpr_write_b32 a44, v140
    v_accvgpr_write_b32 a45, v141
    v_accvgpr_write_b32 a46, v142
    v_accvgpr_write_b32 a47, v143
    v_accvgpr_read_b32 v128, a48
    v_accvgpr_read_b32 v129, a49
    v_accvgpr_read_b32 v130, a50
    v_accvgpr_read_b32 v131, a51
    v_accvgpr_read_b32 v132, a52
    v_accvgpr_read_b32 v133, a53
    v_accvgpr_read_b32 v134, a54
    v_accvgpr_read_b32 v135, a55
    v_accvgpr_read_b32 v136, a56
    v_accvgpr_read_b32 v137, a57
    v_accvgpr_read_b32 v138, a58
    v_accvgpr_read_b32 v139, a59
    v_accvgpr_read_b32 v140, a60
    v_accvgpr_read_b32 v141, a61
    v_accvgpr_read_b32 v142, a62
    v_accvgpr_read_b32 v143, a63
    v_mul_f32 v128, v128, v240
    v_mul_f32 v129, v129, v240
    v_mul_f32 v130, v130, v240
    v_mul_f32 v131, v131, v240
    v_mul_f32 v132, v132, v241
    v_mul_f32 v133, v133, v241
    v_mul_f32 v134, v134, v241
    v_mul_f32 v135, v135, v241
    v_mul_f32 v136, v136, v242
    v_mul_f32 v137, v137, v242
    v_mul_f32 v138, v138, v242
    v_mul_f32 v139, v139, v242
    v_mul_f32 v140, v140, v243
    v_mul_f32 v141, v141, v243
    v_mul_f32 v142, v142, v243
    v_mul_f32 v143, v143, v243
    v_accvgpr_write_b32 a48, v128
    v_accvgpr_write_b32 a49, v129
    v_accvgpr_write_b32 a50, v130
    v_accvgpr_write_b32 a51, v131
    v_accvgpr_write_b32 a52, v132
    v_accvgpr_write_b32 a53, v133
    v_accvgpr_write_b32 a54, v134
    v_accvgpr_write_b32 a55, v135
    v_accvgpr_write_b32 a56, v136
    v_accvgpr_write_b32 a57, v137
    v_accvgpr_write_b32 a58, v138
    v_accvgpr_write_b32 a59, v139
    v_accvgpr_write_b32 a60, v140
    v_accvgpr_write_b32 a61, v141
    v_accvgpr_write_b32 a62, v142
    v_accvgpr_write_b32 a63, v143
    v_accvgpr_read_b32 v128, a64
    v_accvgpr_read_b32 v129, a65
    v_accvgpr_read_b32 v130, a66
    v_accvgpr_read_b32 v131, a67
    v_accvgpr_read_b32 v132, a68
    v_accvgpr_read_b32 v133, a69
    v_accvgpr_read_b32 v134, a70
    v_accvgpr_read_b32 v135, a71
    v_accvgpr_read_b32 v136, a72
    v_accvgpr_read_b32 v137, a73
    v_accvgpr_read_b32 v138, a74
    v_accvgpr_read_b32 v139, a75
    v_accvgpr_read_b32 v140, a76
    v_accvgpr_read_b32 v141, a77
    v_accvgpr_read_b32 v142, a78
    v_accvgpr_read_b32 v143, a79
    v_mul_f32 v128, v128, v240
    v_mul_f32 v129, v129, v240
    v_mul_f32 v130, v130, v240
    v_mul_f32 v131, v131, v240
    v_mul_f32 v132, v132, v241
    v_mul_f32 v133, v133, v241
    v_mul_f32 v134, v134, v241
    v_mul_f32 v135, v135, v241
    v_mul_f32 v136, v136, v242
    v_mul_f32 v137, v137, v242
    v_mul_f32 v138, v138, v242
    v_mul_f32 v139, v139, v242
    v_mul_f32 v140, v140, v243
    v_mul_f32 v141, v141, v243
    v_mul_f32 v142, v142, v243
    v_mul_f32 v143, v143, v243
    v_accvgpr_write_b32 a64, v128
    v_accvgpr_write_b32 a65, v129
    v_accvgpr_write_b32 a66, v130
    v_accvgpr_write_b32 a67, v131
    v_accvgpr_write_b32 a68, v132
    v_accvgpr_write_b32 a69, v133
    v_accvgpr_write_b32 a70, v134
    v_accvgpr_write_b32 a71, v135
    v_accvgpr_write_b32 a72, v136
    v_accvgpr_write_b32 a73, v137
    v_accvgpr_write_b32 a74, v138
    v_accvgpr_write_b32 a75, v139
    v_accvgpr_write_b32 a76, v140
    v_accvgpr_write_b32 a77, v141
    v_accvgpr_write_b32 a78, v142
    v_accvgpr_write_b32 a79, v143
    v_accvgpr_read_b32 v128, a80
    v_accvgpr_read_b32 v129, a81
    v_accvgpr_read_b32 v130, a82
    v_accvgpr_read_b32 v131, a83
    v_accvgpr_read_b32 v132, a84
    v_accvgpr_read_b32 v133, a85
    v_accvgpr_read_b32 v134, a86
    v_accvgpr_read_b32 v135, a87
    v_accvgpr_read_b32 v136, a88
    v_accvgpr_read_b32 v137, a89
    v_accvgpr_read_b32 v138, a90
    v_accvgpr_read_b32 v139, a91
    v_accvgpr_read_b32 v140, a92
    v_accvgpr_read_b32 v141, a93
    v_accvgpr_read_b32 v142, a94
    v_accvgpr_read_b32 v143, a95
    v_mul_f32 v128, v128, v240
    v_mul_f32 v129, v129, v240
    v_mul_f32 v130, v130, v240
    v_mul_f32 v131, v131, v240
    v_mul_f32 v132, v132, v241
    v_mul_f32 v133, v133, v241
    v_mul_f32 v134, v134, v241
    v_mul_f32 v135, v135, v241
    v_mul_f32 v136, v136, v242
    v_mul_f32 v137, v137, v242
    v_mul_f32 v138, v138, v242
    v_mul_f32 v139, v139, v242
    v_mul_f32 v140, v140, v243
    v_mul_f32 v141, v141, v243
    v_mul_f32 v142, v142, v243
    v_mul_f32 v143, v143, v243
    v_accvgpr_write_b32 a80, v128
    v_accvgpr_write_b32 a81, v129
    v_accvgpr_write_b32 a82, v130
    v_accvgpr_write_b32 a83, v131
    v_accvgpr_write_b32 a84, v132
    v_accvgpr_write_b32 a85, v133
    v_accvgpr_write_b32 a86, v134
    v_accvgpr_write_b32 a87, v135
    v_accvgpr_write_b32 a88, v136
    v_accvgpr_write_b32 a89, v137
    v_accvgpr_write_b32 a90, v138
    v_accvgpr_write_b32 a91, v139
    v_accvgpr_write_b32 a92, v140
    v_accvgpr_write_b32 a93, v141
    v_accvgpr_write_b32 a94, v142
    v_accvgpr_write_b32 a95, v143
    v_accvgpr_read_b32 v128, a96
    v_accvgpr_read_b32 v129, a97
    v_accvgpr_read_b32 v130, a98
    v_accvgpr_read_b32 v131, a99
    v_accvgpr_read_b32 v132, a100
    v_accvgpr_read_b32 v133, a101
    v_accvgpr_read_b32 v134, a102
    v_accvgpr_read_b32 v135, a103
    v_accvgpr_read_b32 v136, a104
    v_accvgpr_read_b32 v137, a105
    v_accvgpr_read_b32 v138, a106
    v_accvgpr_read_b32 v139, a107
    v_accvgpr_read_b32 v140, a108
    v_accvgpr_read_b32 v141, a109
    v_accvgpr_read_b32 v142, a110
    v_accvgpr_read_b32 v143, a111
    v_mul_f32 v128, v128, v240
    v_mul_f32 v129, v129, v240
    v_mul_f32 v130, v130, v240
    v_mul_f32 v131, v131, v240
    v_mul_f32 v132, v132, v241
    v_mul_f32 v133, v133, v241
    v_mul_f32 v134, v134, v241
    v_mul_f32 v135, v135, v241
    v_mul_f32 v136, v136, v242
    v_mul_f32 v137, v137, v242
    v_mul_f32 v138, v138, v242
    v_mul_f32 v139, v139, v242
    v_mul_f32 v140, v140, v243
    v_mul_f32 v141, v141, v243
    v_mul_f32 v142, v142, v243
    v_mul_f32 v143, v143, v243
    v_accvgpr_write_b32 a96, v128
    v_accvgpr_write_b32 a97, v129
    v_accvgpr_write_b32 a98, v130
    v_accvgpr_write_b32 a99, v131
    v_accvgpr_write_b32 a100, v132
    v_accvgpr_write_b32 a101, v133
    v_accvgpr_write_b32 a102, v134
    v_accvgpr_write_b32 a103, v135
    v_accvgpr_write_b32 a104, v136
    v_accvgpr_write_b32 a105, v137
    v_accvgpr_write_b32 a106, v138
    v_accvgpr_write_b32 a107, v139
    v_accvgpr_write_b32 a108, v140
    v_accvgpr_write_b32 a109, v141
    v_accvgpr_write_b32 a110, v142
    v_accvgpr_write_b32 a111, v143
    v_accvgpr_read_b32 v128, a112
    v_accvgpr_read_b32 v129, a113
    v_accvgpr_read_b32 v130, a114
    v_accvgpr_read_b32 v131, a115
    v_accvgpr_read_b32 v132, a116
    v_accvgpr_read_b32 v133, a117
    v_accvgpr_read_b32 v134, a118
    v_accvgpr_read_b32 v135, a119
    v_accvgpr_read_b32 v136, a120
    v_accvgpr_read_b32 v137, a121
    v_accvgpr_read_b32 v138, a122
    v_accvgpr_read_b32 v139, a123
    v_accvgpr_read_b32 v140, a124
    v_accvgpr_read_b32 v141, a125
    v_accvgpr_read_b32 v142, a126
    v_accvgpr_read_b32 v143, a127
    v_mul_f32 v128, v128, v240
    v_mul_f32 v129, v129, v240
    v_mul_f32 v130, v130, v240
    v_mul_f32 v131, v131, v240
    v_mul_f32 v132, v132, v241
    v_mul_f32 v133, v133, v241
    v_mul_f32 v134, v134, v241
    v_mul_f32 v135, v135, v241
    v_mul_f32 v136, v136, v242
    v_mul_f32 v137, v137, v242
    v_mul_f32 v138, v138, v242
    v_mul_f32 v139, v139, v242
    v_mul_f32 v140, v140, v243
    v_mul_f32 v141, v141, v243
    v_mul_f32 v142, v142, v243
    v_mul_f32 v143, v143, v243
    v_accvgpr_write_b32 a112, v128
    v_accvgpr_write_b32 a113, v129
    v_accvgpr_write_b32 a114, v130
    v_accvgpr_write_b32 a115, v131
    v_accvgpr_write_b32 a116, v132
    v_accvgpr_write_b32 a117, v133
    v_accvgpr_write_b32 a118, v134
    v_accvgpr_write_b32 a119, v135
    v_accvgpr_write_b32 a120, v136
    v_accvgpr_write_b32 a121, v137
    v_accvgpr_write_b32 a122, v138
    v_accvgpr_write_b32 a123, v139
    v_accvgpr_write_b32 a124, v140
    v_accvgpr_write_b32 a125, v141
    v_accvgpr_write_b32 a126, v142
    v_accvgpr_write_b32 a127, v143
    s_nop 1
    v_mfma_f32_16x16x32_bf16 a[0:3], a[224:227], v[160:163], a[0:3]
    v_mfma_f32_16x16x32_bf16 a[4:7], a[224:227], v[164:167], a[4:7]
    v_mfma_f32_16x16x32_bf16 a[8:11], a[224:227], v[168:171], a[8:11]
    v_mfma_f32_16x16x32_bf16 a[12:15], a[224:227], v[172:175], a[12:15]
    v_mfma_f32_16x16x32_bf16 a[16:19], a[228:231], v[160:163], a[16:19]
    v_mfma_f32_16x16x32_bf16 a[20:23], a[228:231], v[164:167], a[20:23]
    v_mfma_f32_16x16x32_bf16 a[24:27], a[228:231], v[168:171], a[24:27]
    v_mfma_f32_16x16x32_bf16 a[28:31], a[228:231], v[172:175], a[28:31]
    v_mfma_f32_16x16x32_bf16 a[32:35], a[232:235], v[160:163], a[32:35]
    v_mfma_f32_16x16x32_bf16 a[36:39], a[232:235], v[164:167], a[36:39]
    v_mfma_f32_16x16x32_bf16 a[40:43], a[232:235], v[168:171], a[40:43]
    v_mfma_f32_16x16x32_bf16 a[44:47], a[232:235], v[172:175], a[44:47]
    v_mfma_f32_16x16x32_bf16 a[48:51], a[236:239], v[160:163], a[48:51]
    v_mfma_f32_16x16x32_bf16 a[52:55], a[236:239], v[164:167], a[52:55]
    v_mfma_f32_16x16x32_bf16 a[56:59], a[236:239], v[168:171], a[56:59]
    v_mfma_f32_16x16x32_bf16 a[60:63], a[236:239], v[172:175], a[60:63]
    v_mfma_f32_16x16x32_bf16 a[64:67], a[240:243], v[160:163], a[64:67]
    v_mfma_f32_16x16x32_bf16 a[68:71], a[240:243], v[164:167], a[68:71]
    v_mfma_f32_16x16x32_bf16 a[72:75], a[240:243], v[168:171], a[72:75]
    v_mfma_f32_16x16x32_bf16 a[76:79], a[240:243], v[172:175], a[76:79]
    v_mfma_f32_16x16x32_bf16 a[80:83], a[244:247], v[160:163], a[80:83]
    v_mfma_f32_16x16x32_bf16 a[84:87], a[244:247], v[164:167], a[84:87]
    v_mfma_f32_16x16x32_bf16 a[88:91], a[244:247], v[168:171], a[88:91]
    v_mfma_f32_16x16x32_bf16 a[92:95], a[244:247], v[172:175], a[92:95]
    v_mfma_f32_16x16x32_bf16 a[96:99], a[248:251], v[160:163], a[96:99]
    v_mfma_f32_16x16x32_bf16 a[100:103], a[248:251], v[164:167], a[100:103]
    v_mfma_f32_16x16x32_bf16 a[104:107], a[248:251], v[168:171], a[104:107]
    v_mfma_f32_16x16x32_bf16 a[108:111], a[248:251], v[172:175], a[108:111]
    v_mfma_f32_16x16x32_bf16 a[112:115], a[252:255], v[160:163], a[112:115]
    v_mfma_f32_16x16x32_bf16 a[116:119], a[252:255], v[164:167], a[116:119]
    v_mfma_f32_16x16x32_bf16 a[120:123], a[252:255], v[168:171], a[120:123]
    v_mfma_f32_16x16x32_bf16 a[124:127], a[252:255], v[172:175], a[124:127]
    s_nop 7
    s_add_u32 s43, s43, 1
    s_cmp_lt_u32 s43, 2
    s_cbranch_scc1 k_slow_half
    s_cmp_lt_u32 s40, 524288
    s_cbranch_scc1 k_slow_loop
k_attn_epi:
    v_mov_b32 v234, v208
    v_mov_b32 v235, v209
    v_mov_b32 v236, v210
    v_mov_b32 v237, v211
    s_nop 1
    v_permlane16_swap_b32 v208, v234
    v_permlane16_swap_b32 v209, v235
    v_permlane16_swap_b32 v210, v236
    v_permlane16_swap_b32 v211, v237
    s_nop 1
    v_add_f32 v208, v208, v234
    v_add_f32 v209, v209, v235
    v_add_f32 v210, v210, v236
    v_add_f32 v211, v211, v237
    v_mov_b32 v234, v208
    v_mov_b32 v235, v209
    v_mov_b32 v236, v210
    v_mov_b32 v237, v211
    s_nop 1
    v_permlane32_swap_b32 v208, v234
    v_permlane32_swap_b32 v209, v235
    v_permlane32_swap_b32 v210, v236
    v_permlane32_swap_b32 v211, v237
    s_nop 1
    v_add_f32 v208, v208, v234
    v_add_f32 v209, v209, v235
    v_add_f32 v210, v210, v236
    v_add_f32 v211, v211, v237
    v_rcp_f32 v208, v208
    v_rcp_f32 v209, v209
    v_rcp_f32 v210, v210
    v_rcp_f32 v211, v211
    v_accvgpr_read_b32 v96, a0
    v_accvgpr_read_b32 v97, a1
    v_accvgpr_read_b32 v98, a2
    v_accvgpr_read_b32 v99, a3
    v_accvgpr_read_b32 v100, a4
    v_accvgpr_read_b32 v101, a5
    v_accvgpr_read_b32 v102, a6
    v_accvgpr_read_b32 v103, a7
    v_accvgpr_read_b32 v104, a8
    v_accvgpr_read_b32 v105, a9
    v_accvgpr_read_b32 v106, a10
    v_accvgpr_read_b32 v107, a11
    v_accvgpr_read_b32 v108, a12
    v_accvgpr_read_b32 v109, a13
    v_accvgpr_read_b32 v110, a14
    v_accvgpr_read_b32 v111, a15
    v_accvgpr_read_b32 v112, a16
    v_accvgpr_read_b32 v113, a17
    v_accvgpr_read_b32 v114, a18
    v_accvgpr_read_b32 v115, a19
    v_accvgpr_read_b32 v116, a20
    v_accvgpr_read_b32 v117, a21
    v_accvgpr_read_b32 v118, a22
    v_accvgpr_read_b32 v119, a23
    v_accvgpr_read_b32 v120, a24
    v_accvgpr_read_b32 v121, a25
    v_accvgpr_read_b32 v122, a26
    v_accvgpr_read_b32 v123, a27
    v_accvgpr_read_b32 v124, a28
    v_accvgpr_read_b32 v125, a29
    v_accvgpr_read_b32 v126, a30
    v_accvgpr_read_b32 v127, a31
    v_pk_mul_f32 v[96:97], v[96:97], v[208:209] op_sel:[0,0] op_sel_hi:[1,0]
    v_pk_mul_f32 v[98:99], v[98:99], v[208:209] op_sel:[0,0] op_sel_hi:[1,0]
    v_pk_mul_f32 v[100:101], v[100:101], v[208:209] op_sel:[0,1] op_sel_hi:[1,1]
    v_pk_mul_f32 v[102:103], v[102:103], v[208:209] op_sel:[0,1] op_sel_hi:[1,1]
    v_pk_mul_f32 v[104:105], v[104:105], v[210:211] op_sel:[0,0] op_sel_hi:[1,0]
    v_pk_mul_f32 v[106:107], v[106:107], v[210:211] op_sel:[0,0] op_sel_hi:[1,0]
    v_pk_mul_f32 v[108:109], v[108:109], v[210:211] op_sel:[0,1] op_sel_hi:[1,1]
    v_pk_mul_f32 v[110:111], v[110:111], v[210:211] op_sel:[0,1] op_sel_hi:[1,1]
    v_pk_mul_f32 v[112:113], v[112:113], v[208:209] op_sel:[0,0] op_sel_hi:[1,0]
    v_pk_mul_f32 v[114:115], v[114:115], v[208:209] op_sel:[0,0] op_sel_hi:[1,0]
    v_pk_mul_f32 v[116:117], v[116:117], v[208:209] op_sel:[0,1] op_sel_hi:[1,1]
    v_pk_mul_f32 v[118:119], v[118:119], v[208:209] op_sel:[0,1] op_sel_hi:[1,1]
    v_pk_mul_f32 v[120:121], v[120:121], v[210:211] op_sel:[0,0] op_sel_hi:[1,0]
    v_pk_mul_f32 v[122:123], v[122:123], v[210:211] op_sel:[0,0] op_sel_hi:[1,0]
    v_pk_mul_f32 v[124:125], v[124:125], v[210:211] op_sel:[0,1] op_sel_hi:[1,1]
    v_pk_mul_f32 v[126:127], v[126:127], v[210:211] op_sel:[0,1] op_sel_hi:[1,1]
    v_cvt_pk_bf16_f32 v128, v96, v97
    v_cvt_pk_bf16_f32 v129, v98, v99
    v_cvt_pk_bf16_f32 v130, v112, v113
    v_cvt_pk_bf16_f32 v131, v114, v115
    buffer_store_dwordx4 v[128:131], v6, s[36:39], s93 offen offset:0 sc1
    v_cvt_pk_bf16_f32 v132, v100, v101
    v_cvt_pk_bf16_f32 v133, v102, v103
    v_cvt_pk_bf16_f32 v134, v116, v117
    v_cvt_pk_bf16_f32 v135, v118, v119
    buffer_store_dwordx4 v[132:135], v6, s[36:39], s94 offen offset:0 sc1
    v_cvt_pk_bf16_f32 v136, v104, v105
    v_cvt_pk_bf16_f32 v137, v106, v107
    v_cvt_pk_bf16_f32 v138, v120, v121
    v_cvt_pk_bf16_f32 v139, v122, v123
    buffer_store_dwordx4 v[136:139], v6, s[36:39], s95 offen offset:0 sc1
    v_cvt_pk_bf16_f32 v140, v108, v109
    v_cvt_pk_bf16_f32 v141, v110, v111
    v_cvt_pk_bf16_f32 v142, v124, v125
    v_cvt_pk_bf16_f32 v143, v126, v127
    buffer_store_dwordx4 v[140:143], v6, s[36:39], s96 offen offset:0 sc1
k_attn_epi2:
    v_accvgpr_read_b32 v144, a32
    v_accvgpr_read_b32 v145, a33
    v_accvgpr_read_b32 v146, a34
    v_accvgpr_read_b32 v147, a35
    v_accvgpr_read_b32 v148, a36
    v_accvgpr_read_b32 v149, a37
    v_accvgpr_read_b32 v150, a38
    v_accvgpr_read_b32 v151, a39
    v_accvgpr_read_b32 v152, a40
    v_accvgpr_read_b32 v153, a41
    v_accvgpr_read_b32 v154, a42
    v_accvgpr_read_b32 v155, a43
    v_accvgpr_read_b32 v156, a44
    v_accvgpr_read_b32 v157, a45
    v_accvgpr_read_b32 v158, a46
    v_accvgpr_read_b32 v159, a47
    v_accvgpr_read_b32 v160, a48
    v_accvgpr_read_b32 v161, a49
    v_accvgpr_read_b32 v162, a50
    v_accvgpr_read_b32 v163, a51
    v_accvgpr_read_b32 v164, a52
    v_accvgpr_read_b32 v165, a53
    v_accvgpr_read_b32 v166, a54
    v_accvgpr_read_b32 v167, a55
    v_accvgpr_read_b32 v168, a56
    v_accvgpr_read_b32 v169, a57
    v_accvgpr_read_b32 v170, a58
    v_accvgpr_read_b32 v171, a59
    v_accvgpr_read_b32 v172, a60
    v_accvgpr_read_b32 v173, a61
    v_accvgpr_read_b32 v174, a62
    v_accvgpr_read_b32 v175, a63
    v_pk_mul_f32 v[144:145], v[144:145], v[208:209] op_sel:[0,0] op_sel_hi:[1,0]
    v_pk_mul_f32 v[146:147], v[146:147], v[208:209] op_sel:[0,0] op_sel_hi:[1,0]
    v_pk_mul_f32 v[148:149], v[148:149], v[208:209] op_sel:[0,1] op_sel_hi:[1,1]
    v_pk_mul_f32 v[150:151], v[150:151], v[208:209] op_sel:[0,1] op_sel_hi:[1,1]
    v_pk_mul_f32 v[152:153], v[152:153], v[210:211] op_sel:[0,0] op_sel_hi:[1,0]
    v_pk_mul_f32 v[154:155], v[154:155], v[210:211] op_sel:[0,0] op_sel_hi:[1,0]
    v_pk_mul_f32 v[156:157], v[156:157], v[210:211] op_sel:[0,1] op_sel_hi:[1,1]
    v_pk_mul_f32 v[158:159], v[158:159], v[210:211] op_sel:[0,1] op_sel_hi:[1,1]
    v_pk_mul_f32 v[160:161], v[160:161], v[208:209] op_sel:[0,0] op_sel_hi:[1,0]
    v_pk_mul_f32 v[162:163], v[162:163], v[208:209] op_sel:[0,0] op_sel_hi:[1,0]
    v_pk_mul_f32 v[164:165], v[164:165], v[208:209] op_sel:[0,1] op_sel_hi:[1,1]
    v_pk_mul_f32 v[166:167], v[166:167], v[208:209] op_sel:[0,1] op_sel_hi:[1,1]
    v_pk_mul_f32 v[168:169], v[168:169], v[210:211] op_sel:[0,0] op_sel_hi:[1,0]
    v_pk_mul_f32 v[170:171], v[170:171], v[210:211] op_sel:[0,0] op_sel_hi:[1,0]
    v_pk_mul_f32 v[172:173], v[172:173], v[210:211] op_sel:[0,1] op_sel_hi:[1,1]
    v_pk_mul_f32 v[174:175], v[174:175], v[210:211] op_sel:[0,1] op_sel_hi:[1,1]
    v_cvt_pk_bf16_f32 v176, v144, v145
    v_cvt_pk_bf16_f32 v177, v146, v147
    v_cvt_pk_bf16_f32 v178, v160, v161
    v_cvt_pk_bf16_f32 v179, v162, v163
    buffer_store_dwordx4 v[176:179], v6, s[36:39], s93 offen offset:1024 sc1
    v_cvt_pk_bf16_f32 v180, v148, v149
    v_cvt_pk_bf16_f32 v181, v150, v151
    v_cvt_pk_bf16_f32 v182, v164, v165
    v_cvt_pk_bf16_f32 v183, v166, v167
    buffer_store_dwordx4 v[180:183], v6, s[36:39], s94 offen offset:1024 sc1
    v_cvt_pk_bf16_f32 v184, v152, v153
    v_cvt_pk_bf16_f32 v185, v154, v155
    v_cvt_pk_bf16_f32 v186, v168, v169
    v_cvt_pk_bf16_f32 v187, v170, v171
    buffer_store_dwordx4 v[184:187], v6, s[36:39], s95 offen offset:1024 sc1
    v_cvt_pk_bf16_f32 v188, v156, v157
    v_cvt_pk_bf16_f32 v189, v158, v159
    v_cvt_pk_bf16_f32 v190, v172, v173
    v_cvt_pk_bf16_f32 v191, v174, v175
    buffer_store_dwordx4 v[188:191], v6, s[36:39], s96 offen offset:1024 sc1
    v_accvgpr_read_b32 v96, a64
    v_accvgpr_read_b32 v97, a65
    v_accvgpr_read_b32 v98, a66
    v_accvgpr_read_b32 v99, a67
    v_accvgpr_read_b32 v100, a68
    v_accvgpr_read_b32 v101, a69
    v_accvgpr_read_b32 v102, a70
    v_accvgpr_read_b32 v103, a71
    v_accvgpr_read_b32 v104, a72
    v_accvgpr_read_b32 v105, a73
    v_accvgpr_read_b32 v106, a74
    v_accvgpr_read_b32 v107, a75
    v_accvgpr_read_b32 v108, a76
    v_accvgpr_read_b32 v109, a77
    v_accvgpr_read_b32 v110, a78
    v_accvgpr_read_b32 v111, a79
    v_accvgpr_read_b32 v112, a80
    v_accvgpr_read_b32 v113, a81
    v_accvgpr_read_b32 v114, a82
    v_accvgpr_read_b32 v115, a83
    v_accvgpr_read_b32 v116, a84
    v_accvgpr_read_b32 v117, a85
    v_accvgpr_read_b32 v118, a86
    v_accvgpr_read_b32 v119, a87
    v_accvgpr_read_b32 v120, a88
    v_accvgpr_read_b32 v121, a89
    v_accvgpr_read_b32 v122, a90
    v_accvgpr_read_b32 v123, a91
    v_accvgpr_read_b32 v124, a92
    v_accvgpr_read_b32 v125, a93
    v_accvgpr_read_b32 v126, a94
    v_accvgpr_read_b32 v127, a95
    v_pk_mul_f32 v[96:97], v[96:97], v[208:209] op_sel:[0,0] op_sel_hi:[1,0]
    v_pk_mul_f32 v[98:99], v[98:99], v[208:209] op_sel:[0,0] op_sel_hi:[1,0]
    v_pk_mul_f32 v[100:101], v[100:101], v[208:209] op_sel:[0,1] op_sel_hi:[1,1]
    v_pk_mul_f32 v[102:103], v[102:103], v[208:209] op_sel:[0,1] op_sel_hi:[1,1]
    v_pk_mul_f32 v[104:105], v[104:105], v[210:211] op_sel:[0,0] op_sel_hi:[1,0]
    v_pk_mul_f32 v[106:107], v[106:107], v[210:211] op_sel:[0,0] op_sel_hi:[1,0]
    v_pk_mul_f32 v[108:109], v[108:109], v[210:211] op_sel:[0,1] op_sel_hi:[1,1]
    v_pk_mul_f32 v[110:111], v[110:111], v[210:211] op_sel:[0,1] op_sel_hi:[1,1]
    v_pk_mul_f32 v[112:113], v[112:113], v[208:209] op_sel:[0,0] op_sel_hi:[1,0]
    v_pk_mul_f32 v[114:115], v[114:115], v[208:209] op_sel:[0,0] op_sel_hi:[1,0]
    v_pk_mul_f32 v[116:117], v[116:117], v[208:209] op_sel:[0,1] op_sel_hi:[1,1]
    v_pk_mul_f32 v[118:119], v[118:119], v[208:209] op_sel:[0,1] op_sel_hi:[1,1]
    v_pk_mul_f32 v[120:121], v[120:121], v[210:211] op_sel:[0,0] op_sel_hi:[1,0]
    v_pk_mul_f32 v[122:123], v[122:123], v[210:211] op_sel:[0,0] op_sel_hi:[1,0]
    v_pk_mul_f32 v[124:125], v[124:125], v[210:211] op_sel:[0,1] op_sel_hi:[1,1]
    v_pk_mul_f32 v[126:127], v[126:127], v[210:211] op_sel:[0,1] op_sel_hi:[1,1]
    v_cvt_pk_bf16_f32 v128, v96, v97
    v_cvt_pk_bf16_f32 v129, v98, v99
    v_cvt_pk_bf16_f32 v130, v112, v113
    v_cvt_pk_bf16_f32 v131, v114, v115
    buffer_store_dwordx4 v[128:131], v6, s[36:39], s93 offen offset:2048 sc1
    v_cvt_pk_bf16_f32 v132, v100, v101
    v_cvt_pk_bf16_f32 v133, v102, v103
    v_cvt_pk_bf16_f32 v134, v116, v117
    v_cvt_pk_bf16_f32 v135, v118, v119
    buffer_store_dwordx4 v[132:135], v6, s[36:39], s94 offen offset:2048 sc1
    v_cvt_pk_bf16_f32 v136, v104, v105
    v_cvt_pk_bf16_f32 v137, v106, v107
    v_cvt_pk_bf16_f32 v138, v120, v121
    v_cvt_pk_bf16_f32 v139, v122, v123
    buffer_store_dwordx4 v[136:139], v6, s[36:39], s95 offen offset:2048 sc1
    v_cvt_pk_bf16_f32 v140, v108, v109
    v_cvt_pk_bf16_f32 v141, v110, v111
    v_cvt_pk_bf16_f32 v142, v124, v125
    v_cvt_pk_bf16_f32 v143, v126, v127
    buffer_store_dwordx4 v[140:143], v6, s[36:39], s96 offen offset:2048 sc1
    v_accvgpr_read_b32 v144, a96
    v_accvgpr_read_b32 v145, a97
    v_accvgpr_read_b32 v146, a98
    v_accvgpr_read_b32 v147, a99
    v_accvgpr_read_b32 v148, a100
    v_accvgpr_read_b32 v149, a101
    v_accvgpr_read_b32 v150, a102
    v_accvgpr_read_b32 v151, a103
    v_accvgpr_read_b32 v152, a104
    v_accvgpr_read_b32 v153, a105
    v_accvgpr_read_b32 v154, a106
    v_accvgpr_read_b32 v155, a107
    v_accvgpr_read_b32 v156, a108
    v_accvgpr_read_b32 v157, a109
    v_accvgpr_read_b32 v158, a110
    v_accvgpr_read_b32 v159, a111
    v_accvgpr_read_b32 v160, a112
    v_accvgpr_read_b32 v161, a113
    v_accvgpr_read_b32 v162, a114
    v_accvgpr_read_b32 v163, a115
    v_accvgpr_read_b32 v164, a116
    v_accvgpr_read_b32 v165, a117
    v_accvgpr_read_b32 v166, a118
    v_accvgpr_read_b32 v167, a119
    v_accvgpr_read_b32 v168, a120
    v_accvgpr_read_b32 v169, a121
    v_accvgpr_read_b32 v170, a122
    v_accvgpr_read_b32 v171, a123
    v_accvgpr_read_b32 v172, a124
    v_accvgpr_read_b32 v173, a125
    v_accvgpr_read_b32 v174, a126
    v_accvgpr_read_b32 v175, a127
    v_pk_mul_f32 v[144:145], v[144:145], v[208:209] op_sel:[0,0] op_sel_hi:[1,0]
    v_pk_mul_f32 v[146:147], v[146:147], v[208:209] op_sel:[0,0] op_sel_hi:[1,0]
    v_pk_mul_f32 v[148:149], v[148:149], v[208:209] op_sel:[0,1] op_sel_hi:[1,1]
    v_pk_mul_f32 v[150:151], v[150:151], v[208:209] op_sel:[0,1] op_sel_hi:[1,1]
    v_pk_mul_f32 v[152:153], v[152:153], v[210:211] op_sel:[0,0] op_sel_hi:[1,0]
    v_pk_mul_f32 v[154:155], v[154:155], v[210:211] op_sel:[0,0] op_sel_hi:[1,0]
    v_pk_mul_f32 v[156:157], v[156:157], v[210:211] op_sel:[0,1] op_sel_hi:[1,1]
    v_pk_mul_f32 v[158:159], v[158:159], v[210:211] op_sel:[0,1] op_sel_hi:[1,1]
    v_pk_mul_f32 v[160:161], v[160:161], v[208:209] op_sel:[0,0] op_sel_hi:[1,0]
    v_pk_mul_f32 v[162:163], v[162:163], v[208:209] op_sel:[0,0] op_sel_hi:[1,0]
    v_pk_mul_f32 v[164:165], v[164:165], v[208:209] op_sel:[0,1] op_sel_hi:[1,1]
    v_pk_mul_f32 v[166:167], v[166:167], v[208:209] op_sel:[0,1] op_sel_hi:[1,1]
    v_pk_mul_f32 v[168:169], v[168:169], v[210:211] op_sel:[0,0] op_sel_hi:[1,0]
    v_pk_mul_f32 v[170:171], v[170:171], v[210:211] op_sel:[0,0] op_sel_hi:[1,0]
    v_pk_mul_f32 v[172:173], v[172:173], v[210:211] op_sel:[0,1] op_sel_hi:[1,1]
    v_pk_mul_f32 v[174:175], v[174:175], v[210:211] op_sel:[0,1] op_sel_hi:[1,1]
    v_cvt_pk_bf16_f32 v176, v144, v145
    v_cvt_pk_bf16_f32 v177, v146, v147
    v_cvt_pk_bf16_f32 v178, v160, v161
    v_cvt_pk_bf16_f32 v179, v162, v163
    buffer_store_dwordx4 v[176:179], v6, s[36:39], s93 offen offset:3072 sc1
    v_cvt_pk_bf16_f32 v180, v148, v149
    v_cvt_pk_bf16_f32 v181, v150, v151
    v_cvt_pk_bf16_f32 v182, v164, v165
    v_cvt_pk_bf16_f32 v183, v166, v167
    buffer_store_dwordx4 v[180:183], v6, s[36:39], s94 offen offset:3072 sc1
    v_cvt_pk_bf16_f32 v184, v152, v153
    v_cvt_pk_bf16_f32 v185, v154, v155
    v_cvt_pk_bf16_f32 v186, v168, v169
    v_cvt_pk_bf16_f32 v187, v170, v171
    buffer_store_dwordx4 v[184:187], v6, s[36:39], s95 offen offset:3072 sc1
    v_cvt_pk_bf16_f32 v188, v156, v157
    v_cvt_pk_bf16_f32 v189, v158, v159
    v_cvt_pk_bf16_f32 v190, v172, v173
    v_cvt_pk_bf16_f32 v191, v174, v175
    buffer_store_dwordx4 v[188:191], v6, s[36:39], s96 offen offset:3072 sc1
    s_lshl_b32 s32, s20, 2
    s_add_u32 s32, s32, 131072
    v_mov_b32 v213, s32
    v_mov_b32 v214, s42
    ds_write_b32 v213, v214
    v_mov_b32 v213, 131072
    s_waitcnt lgkmcnt(0)
    s_barrier
    ds_read_b128 v[244:247], v213
    s_waitcnt lgkmcnt(0)
    v_or_b32 v244, v244, v245
    v_or3_b32 v244, v244, v246, v247
    s_nop 0
    v_readfirstlane_b32 s42, v244
    s_nop 3
    s_cmp_lg_u32 s42, 0
    s_cbranch_scc1 k_slow
    s_mov_b32 s3, 0
k_rk_wait:
    v_readfirstlane_b32 s60, v238
    s_add_u32 s3, s3, 1
    s_nop 2
    s_cmp_lg_u32 s60, 0
    s_cbranch_scc1 k_rk_seen
    s_cmp_gt_u32 s3, 0x40000
    s_cbranch_scc1 k_rk_seen
    global_load_dword v238, v252, s[44:45] sc1
    s_waitcnt vmcnt(0)
    s_branch k_rk_wait
k_rk_seen:
    s_load_dwordx2 s[4:5], s[0:1], 32
    s_load_dwordx2 s[6:7], s[0:1], 56
    s_load_dwordx2 s[48:49], s[0:1], 64
    s_load_dwordx2 s[50:51], s[0:1], 0
    s_sub_u32 s60, s60, 1
    s_and_b32 s60, s60, 7
    s_lshl_b32 s60, s60, 2
    s_lshr_b32 s61, 0x32765410, s60
    s_and_b32 s61, s61, 7
    s_lshl_b32 s61, s61, 2
    s_and_b32 s3, s21, 3
    s_add_u32 s61, s61, s3
    s_lshr_b32 s24, s61, 4
    s_bfe_u32 s41, s61, 0x10003
    s_and_b32 s40, s61, 7
    s_lshl_b32 s60, s22, 5
    s_add_u32 s60, s60, s61
    s_lshl_b32 s60, s60, 10
    s_lshr_b32 s3, s61, 2
    s_mov_b32 s30, 0x14831040
    s_mov_b32 s31, 0x73
    s_mov_b32 s29, 7
    s_cmp_eq_u32 s3, 1
    s_cselect_b32 s30, 0x14831040, s30
    s_cselect_b32 s31, 0x73, s31
    s_cselect_b32 s29, 7, s29
    s_cmp_eq_u32 s3, 2
    s_cselect_b32 s30, 0x358b5250, s30
    s_cselect_b32 s31, 0x0, s31
    s_cselect_b32 s29, 5, s29
    s_cmp_eq_u32 s3, 3
    s_cselect_b32 s30, 0x358b5250, s30
    s_cselect_b32 s31, 0x0, s31
    s_cselect_b32 s29, 5, s29
    s_cmp_eq_u32 s3, 4
    s_cselect_b32 s30, 0xd2728c20, s30
    s_cselect_b32 s31, 0x80000f6a, s31
    s_cselect_b32 s29, 8, s29
    s_cmp_eq_u32 s3, 5
    s_cselect_b32 s30, 0xd2728c20, s30
    s_cselect_b32 s31, 0x80000f6a, s31
    s_cselect_b32 s29, 8, s29
    s_cmp_eq_u32 s3, 6
    s_cselect_b32 s30, 0x358b5251, s30
    s_cselect_b32 s31, 0x800000f7, s31
    s_cselect_b32 s29, 7, s29
    s_cmp_eq_u32 s3, 7
    s_cselect_b32 s30, 0x358b5251, s30
    s_cselect_b32 s31, 0x800000f7, s31
    s_cselect_b32 s29, 7, s29
    s_lshr_b32 s97, s31, 31
    s_lshl_b32 s96, s97, 1
    s_sub_u32 s96, 3, s96
    s_and_b32 s63, s30, 31
    s_lshr_b64 s[30:31], s[30:31], 5
    s_lshl_b32 s27, s63, 18
    s_lshl_b32 s26, s63, 12
    s_lshl_b32 s62, s96, s63
    s_mul_i32 s62, s62, s24
    s_lshl_b32 s96, s97, 15
    s_add_u32 s96, s96, s23
    s_lshl_b32 s42, s20, 14
    v_lshlrev_b32 v7, 11, v4
    v_add_u32 v7, s42, v7
    v_add_u32 v8, 0, v4
    v_lshlrev_b32 v8, 1, v8
    v_xor_b32 v8, v8, v5
    v_lshl_add_u32 v8, v8, 4, v7
    v_add_u32 v18, 0, v8
    v_add_u32 v8, 4, v4
    v_lshlrev_b32 v8, 1, v8
    v_xor_b32 v8, v8, v5
    v_lshl_add_u32 v8, v8, 4, v7
    v_add_u32 v19, 7168, v8
    s_cmp_eq_u32 s24, 1
    s_mov_b32 s43, 112
    s_cselect_b32 s43, 128, s43
    s_mov_b32 s93, 4194304
    s_cselect_b32 s93, 20971520, s93
    s_mov_b32 s94, 14680064
    s_cselect_b32 s94, 16777216, s94
    s_mov_b32 s95, 7340032
    s_cselect_b32 s95, 8388608, s95
    s_waitcnt lgkmcnt(0)
    s_cselect_b32 s4, s4, s6
    s_cselect_b32 s5, s5, s7
    s_lshl_b32 s3, s40, 8
    s_sub_u32 s95, s95, s3
    s_mov_b32 s12, s4
    s_mov_b32 s13, s5
    s_add_u32 s12, s12, s3
    s_addc_u32 s13, s13, 0
    s_and_b32 s13, s13, 0xffff
    s_mov_b32 s14, s95
    s_mov_b32 s15, 0x20000
    s_mul_i32 s3, s33, s43
    s_lshl_b32 s3, s3, 10
    s_sub_u32 s94, s94, s3
    s_add_u32 s3, s3, s93
    s_mov_b32 s8, s34
    s_mov_b32 s9, s35
    s_add_u32 s8, s8, s3
    s_addc_u32 s9, s9, 0
    s_and_b32 s9, s9, 0xffff
    s_mov_b32 s10, s94
    s_mov_b32 s11, 0x20000
    s_lshl_b32 s93, s41, 1
    s_xor_b32 s42, s93, 0
    s_mul_i32 s42, s42, s43
    s_lshl_b32 s42, s42, 10
    v_add_u32 v20, s42, v6
    s_xor_b32 s42, s93, 1
    s_mul_i32 s42, s42, s43
    s_lshl_b32 s42, s42, 10
    v_add_u32 v21, s42, v6
    s_xor_b32 s42, s93, 2
    s_mul_i32 s42, s42, s43
    s_lshl_b32 s42, s42, 10
    v_add_u32 v22, s42, v6
    s_xor_b32 s42, s93, 3
    s_mul_i32 s42, s42, s43
    s_lshl_b32 s42, s42, 10
    v_add_u32 v23, s42, v6
    v_lshlrev_b32 v7, 11, v5
    v_lshl_add_u32 v7, v4, 4, v7
    s_add_u32 s3, s33, s93
    s_lshl_b32 s3, s3, 15
    s_lshl_b32 s32, s40, 8
    s_add_u32 s3, s3, s32
    v_add_u32 v24, s3, v7
    v_add_u32 v25, 32768, v24
    v_lshl_add_u32 v7, v4, 2, v2
    v_lshlrev_b32 v7, 8, v7
    v_lshl_add_u32 v7, v3, 3, v7
    v_and_b32 v9, 1, v4
    v_lshl_add_u32 v9, v9, 2, v2
    v_xor_b32 v8, 0, v9
    v_lshl_add_u32 v10, v8, 5, v7
    v_xor_b32 v8, 1, v9
    v_lshl_add_u32 v11, v8, 5, v7
    v_xor_b32 v8, 2, v9
    v_lshl_add_u32 v12, v8, 5, v7
    v_xor_b32 v8, 3, v9
    v_lshl_add_u32 v13, v8, 5, v7
    v_xor_b32 v8, 4, v9
    v_lshl_add_u32 v14, v8, 5, v7
    v_xor_b32 v8, 5, v9
    v_lshl_add_u32 v15, v8, 5, v7
    v_xor_b32 v8, 6, v9
    v_lshl_add_u32 v16, v8, 5, v7
    v_xor_b32 v8, 7, v9
    v_lshl_add_u32 v17, v8, 5, v7
    v_accvgpr_write_b32 a0, 0
    v_accvgpr_write_b32 a1, 0
    v_accvgpr_write_b32 a2, 0
    v_accvgpr_write_b32 a3, 0
    v_accvgpr_write_b32 a4, 0
    v_accvgpr_write_b32 a5, 0
    v_accvgpr_write_b32 a6, 0
    v_accvgpr_write_b32 a7, 0
    v_accvgpr_write_b32 a8, 0
    v_accvgpr_write_b32 a9, 0
    v_accvgpr_write_b32 a10, 0
    v_accvgpr_write_b32 a11, 0
    v_accvgpr_write_b32 a12, 0
    v_accvgpr_write_b32 a13, 0
    v_accvgpr_write_b32 a14, 0
    v_accvgpr_write_b32 a15, 0
    v_accvgpr_write_b32 a16, 0
    v_accvgpr_write_b32 a17, 0
    v_accvgpr_write_b32 a18, 0
    v_accvgpr_write_b32 a19, 0
    v_accvgpr_write_b32 a20, 0
    v_accvgpr_write_b32 a21, 0
    v_accvgpr_write_b32 a22, 0
    v_accvgpr_write_b32 a23, 0
    v_accvgpr_write_b32 a24, 0
    v_accvgpr_write_b32 a25, 0
    v_accvgpr_write_b32 a26, 0
    v_accvgpr_write_b32 a27, 0
    v_accvgpr_write_b32 a28, 0
    v_accvgpr_write_b32 a29, 0
    v_accvgpr_write_b32 a30, 0
    v_accvgpr_write_b32 a31, 0
    v_accvgpr_write_b32 a32, 0
    v_accvgpr_write_b32 a33, 0
    v_accvgpr_write_b32 a34, 0
    v_accvgpr_write_b32 a35, 0
    v_accvgpr_write_b32 a36, 0
    v_accvgpr_write_b32 a37, 0
    v_accvgpr_write_b32 a38, 0
    v_accvgpr_write_b32 a39, 0
    v_accvgpr_write_b32 a40, 0
    v_accvgpr_write_b32 a41, 0
    v_accvgpr_write_b32 a42, 0
    v_accvgpr_write_b32 a43, 0
    v_accvgpr_write_b32 a44, 0
    v_accvgpr_write_b32 a45, 0
    v_accvgpr_write_b32 a46, 0
    v_accvgpr_write_b32 a47, 0
    v_accvgpr_write_b32 a48, 0
    v_accvgpr_write_b32 a49, 0
    v_accvgpr_write_b32 a50, 0
    v_accvgpr_write_b32 a51, 0
    v_accvgpr_write_b32 a52, 0
    v_accvgpr_write_b32 a53, 0
    v_accvgpr_write_b32 a54, 0
    v_accvgpr_write_b32 a55, 0
    v_accvgpr_write_b32 a56, 0
    v_accvgpr_write_b32 a57, 0
    v_accvgpr_write_b32 a58, 0
    v_accvgpr_write_b32 a59, 0
    v_accvgpr_write_b32 a60, 0
    v_accvgpr_write_b32 a61, 0
    v_accvgpr_write_b32 a62, 0
    v_accvgpr_write_b32 a63, 0
    v_accvgpr_write_b32 a64, 0
    v_accvgpr_write_b32 a65, 0
    v_accvgpr_write_b32 a66, 0
    v_accvgpr_write_b32 a67, 0
    v_accvgpr_write_b32 a68, 0
    v_accvgpr_write_b32 a69, 0
    v_accvgpr_write_b32 a70, 0
    v_accvgpr_write_b32 a71, 0
    v_accvgpr_write_b32 a72, 0
    v_accvgpr_write_b32 a73, 0
    v_accvgpr_write_b32 a74, 0
    v_accvgpr_write_b32 a75, 0
    v_accvgpr_write_b32 a76, 0
    v_accvgpr_write_b32 a77, 0
    v_accvgpr_write_b32 a78, 0
    v_accvgpr_write_b32 a79, 0
    v_accvgpr_write_b32 a80, 0
    v_accvgpr_write_b32 a81, 0
    v_accvgpr_write_b32 a82, 0
    v_accvgpr_write_b32 a83, 0
    v_accvgpr_write_b32 a84, 0
    v_accvgpr_write_b32 a85, 0
    v_accvgpr_write_b32 a86, 0
    v_accvgpr_write_b32 a87, 0
    v_accvgpr_write_b32 a88, 0
    v_accvgpr_write_b32 a89, 0
    v_accvgpr_write_b32 a90, 0
    v_accvgpr_write_b32 a91, 0
    v_accvgpr_write_b32 a92, 0
    v_accvgpr_write_b32 a93, 0
    v_accvgpr_write_b32 a94, 0
    v_accvgpr_write_b32 a95, 0
    v_accvgpr_write_b32 a96, 0
    v_accvgpr_write_b32 a97, 0
    v_accvgpr_write_b32 a98, 0
    v_accvgpr_write_b32 a99, 0
    v_accvgpr_write_b32 a100, 0
    v_accvgpr_write_b32 a101, 0
    v_accvgpr_write_b32 a102, 0
    v_accvgpr_write_b32 a103, 0
    v_accvgpr_write_b32 a104, 0
    v_accvgpr_write_b32 a105, 0
    v_accvgpr_write_b32 a106, 0
    v_accvgpr_write_b32 a107, 0
    v_accvgpr_write_b32 a108, 0
    v_accvgpr_write_b32 a109, 0
    v_accvgpr_write_b32 a110, 0
    v_accvgpr_write_b32 a111, 0
    v_accvgpr_write_b32 a112, 0
    v_accvgpr_write_b32 a113, 0
    v_accvgpr_write_b32 a114, 0
    v_accvgpr_write_b32 a115, 0
    v_accvgpr_write_b32 a116, 0
    v_accvgpr_write_b32 a117, 0
    v_accvgpr_write_b32 a118, 0
    v_accvgpr_write_b32 a119, 0
    v_accvgpr_write_b32 a120, 0
    v_accvgpr_write_b32 a121, 0
    v_accvgpr_write_b32 a122, 0
    v_accvgpr_write_b32 a123, 0
    v_accvgpr_write_b32 a124, 0
    v_accvgpr_write_b32 a125, 0
    v_accvgpr_write_b32 a126, 0
    v_accvgpr_write_b32 a127, 0
    s_lshl_b32 s3, s60, 6
    s_lshl_b32 s32, s20, 14
    s_add_u32 s3, s3, s32
    s_add_u32 s52, s34, 100663296
    s_addc_u32 s53, s35, 0
    s_add_u32 s52, s52, s3
    s_addc_u32 s53, s53, 0
    s_and_b32 s53, s53, 0xffff
    s_mov_b32 s54, 16384
    s_mov_b32 s55, 0x20000
    s_xor_b32 s42, s3, 524288
    s_add_u32 s56, s34, 100663296
    s_addc_u32 s57, s35, 0
    s_add_u32 s56, s56, s42
    s_addc_u32 s57, s57, 0
    s_and_b32 s57, s57, 0xffff
    s_mov_b32 s58, 8192
    s_mov_b32 s59, 0x20000
    s_xor_b32 s42, s3, 1048576
    s_add_u32 s16, s34, 100671488
    s_addc_u32 s17, s35, 0
    s_add_u32 s16, s16, s42
    s_addc_u32 s17, s17, 0
    s_and_b32 s17, s17, 0xffff
    s_mov_b32 s18, 8192
    s_mov_b32 s19, 0x20000
    s_lshl_b32 s32, s24, 22
    s_mov_b32 s36, s50
    s_mov_b32 s37, s51
    s_and_b32 s37, s37, 0xffff
    s_mov_b32 s38, s32
    s_mov_b32 s39, 0x20000
    s_mov_b32 s44, s48
    s_mov_b32 s45, s49
    s_and_b32 s45, s45, 0xffff
    s_mov_b32 s46, 4194304
    s_mov_b32 s47, 0x20000
    s_lshl_b32 s3, s22, 15
    s_lshl_b32 s32, s24, 7
    s_add_u32 s3, s3, s32
    v_and_b32 v26, 31, v1
    v_lshlrev_b32 v26, 10, v26
    v_add_u32 v26, s3, v26
    s_waitcnt vmcnt(0)
    s_barrier
    s_cmp_eq_u32 s20, 0
    s_cbranch_scc0 k_o_pub
    v_mov_b32 v7, s101
    v_mov_b32 v8, s100
    s_mov_b64 exec, 1
    global_store_dword v7, v8, s[98:99] offset:256 sc1
    s_mov_b64 exec, -1
k_o_pub:
    s_add_u32 m0, s96, 0
    s_nop 0
    buffer_load_dwordx4 v18, s[12:15], s27 offen offset:0 lds
    buffer_load_dwordx4 v19, s[12:15], s27 offen offset:1024 lds
    s_add_u32 s27, s27, 65536
    s_add_u32 m0, s96, 8192
    s_nop 0
    buffer_load_dwordx4 v18, s[12:15], s27 offen offset:0 lds
    buffer_load_dwordx4 v19, s[12:15], s27 offen offset:1024 lds
    s_add_u32 s27, s27, 65536
    s_add_u32 m0, s96, 16384
    s_nop 0
    buffer_load_dwordx4 v18, s[12:15], s27 offen offset:0 lds
    buffer_load_dwordx4 v19, s[12:15], s27 offen offset:1024 lds
    s_add_u32 s27, s27, 65536
    s_add_u32 m0, s96, 24576
    s_nop 0
    buffer_load_dwordx4 v18, s[12:15], s27 offen offset:0 lds
    buffer_load_dwordx4 v19, s[12:15], s27 offen offset:1024 lds
    s_add_u32 s27, s27, 65536
    s_sub_u32 s93, s24, 1
    s_or_b32 s93, s93, s62
    s_cmp_eq_u32 s20, 0
    s_cbranch_scc0 k_dep_seen
    s_mov_b32 s3, 0
k_dep_wait:
    global_load_dword v27, v26, s[98:99] offset:128 sc1
    s_waitcnt vmcnt(0)
    v_cmp_ne_u32 vcc, s100, v27
    s_add_u32 s3, s3, 1
    s_and_b32 s63, vcc_lo, s93
    s_cbranch_scc0 k_dep_seen
    s_cmp_gt_u32 s3, 0x40000
    s_cbranch_scc0 k_dep_wait
k_dep_seen:
    s_waitcnt vmcnt(0)
    s_barrier
    global_load_dword v27, v26, s[98:99] offset:128 sc1
    s_mov_b32 s63, s97
    s_cmp_eq_u32 s97, 1
    s_cbranch_scc1 k_b_half
    buffer_load_dwordx4 v[32:35], v20, s[8:11], s26 offen offset:0 sc1
    buffer_load_dwordx4 v[36:39], v21, s[8:11], s26 offen offset:0 sc1
    buffer_load_dwordx4 v[40:43], v22, s[8:11], s26 offen offset:0 sc1
    buffer_load_dwordx4 v[44:47], v23, s[8:11], s26 offen offset:0 sc1
    buffer_load_dwordx4 v[48:51], v20, s[8:11], s26 offen offset:1024 sc1
    buffer_load_dwordx4 v[52:55], v21, s[8:11], s26 offen offset:1024 sc1
    buffer_load_dwordx4 v[56:59], v22, s[8:11], s26 offen offset:1024 sc1
    buffer_load_dwordx4 v[60:63], v23, s[8:11], s26 offen offset:1024 sc1
    buffer_load_dwordx4 v[64:67], v20, s[8:11], s26 offen offset:2048 sc1
    buffer_load_dwordx4 v[68:71], v21, s[8:11], s26 offen offset:2048 sc1
    buffer_load_dwordx4 v[72:75], v22, s[8:11], s26 offen offset:2048 sc1
    buffer_load_dwordx4 v[76:79], v23, s[8:11], s26 offen offset:2048 sc1
    buffer_load_dwordx4 v[80:83], v20, s[8:11], s26 offen offset:3072 sc1
    buffer_load_dwordx4 v[84:87], v21, s[8:11], s26 offen offset:3072 sc1
    buffer_load_dwordx4 v[88:91], v22, s[8:11], s26 offen offset:3072 sc1
    buffer_load_dwordx4 v[92:95], v23, s[8:11], s26 offen offset:3072 sc1
    s_add_u32 s26, s26, 4096
    s_branch k_b_x
k_b_half:
    buffer_load_dwordx4 v[96:99], v20, s[8:11], s26 offen offset:0 sc1
    buffer_load_dwordx4 v[100:103], v21, s[8:11], s26 offen offset:0 sc1
    buffer_load_dwordx4 v[104:107], v22, s[8:11], s26 offen offset:0 sc1
    buffer_load_dwordx4 v[108:111], v23, s[8:11], s26 offen offset:0 sc1
    buffer_load_dwordx4 v[112:115], v20, s[8:11], s26 offen offset:1024 sc1
    buffer_load_dwordx4 v[116:119], v21, s[8:11], s26 offen offset:1024 sc1
    buffer_load_dwordx4 v[120:123], v22, s[8:11], s26 offen offset:1024 sc1
    buffer_load_dwordx4 v[124:127], v23, s[8:11], s26 offen offset:1024 sc1
    buffer_load_dwordx4 v[128:131], v20, s[8:11], s26 offen offset:2048 sc1
    buffer_load_dwordx4 v[132:135], v21, s[8:11], s26 offen offset:2048 sc1
    buffer_load_dwordx4 v[136:139], v22, s[8:11], s26 offen offset:2048 sc1
    buffer_load_dwordx4 v[140:143], v23, s[8:11], s26 offen offset:2048 sc1
    buffer_load_dwordx4 v[144:147], v20, s[8:11], s26 offen offset:3072 sc1
    buffer_load_dwordx4 v[148:151], v21, s[8:11], s26 offen offset:3072 sc1
    buffer_load_dwordx4 v[152:155], v22, s[8:11], s26 offen offset:3072 sc1
    buffer_load_dwordx4 v[156:159], v23, s[8:11], s26 offen offset:3072 sc1
k_b_x:
    s_mov_b32 s3, 0x40000000
    buffer_load_dword v31, v6, s[8:11], s3 offen
    buffer_load_dword v31, v6, s[8:11], s3 offen
    buffer_load_dword v31, v6, s[8:11], s3 offen
    buffer_load_dword v31, v6, s[8:11], s3 offen
    v_lshlrev_b32 v7, 11, v5
    v_sub_u32 v7, v24, v7
    v_lshlrev_b32 v8, 4, v4
    v_sub_u32 v7, v7, v8
    v_lshl_add_u32 v7, v4, 11, v7
    s_mov_b32 s96, 32768
    s_lshl_b32 s97, s20, 13
    s_add_u32 s97, s97, 65536
    v_add_u32 v8, 0, v4
    v_xor_b32 v8, v8, v5
    v_lshl_add_u32 v8, v8, 4, v7
    v_add_u32 v224, 0, v8
    v_accvgpr_write_b32 a128, v224
    v_add_u32 v8, 4, v4
    v_xor_b32 v8, v8, v5
    v_lshl_add_u32 v8, v8, 4, v7
    v_add_u32 v225, 7168, v8
    v_accvgpr_write_b32 a129, v225
    v_add_u32 v8, 8, v4
    v_xor_b32 v8, v8, v5
    v_lshl_add_u32 v8, v8, 4, v7
    v_add_u32 v226, 14336, v8
    v_accvgpr_write_b32 a130, v226
    v_add_u32 v8, 12, v4
    v_xor_b32 v8, v8, v5
    v_lshl_add_u32 v8, v8, 4, v7
    v_add_u32 v227, 21504, v8
    v_accvgpr_write_b32 a131, v227
    s_xor_b32 s3, s60, 8192
    v_mov_b32 v28, s3
    s_xor_b32 s3, s60, 16384
    v_mov_b32 v29, s3
    s_mov_b32 s28, 0
    s_cmp_eq_u32 s63, 1
    s_cbranch_scc0 k_b_full
    ds_read_b64_tr_b16 v[160:161], v10 offset:32768
    ds_read_b64_tr_b16 v[162:163], v10 offset:36864
    ds_read_b64_tr_b16 v[164:165], v11 offset:32768
    ds_read_b64_tr_b16 v[166:167], v11 offset:36864
    ds_read_b64_tr_b16 v[168:169], v12 offset:32768
    ds_read_b64_tr_b16 v[170:171], v12 offset:36864
    ds_read_b64_tr_b16 v[172:173], v13 offset:32768
    ds_read_b64_tr_b16 v[174:175], v13 offset:36864
    ds_read_b64_tr_b16 v[176:177], v14 offset:32768
    ds_read_b64_tr_b16 v[178:179], v14 offset:36864
    ds_read_b64_tr_b16 v[180:181], v15 offset:32768
    ds_read_b64_tr_b16 v[182:183], v15 offset:36864
    ds_read_b64_tr_b16 v[184:185], v16 offset:32768
    ds_read_b64_tr_b16 v[186:187], v16 offset:36864
    ds_read_b64_tr_b16 v[188:189], v17 offset:32768
    ds_read_b64_tr_b16 v[190:191], v17 offset:36864
    s_branch k_g2_mid
k_b_full:
    ds_read_b64_tr_b16 v[160:161], v10 offset:0
    ds_read_b64_tr_b16 v[162:163], v10 offset:4096
    ds_read_b64_tr_b16 v[164:165], v11 offset:0
    ds_read_b64_tr_b16 v[166:167], v11 offset:4096
    ds_read_b64_tr_b16 v[168:169], v12 offset:0
    ds_read_b64_tr_b16 v[170:171], v12 offset:4096
    ds_read_b64_tr_b16 v[172:173], v13 offset:0
    ds_read_b64_tr_b16 v[174:175], v13 offset:4096
    ds_read_b64_tr_b16 v[176:177], v14 offset:0
    ds_read_b64_tr_b16 v[178:179], v14 offset:4096
    ds_read_b64_tr_b16 v[180:181], v15 offset:0
    ds_read_b64_tr_b16 v[182:183], v15 offset:4096
    ds_read_b64_tr_b16 v[184:185], v16 offset:0
    ds_read_b64_tr_b16 v[186:187], v16 offset:4096
    ds_read_b64_tr_b16 v[188:189], v17 offset:0
    ds_read_b64_tr_b16 v[190:191], v17 offset:4096
k_g2_loop:
    s_waitcnt vmcnt(16) lgkmcnt(0)
    s_barrier
    v_mfma_f32_16x16x32_bf16 a[0:3], v[160:163], v[32:35], a[0:3]
    s_add_u32 m0, s23, 32768
    ds_read_b64_tr_b16 v[192:193], v10 offset:8192
    v_mfma_f32_16x16x32_bf16 a[4:7], v[164:167], v[32:35], a[4:7]
    buffer_load_dwordx4 v18, s[12:15], s27 offen offset:0 lds
    v_mfma_f32_16x16x32_bf16 a[8:11], v[168:171], v[32:35], a[8:11]
    ds_read_b64_tr_b16 v[194:195], v10 offset:12288
    v_mfma_f32_16x16x32_bf16 a[12:15], v[172:175], v[32:35], a[12:15]
    ds_read_b64_tr_b16 v[196:197], v11 offset:8192
    v_mfma_f32_16x16x32_bf16 a[16:19], v[176:179], v[32:35], a[16:19]
    ds_read_b64_tr_b16 v[198:199], v11 offset:12288
    v_mfma_f32_16x16x32_bf16 a[20:23], v[180:183], v[32:35], a[20:23]
    ds_read_b64_tr_b16 v[200:201], v12 offset:8192
    v_mfma_f32_16x16x32_bf16 a[24:27], v[184:187], v[32:35], a[24:27]
    buffer_load_dwordx4 v19, s[12:15], s27 offen offset:1024 lds
    v_mfma_f32_16x16x32_bf16 a[28:31], v[188:191], v[32:35], a[28:31]
    s_add_u32 s27, s27, 65536
    ds_read_b64_tr_b16 v[202:203], v12 offset:12288
    v_mfma_f32_16x16x32_bf16 a[32:35], v[160:163], v[36:39], a[32:35]
    ds_read_b64_tr_b16 v[204:205], v13 offset:8192
    v_mfma_f32_16x16x32_bf16 a[36:39], v[164:167], v[36:39], a[36:39]
    ds_read_b64_tr_b16 v[206:207], v13 offset:12288
    v_mfma_f32_16x16x32_bf16 a[40:43], v[168:171], v[36:39], a[40:43]
    ds_read_b64_tr_b16 v[208:209], v14 offset:8192
    v_mfma_f32_16x16x32_bf16 a[44:47], v[172:175], v[36:39], a[44:47]
    buffer_load_dwordx4 v[96:99], v20, s[8:11], s26 offen offset:0 sc1
    v_mfma_f32_16x16x32_bf16 a[48:51], v[176:179], v[36:39], a[48:51]
    ds_read_b64_tr_b16 v[210:211], v14 offset:12288
    v_mfma_f32_16x16x32_bf16 a[52:55], v[180:183], v[36:39], a[52:55]
    ds_read_b64_tr_b16 v[212:213], v15 offset:8192
    v_mfma_f32_16x16x32_bf16 a[56:59], v[184:187], v[36:39], a[56:59]
    ds_read_b64_tr_b16 v[214:215], v15 offset:12288
    v_mfma_f32_16x16x32_bf16 a[60:63], v[188:191], v[36:39], a[60:63]
    ds_read_b64_tr_b16 v[216:217], v16 offset:8192
    v_mfma_f32_16x16x32_bf16 a[64:67], v[160:163], v[40:43], a[64:67]
    buffer_load_dwordx4 v[100:103], v21, s[8:11], s26 offen offset:0 sc1
    v_mfma_f32_16x16x32_bf16 a[68:71], v[164:167], v[40:43], a[68:71]
    ds_read_b64_tr_b16 v[218:219], v16 offset:12288
    v_mfma_f32_16x16x32_bf16 a[72:75], v[168:171], v[40:43], a[72:75]
    ds_read_b64_tr_b16 v[220:221], v17 offset:8192
    v_mfma_f32_16x16x32_bf16 a[76:79], v[172:175], v[40:43], a[76:79]
    ds_read_b64_tr_b16 v[222:223], v17 offset:12288
    v_mfma_f32_16x16x32_bf16 a[80:83], v[176:179], v[40:43], a[80:83]
    v_mfma_f32_16x16x32_bf16 a[84:87], v[180:183], v[40:43], a[84:87]
    buffer_load_dwordx4 v[104:107], v22, s[8:11], s26 offen offset:0 sc1
    v_mfma_f32_16x16x32_bf16 a[88:91], v[184:187], v[40:43], a[88:91]
    v_mfma_f32_16x16x32_bf16 a[92:95], v[188:191], v[40:43], a[92:95]
    v_mfma_f32_16x16x32_bf16 a[96:99], v[160:163], v[44:47], a[96:99]
    v_mfma_f32_16x16x32_bf16 a[100:103], v[164:167], v[44:47], a[100:103]
    v_mfma_f32_16x16x32_bf16 a[104:107], v[168:171], v[44:47], a[104:107]
    buffer_load_dwordx4 v[108:111], v23, s[8:11], s26 offen offset:0 sc1
    v_mfma_f32_16x16x32_bf16 a[108:111], v[172:175], v[44:47], a[108:111]
    v_mfma_f32_16x16x32_bf16 a[112:115], v[176:179], v[44:47], a[112:115]
    v_mfma_f32_16x16x32_bf16 a[116:119], v[180:183], v[44:47], a[116:119]
    global_load_dword v27, v26, s[98:99] offset:128 sc1
    v_mfma_f32_16x16x32_bf16 a[120:123], v[184:187], v[44:47], a[120:123]
    v_mfma_f32_16x16x32_bf16 a[124:127], v[188:191], v[44:47], a[124:127]
    s_waitcnt vmcnt(16) lgkmcnt(0)
    s_barrier
    v_mfma_f32_16x16x32_bf16 a[0:3], v[192:195], v[48:51], a[0:3]
    s_add_u32 m0, s23, 40960
    ds_read_b64_tr_b16 v[160:161], v10 offset:16384
    v_mfma_f32_16x16x32_bf16 a[4:7], v[196:199], v[48:51], a[4:7]
    buffer_load_dwordx4 v18, s[12:15], s27 offen offset:0 lds
    v_mfma_f32_16x16x32_bf16 a[8:11], v[200:203], v[48:51], a[8:11]
    ds_read_b64_tr_b16 v[162:163], v10 offset:20480
    v_mfma_f32_16x16x32_bf16 a[12:15], v[204:207], v[48:51], a[12:15]
    ds_read_b64_tr_b16 v[164:165], v11 offset:16384
    v_mfma_f32_16x16x32_bf16 a[16:19], v[208:211], v[48:51], a[16:19]
    ds_read_b64_tr_b16 v[166:167], v11 offset:20480
    v_mfma_f32_16x16x32_bf16 a[20:23], v[212:215], v[48:51], a[20:23]
    ds_read_b64_tr_b16 v[168:169], v12 offset:16384
    v_mfma_f32_16x16x32_bf16 a[24:27], v[216:219], v[48:51], a[24:27]
    buffer_load_dwordx4 v19, s[12:15], s27 offen offset:1024 lds
    v_mfma_f32_16x16x32_bf16 a[28:31], v[220:223], v[48:51], a[28:31]
    s_add_u32 s27, s27, 65536
    ds_read_b64_tr_b16 v[170:171], v12 offset:20480
    v_mfma_f32_16x16x32_bf16 a[32:35], v[192:195], v[52:55], a[32:35]
    ds_read_b64_tr_b16 v[172:173], v13 offset:16384
    v_mfma_f32_16x16x32_bf16 a[36:39], v[196:199], v[52:55], a[36:39]
    ds_read_b64_tr_b16 v[174:175], v13 offset:20480
    v_mfma_f32_16x16x32_bf16 a[40:43], v[200:203], v[52:55], a[40:43]
    ds_read_b64_tr_b16 v[176:177], v14 offset:16384
    v_mfma_f32_16x16x32_bf16 a[44:47], v[204:207], v[52:55], a[44:47]
    buffer_load_dwordx4 v[112:115], v20, s[8:11], s26 offen offset:1024 sc1
    v_mfma_f32_16x16x32_bf16 a[48:51], v[208:211], v[52:55], a[48:51]
    ds_read_b64_tr_b16 v[178:179], v14 offset:20480
    v_mfma_f32_16x16x32_bf16 a[52:55], v[212:215], v[52:55], a[52:55]
    ds_read_b64_tr_b16 v[180:181], v15 offset:16384
    v_mfma_f32_16x16x32_bf16 a[56:59], v[216:219], v[52:55], a[56:59]
    ds_read_b64_tr_b16 v[182:183], v15 offset:20480
    v_mfma_f32_16x16x32_bf16 a[60:63], v[220:223], v[52:55], a[60:63]
    ds_read_b64_tr_b16 v[184:185], v16 offset:16384
    v_mfma_f32_16x16x32_bf16 a[64:67], v[192:195], v[56:59], a[64:67]
    buffer_load_dwordx4 v[116:119], v21, s[8:11], s26 offen offset:1024 sc1
    v_mfma_f32_16x16x32_bf16 a[68:71], v[196:199], v[56:59], a[68:71]
    ds_read_b64_tr_b16 v[186:187], v16 offset:20480
    v_mfma_f32_16x16x32_bf16 a[72:75], v[200:203], v[56:59], a[72:75]
    ds_read_b64_tr_b16 v[188:189], v17 offset:16384
    v_mfma_f32_16x16x32_bf16 a[76:79], v[204:207], v[56:59], a[76:79]
    ds_read_b64_tr_b16 v[190:191], v17 offset:20480
    v_mfma_f32_16x16x32_bf16 a[80:83], v[208:211], v[56:59], a[80:83]
    v_mfma_f32_16x16x32_bf16 a[84:87], v[212:215], v[56:59], a[84:87]
    buffer_load_dwordx4 v[120:123], v22, s[8:11], s26 offen offset:1024 sc1
    v_mfma_f32_16x16x32_bf16 a[88:91], v[216:219], v[56:59], a[88:91]
    v_mfma_f32_16x16x32_bf16 a[92:95], v[220:223], v[56:59], a[92:95]
    v_mfma_f32_16x16x32_bf16 a[96:99], v[192:195], v[60:63], a[96:99]
    v_mfma_f32_16x16x32_bf16 a[100:103], v[196:199], v[60:63], a[100:103]
    v_mfma_f32_16x16x32_bf16 a[104:107], v[200:203], v[60:63], a[104:107]
    buffer_load_dwordx4 v[124:127], v23, s[8:11], s26 offen offset:1024 sc1
    v_mfma_f32_16x16x32_bf16 a[108:111], v[204:207], v[60:63], a[108:111]
    v_mfma_f32_16x16x32_bf16 a[112:115], v[208:211], v[60:63], a[112:115]
    v_mfma_f32_16x16x32_bf16 a[116:119], v[212:215], v[60:63], a[116:119]
    v_mfma_f32_16x16x32_bf16 a[120:123], v[216:219], v[60:63], a[120:123]
    v_mfma_f32_16x16x32_bf16 a[124:127], v[220:223], v[60:63], a[124:127]
    s_waitcnt vmcnt(16) lgkmcnt(0)
    s_barrier
    v_mfma_f32_16x16x32_bf16 a[0:3], v[160:163], v[64:67], a[0:3]
    s_add_u32 m0, s23, 49152
    ds_read_b64_tr_b16 v[192:193], v10 offset:24576
    v_mfma_f32_16x16x32_bf16 a[4:7], v[164:167], v[64:67], a[4:7]
    buffer_load_dwordx4 v18, s[12:15], s27 offen offset:0 lds
    v_mfma_f32_16x16x32_bf16 a[8:11], v[168:171], v[64:67], a[8:11]
    ds_read_b64_tr_b16 v[194:195], v10 offset:28672
    v_mfma_f32_16x16x32_bf16 a[12:15], v[172:175], v[64:67], a[12:15]
    ds_read_b64_tr_b16 v[196:197], v11 offset:24576
    v_mfma_f32_16x16x32_bf16 a[16:19], v[176:179], v[64:67], a[16:19]
    ds_read_b64_tr_b16 v[198:199], v11 offset:28672
    v_mfma_f32_16x16x32_bf16 a[20:23], v[180:183], v[64:67], a[20:23]
    ds_read_b64_tr_b16 v[200:201], v12 offset:24576
    v_mfma_f32_16x16x32_bf16 a[24:27], v[184:187], v[64:67], a[24:27]
    buffer_load_dwordx4 v19, s[12:15], s27 offen offset:1024 lds
    v_mfma_f32_16x16x32_bf16 a[28:31], v[188:191], v[64:67], a[28:31]
    s_add_u32 s27, s27, 65536
    ds_read_b64_tr_b16 v[202:203], v12 offset:28672
    v_mfma_f32_16x16x32_bf16 a[32:35], v[160:163], v[68:71], a[32:35]
    ds_read_b64_tr_b16 v[204:205], v13 offset:24576
    v_mfma_f32_16x16x32_bf16 a[36:39], v[164:167], v[68:71], a[36:39]
    ds_read_b64_tr_b16 v[206:207], v13 offset:28672
    v_mfma_f32_16x16x32_bf16 a[40:43], v[168:171], v[68:71], a[40:43]
    ds_read_b64_tr_b16 v[208:209], v14 offset:24576
    v_mfma_f32_16x16x32_bf16 a[44:47], v[172:175], v[68:71], a[44:47]
    buffer_load_dwordx4 v[128:131], v20, s[8:11], s26 offen offset:2048 sc1
    v_mfma_f32_16x16x32_bf16 a[48:51], v[176:179], v[68:71], a[48:51]
    ds_read_b64_tr_b16 v[210:211], v14 offset:28672
    v_mfma_f32_16x16x32_bf16 a[52:55], v[180:183], v[68:71], a[52:55]
    ds_read_b64_tr_b16 v[212:213], v15 offset:24576
    v_mfma_f32_16x16x32_bf16 a[56:59], v[184:187], v[68:71], a[56:59]
    ds_read_b64_tr_b16 v[214:215], v15 offset:28672
    v_mfma_f32_16x16x32_bf16 a[60:63], v[188:191], v[68:71], a[60:63]
    ds_read_b64_tr_b16 v[216:217], v16 offset:24576
    v_mfma_f32_16x16x32_bf16 a[64:67], v[160:163], v[72:75], a[64:67]
    buffer_load_dwordx4 v[132:135], v21, s[8:11], s26 offen offset:2048 sc1
    v_mfma_f32_16x16x32_bf16 a[68:71], v[164:167], v[72:75], a[68:71]
    ds_read_b64_tr_b16 v[218:219], v16 offset:28672
    v_mfma_f32_16x16x32_bf16 a[72:75], v[168:171], v[72:75], a[72:75]
    ds_read_b64_tr_b16 v[220:221], v17 offset:24576
    v_mfma_f32_16x16x32_bf16 a[76:79], v[172:175], v[72:75], a[76:79]
    ds_read_b64_tr_b16 v[222:223], v17 offset:28672
    v_mfma_f32_16x16x32_bf16 a[80:83], v[176:179], v[72:75], a[80:83]
    v_mfma_f32_16x16x32_bf16 a[84:87], v[180:183], v[72:75], a[84:87]
    buffer_load_dwordx4 v[136:139], v22, s[8:11], s26 offen offset:2048 sc1
    v_mfma_f32_16x16x32_bf16 a[88:91], v[184:187], v[72:75], a[88:91]
    v_mfma_f32_16x16x32_bf16 a[92:95], v[188:191], v[72:75], a[92:95]
    v_mfma_f32_16x16x32_bf16 a[96:99], v[160:163], v[76:79], a[96:99]
    v_mfma_f32_16x16x32_bf16 a[100:103], v[164:167], v[76:79], a[100:103]
    v_mfma_f32_16x16x32_bf16 a[104:107], v[168:171], v[76:79], a[104:107]
    buffer_load_dwordx4 v[140:143], v23, s[8:11], s26 offen offset:2048 sc1
    v_mfma_f32_16x16x32_bf16 a[108:111], v[172:175], v[76:79], a[108:111]
    v_mfma_f32_16x16x32_bf16 a[112:115], v[176:179], v[76:79], a[112:115]
    v_mfma_f32_16x16x32_bf16 a[116:119], v[180:183], v[76:79], a[116:119]
    v_mfma_f32_16x16x32_bf16 a[120:123], v[184:187], v[76:79], a[120:123]
    v_mfma_f32_16x16x32_bf16 a[124:127], v[188:191], v[76:79], a[124:127]
    s_waitcnt vmcnt(16) lgkmcnt(0)
    s_barrier
    v_mfma_f32_16x16x32_bf16 a[0:3], v[192:195], v[80:83], a[0:3]
    s_add_u32 m0, s23, 57344
    ds_read_b64_tr_b16 v[160:161], v10 offset:32768
    v_mfma_f32_16x16x32_bf16 a[4:7], v[196:199], v[80:83], a[4:7]
    buffer_load_dwordx4 v18, s[12:15], s27 offen offset:0 lds
    v_mfma_f32_16x16x32_bf16 a[8:11], v[200:203], v[80:83], a[8:11]
    ds_read_b64_tr_b16 v[162:163], v10 offset:36864
    v_mfma_f32_16x16x32_bf16 a[12:15], v[204:207], v[80:83], a[12:15]
    ds_read_b64_tr_b16 v[164:165], v11 offset:32768
    v_mfma_f32_16x16x32_bf16 a[16:19], v[208:211], v[80:83], a[16:19]
    ds_read_b64_tr_b16 v[166:167], v11 offset:36864
    v_mfma_f32_16x16x32_bf16 a[20:23], v[212:215], v[80:83], a[20:23]
    ds_read_b64_tr_b16 v[168:169], v12 offset:32768
    v_mfma_f32_16x16x32_bf16 a[24:27], v[216:219], v[80:83], a[24:27]
    buffer_load_dwordx4 v19, s[12:15], s27 offen offset:1024 lds
    v_mfma_f32_16x16x32_bf16 a[28:31], v[220:223], v[80:83], a[28:31]
    s_add_u32 s27, s27, 65536
    ds_read_b64_tr_b16 v[170:171], v12 offset:36864
    v_mfma_f32_16x16x32_bf16 a[32:35], v[192:195], v[84:87], a[32:35]
    ds_read_b64_tr_b16 v[172:173], v13 offset:32768
    v_mfma_f32_16x16x32_bf16 a[36:39], v[196:199], v[84:87], a[36:39]
    ds_read_b64_tr_b16 v[174:175], v13 offset:36864
    v_mfma_f32_16x16x32_bf16 a[40:43], v[200:203], v[84:87], a[40:43]
    ds_read_b64_tr_b16 v[176:177], v14 offset:32768
    v_mfma_f32_16x16x32_bf16 a[44:47], v[204:207], v[84:87], a[44:47]
    buffer_load_dwordx4 v[144:147], v20, s[8:11], s26 offen offset:3072 sc1
    v_mfma_f32_16x16x32_bf16 a[48:51], v[208:211], v[84:87], a[48:51]
    ds_read_b64_tr_b16 v[178:179], v14 offset:36864
    v_mfma_f32_16x16x32_bf16 a[52:55], v[212:215], v[84:87], a[52:55]
    ds_read_b64_tr_b16 v[180:181], v15 offset:32768
    v_mfma_f32_16x16x32_bf16 a[56:59], v[216:219], v[84:87], a[56:59]
    ds_read_b64_tr_b16 v[182:183], v15 offset:36864
    v_mfma_f32_16x16x32_bf16 a[60:63], v[220:223], v[84:87], a[60:63]
    ds_read_b64_tr_b16 v[184:185], v16 offset:32768
    v_mfma_f32_16x16x32_bf16 a[64:67], v[192:195], v[88:91], a[64:67]
    buffer_load_dwordx4 v[148:151], v21, s[8:11], s26 offen offset:3072 sc1
    v_mfma_f32_16x16x32_bf16 a[68:71], v[196:199], v[88:91], a[68:71]
    ds_read_b64_tr_b16 v[186:187], v16 offset:36864
    v_mfma_f32_16x16x32_bf16 a[72:75], v[200:203], v[88:91], a[72:75]
    ds_read_b64_tr_b16 v[188:189], v17 offset:32768
    v_mfma_f32_16x16x32_bf16 a[76:79], v[204:207], v[88:91], a[76:79]
    ds_read_b64_tr_b16 v[190:191], v17 offset:36864
    v_mfma_f32_16x16x32_bf16 a[80:83], v[208:211], v[88:91], a[80:83]
    v_mfma_f32_16x16x32_bf16 a[84:87], v[212:215], v[88:91], a[84:87]
    buffer_load_dwordx4 v[152:155], v22, s[8:11], s26 offen offset:3072 sc1
    v_mfma_f32_16x16x32_bf16 a[88:91], v[216:219], v[88:91], a[88:91]
    v_mfma_f32_16x16x32_bf16 a[92:95], v[220:223], v[88:91], a[92:95]
    v_mfma_f32_16x16x32_bf16 a[96:99], v[192:195], v[92:95], a[96:99]
    v_mfma_f32_16x16x32_bf16 a[100:103], v[196:199], v[92:95], a[100:103]
    v_mfma_f32_16x16x32_bf16 a[104:107], v[200:203], v[92:95], a[104:107]
    buffer_load_dwordx4 v[156:159], v23, s[8:11], s26 offen offset:3072 sc1
    v_mfma_f32_16x16x32_bf16 a[108:111], v[204:207], v[92:95], a[108:111]
    v_mfma_f32_16x16x32_bf16 a[112:115], v[208:211], v[92:95], a[112:115]
    v_mfma_f32_16x16x32_bf16 a[116:119], v[212:215], v[92:95], a[116:119]
    v_mfma_f32_16x16x32_bf16 a[120:123], v[216:219], v[92:95], a[120:123]
    v_mfma_f32_16x16x32_bf16 a[124:127], v[220:223], v[92:95], a[124:127]
k_g2_mid:
    s_waitcnt vmcnt(16) lgkmcnt(0)
    s_and_b32 s63, s30, 31
    s_lshr_b64 s[30:31], s[30:31], 5
    s_lshl_b32 s27, s63, 18
    s_lshl_b32 s26, s63, 12
    s_lshl_b32 s62, 3, s63
    s_mul_i32 s62, s62, s24
    v_cmp_ne_u32 vcc, s100, v27
    s_mov_b32 s3, 0
    s_and_b32 s63, vcc_lo, s62
    s_cbranch_scc0 k_grp_ok
k_grp_wait:
    global_load_dword v27, v26, s[98:99] offset:128 sc1
    s_waitcnt vmcnt(0)
    v_cmp_ne_u32 vcc, s100, v27
    s_add_u32 s3, s3, 1
    s_and_b32 s63, vcc_lo, s62
    s_cbranch_scc0 k_grp_ok
    s_cmp_gt_u32 s3, 0x40000
    s_cbranch_scc0 k_grp_wait
k_grp_ok:
    s_barrier
    v_mfma_f32_16x16x32_bf16 a[0:3], v[160:163], v[96:99], a[0:3]
    s_add_u32 m0, s23, 0
    ds_read_b64_tr_b16 v[192:193], v10 offset:40960
    v_mfma_f32_16x16x32_bf16 a[4:7], v[164:167], v[96:99], a[4:7]
    buffer_load_dwordx4 v18, s[12:15], s27 offen offset:0 lds
    v_mfma_f32_16x16x32_bf16 a[8:11], v[168:171], v[96:99], a[8:11]
    ds_read_b64_tr_b16 v[194:195], v10 offset:45056
    v_mfma_f32_16x16x32_bf16 a[12:15], v[172:175], v[96:99], a[12:15]
    ds_read_b64_tr_b16 v[196:197], v11 offset:40960
    v_mfma_f32_16x16x32_bf16 a[16:19], v[176:179], v[96:99], a[16:19]
    ds_read_b64_tr_b16 v[198:199], v11 offset:45056
    v_mfma_f32_16x16x32_bf16 a[20:23], v[180:183], v[96:99], a[20:23]
    ds_read_b64_tr_b16 v[200:201], v12 offset:40960
    v_mfma_f32_16x16x32_bf16 a[24:27], v[184:187], v[96:99], a[24:27]
    buffer_load_dwordx4 v19, s[12:15], s27 offen offset:1024 lds
    v_mfma_f32_16x16x32_bf16 a[28:31], v[188:191], v[96:99], a[28:31]
    s_add_u32 s27, s27, 65536
    ds_read_b64_tr_b16 v[202:203], v12 offset:45056
    v_mfma_f32_16x16x32_bf16 a[32:35], v[160:163], v[100:103], a[32:35]
    ds_read_b64_tr_b16 v[204:205], v13 offset:40960
    v_mfma_f32_16x16x32_bf16 a[36:39], v[164:167], v[100:103], a[36:39]
    ds_read_b64_tr_b16 v[206:207], v13 offset:45056
    v_mfma_f32_16x16x32_bf16 a[40:43], v[168:171], v[100:103], a[40:43]
    ds_read_b64_tr_b16 v[208:209], v14 offset:40960
    v_mfma_f32_16x16x32_bf16 a[44:47], v[172:175], v[100:103], a[44:47]
    buffer_load_dwordx4 v[32:35], v20, s[8:11], s26 offen offset:0 sc1
    v_mfma_f32_16x16x32_bf16 a[48:51], v[176:179], v[100:103], a[48:51]
    ds_read_b64_tr_b16 v[210:211], v14 offset:45056
    v_mfma_f32_16x16x32_bf16 a[52:55], v[180:183], v[100:103], a[52:55]
    ds_read_b64_tr_b16 v[212:213], v15 offset:40960
    v_mfma_f32_16x16x32_bf16 a[56:59], v[184:187], v[100:103], a[56:59]
    ds_read_b64_tr_b16 v[214:215], v15 offset:45056
    v_mfma_f32_16x16x32_bf16 a[60:63], v[188:191], v[100:103], a[60:63]
    ds_read_b64_tr_b16 v[216:217], v16 offset:40960
    v_mfma_f32_16x16x32_bf16 a[64:67], v[160:163], v[104:107], a[64:67]
    buffer_load_dwordx4 v[36:39], v21, s[8:11], s26 offen offset:0 sc1
    v_mfma_f32_16x16x32_bf16 a[68:71], v[164:167], v[104:107], a[68:71]
    ds_read_b64_tr_b16 v[218:219], v16 offset:45056
    v_mfma_f32_16x16x32_bf16 a[72:75], v[168:171], v[104:107], a[72:75]
    ds_read_b64_tr_b16 v[220:221], v17 offset:40960
    v_mfma_f32_16x16x32_bf16 a[76:79], v[172:175], v[104:107], a[76:79]
    ds_read_b64_tr_b16 v[222:223], v17 offset:45056
    v_mfma_f32_16x16x32_bf16 a[80:83], v[176:179], v[104:107], a[80:83]
    v_mfma_f32_16x16x32_bf16 a[84:87], v[180:183], v[104:107], a[84:87]
    buffer_load_dwordx4 v[40:43], v22, s[8:11], s26 offen offset:0 sc1
    v_mfma_f32_16x16x32_bf16 a[88:91], v[184:187], v[104:107], a[88:91]
    v_mfma_f32_16x16x32_bf16 a[92:95], v[188:191], v[104:107], a[92:95]
    v_mfma_f32_16x16x32_bf16 a[96:99], v[160:163], v[108:111], a[96:99]
    v_mfma_f32_16x16x32_bf16 a[100:103], v[164:167], v[108:111], a[100:103]
    v_mfma_f32_16x16x32_bf16 a[104:107], v[168:171], v[108:111], a[104:107]
    buffer_load_dwordx4 v[44:47], v23, s[8:11], s26 offen offset:0 sc1
    v_mfma_f32_16x16x32_bf16 a[108:111], v[172:175], v[108:111], a[108:111]
    v_mfma_f32_16x16x32_bf16 a[112:115], v[176:179], v[108:111], a[112:115]
    v_mfma_f32_16x16x32_bf16 a[116:119], v[180:183], v[108:111], a[116:119]
    v_mfma_f32_16x16x32_bf16 a[120:123], v[184:187], v[108:111], a[120:123]
    v_mfma_f32_16x16x32_bf16 a[124:127], v[188:191], v[108:111], a[124:127]
    s_waitcnt vmcnt(16) lgkmcnt(0)
    s_barrier
    v_mfma_f32_16x16x32_bf16 a[0:3], v[192:195], v[112:115], a[0:3]
    s_add_u32 m0, s23, 8192
    ds_read_b64_tr_b16 v[160:161], v10 offset:49152
    v_mfma_f32_16x16x32_bf16 a[4:7], v[196:199], v[112:115], a[4:7]
    buffer_load_dwordx4 v18, s[12:15], s27 offen offset:0 lds
    v_mfma_f32_16x16x32_bf16 a[8:11], v[200:203], v[112:115], a[8:11]
    ds_read_b64_tr_b16 v[162:163], v10 offset:53248
    v_mfma_f32_16x16x32_bf16 a[12:15], v[204:207], v[112:115], a[12:15]
    ds_read_b64_tr_b16 v[164:165], v11 offset:49152
    v_mfma_f32_16x16x32_bf16 a[16:19], v[208:211], v[112:115], a[16:19]
    ds_read_b64_tr_b16 v[166:167], v11 offset:53248
    v_mfma_f32_16x16x32_bf16 a[20:23], v[212:215], v[112:115], a[20:23]
    ds_read_b64_tr_b16 v[168:169], v12 offset:49152
    v_mfma_f32_16x16x32_bf16 a[24:27], v[216:219], v[112:115], a[24:27]
    buffer_load_dwordx4 v19, s[12:15], s27 offen offset:1024 lds
    v_mfma_f32_16x16x32_bf16 a[28:31], v[220:223], v[112:115], a[28:31]
    s_add_u32 s27, s27, 65536
    ds_read_b64_tr_b16 v[170:171], v12 offset:53248
    v_mfma_f32_16x16x32_bf16 a[32:35], v[192:195], v[116:119], a[32:35]
    ds_read_b64_tr_b16 v[172:173], v13 offset:49152
    v_mfma_f32_16x16x32_bf16 a[36:39], v[196:199], v[116:119], a[36:39]
    ds_read_b64_tr_b16 v[174:175], v13 offset:53248
    v_mfma_f32_16x16x32_bf16 a[40:43], v[200:203], v[116:119], a[40:43]
    ds_read_b64_tr_b16 v[176:177], v14 offset:49152
    v_mfma_f32_16x16x32_bf16 a[44:47], v[204:207], v[116:119], a[44:47]
    buffer_load_dwordx4 v[48:51], v20, s[8:11], s26 offen offset:1024 sc1
    v_mfma_f32_16x16x32_bf16 a[48:51], v[208:211], v[116:119], a[48:51]
    ds_read_b64_tr_b16 v[178:179], v14 offset:53248
    v_mfma_f32_16x16x32_bf16 a[52:55], v[212:215], v[116:119], a[52:55]
    ds_read_b64_tr_b16 v[180:181], v15 offset:49152
    v_mfma_f32_16x16x32_bf16 a[56:59], v[216:219], v[116:119], a[56:59]
    ds_read_b64_tr_b16 v[182:183], v15 offset:53248
    v_mfma_f32_16x16x32_bf16 a[60:63], v[220:223], v[116:119], a[60:63]
    ds_read_b64_tr_b16 v[184:185], v16 offset:49152
    v_mfma_f32_16x16x32_bf16 a[64:67], v[192:195], v[120:123], a[64:67]
    buffer_load_dwordx4 v[52:55], v21, s[8:11], s26 offen offset:1024 sc1
    v_mfma_f32_16x16x32_bf16 a[68:71], v[196:199], v[120:123], a[68:71]
    ds_read_b64_tr_b16 v[186:187], v16 offset:53248
    v_mfma_f32_16x16x32_bf16 a[72:75], v[200:203], v[120:123], a[72:75]
    ds_read_b64_tr_b16 v[188:189], v17 offset:49152
    v_mfma_f32_16x16x32_bf16 a[76:79], v[204:207], v[120:123], a[76:79]
    ds_read_b64_tr_b16 v[190:191], v17 offset:53248
    v_mfma_f32_16x16x32_bf16 a[80:83], v[208:211], v[120:123], a[80:83]
    v_mfma_f32_16x16x32_bf16 a[84:87], v[212:215], v[120:123], a[84:87]
    buffer_load_dwordx4 v[56:59], v22, s[8:11], s26 offen offset:1024 sc1
    v_mfma_f32_16x16x32_bf16 a[88:91], v[216:219], v[120:123], a[88:91]
    v_mfma_f32_16x16x32_bf16 a[92:95], v[220:223], v[120:123], a[92:95]
    v_mfma_f32_16x16x32_bf16 a[96:99], v[192:195], v[124:127], a[96:99]
    v_mfma_f32_16x16x32_bf16 a[100:103], v[196:199], v[124:127], a[100:103]
    v_mfma_f32_16x16x32_bf16 a[104:107], v[200:203], v[124:127], a[104:107]
    buffer_load_dwordx4 v[60:63], v23, s[8:11], s26 offen offset:1024 sc1
    v_mfma_f32_16x16x32_bf16 a[108:111], v[204:207], v[124:127], a[108:111]
    v_mfma_f32_16x16x32_bf16 a[112:115], v[208:211], v[124:127], a[112:115]
    v_mfma_f32_16x16x32_bf16 a[116:119], v[212:215], v[124:127], a[116:119]
    v_mfma_f32_16x16x32_bf16 a[120:123], v[216:219], v[124:127], a[120:123]
    v_mfma_f32_16x16x32_bf16 a[124:127], v[220:223], v[124:127], a[124:127]
    s_waitcnt vmcnt(16) lgkmcnt(0)
    s_barrier
    v_mfma_f32_16x16x32_bf16 a[0:3], v[160:163], v[128:131], a[0:3]
    s_add_u32 m0, s23, 16384
    ds_read_b64_tr_b16 v[192:193], v10 offset:57344
    v_mfma_f32_16x16x32_bf16 a[4:7], v[164:167], v[128:131], a[4:7]
    buffer_load_dwordx4 v18, s[12:15], s27 offen offset:0 lds
    v_mfma_f32_16x16x32_bf16 a[8:11], v[168:171], v[128:131], a[8:11]
    ds_read_b64_tr_b16 v[194:195], v10 offset:61440
    v_mfma_f32_16x16x32_bf16 a[12:15], v[172:175], v[128:131], a[12:15]
    ds_read_b64_tr_b16 v[196:197], v11 offset:57344
    v_mfma_f32_16x16x32_bf16 a[16:19], v[176:179], v[128:131], a[16:19]
    ds_read_b64_tr_b16 v[198:199], v11 offset:61440
    v_mfma_f32_16x16x32_bf16 a[20:23], v[180:183], v[128:131], a[20:23]
    ds_read_b64_tr_b16 v[200:201], v12 offset:57344
    v_mfma_f32_16x16x32_bf16 a[24:27], v[184:187], v[128:131], a[24:27]
    buffer_load_dwordx4 v19, s[12:15], s27 offen offset:1024 lds
    v_mfma_f32_16x16x32_bf16 a[28:31], v[188:191], v[128:131], a[28:31]
    s_add_u32 s27, s27, 65536
    ds_read_b64_tr_b16 v[202:203], v12 offset:61440
    v_mfma_f32_16x16x32_bf16 a[32:35], v[160:163], v[132:135], a[32:35]
    ds_read_b64_tr_b16 v[204:205], v13 offset:57344
    v_mfma_f32_16x16x32_bf16 a[36:39], v[164:167], v[132:135], a[36:39]
    ds_read_b64_tr_b16 v[206:207], v13 offset:61440
    v_mfma_f32_16x16x32_bf16 a[40:43], v[168:171], v[132:135], a[40:43]
    ds_read_b64_tr_b16 v[208:209], v14 offset:57344
    v_mfma_f32_16x16x32_bf16 a[44:47], v[172:175], v[132:135], a[44:47]
    buffer_load_dwordx4 v[64:67], v20, s[8:11], s26 offen offset:2048 sc1
    v_mfma_f32_16x16x32_bf16 a[48:51], v[176:179], v[132:135], a[48:51]
    ds_read_b64_tr_b16 v[210:211], v14 offset:61440
    v_mfma_f32_16x16x32_bf16 a[52:55], v[180:183], v[132:135], a[52:55]
    ds_read_b64_tr_b16 v[212:213], v15 offset:57344
    v_mfma_f32_16x16x32_bf16 a[56:59], v[184:187], v[132:135], a[56:59]
    ds_read_b64_tr_b16 v[214:215], v15 offset:61440
    v_mfma_f32_16x16x32_bf16 a[60:63], v[188:191], v[132:135], a[60:63]
    ds_read_b64_tr_b16 v[216:217], v16 offset:57344
    v_mfma_f32_16x16x32_bf16 a[64:67], v[160:163], v[136:139], a[64:67]
    buffer_load_dwordx4 v[68:71], v21, s[8:11], s26 offen offset:2048 sc1
    v_mfma_f32_16x16x32_bf16 a[68:71], v[164:167], v[136:139], a[68:71]
    ds_read_b64_tr_b16 v[218:219], v16 offset:61440
    v_mfma_f32_16x16x32_bf16 a[72:75], v[168:171], v[136:139], a[72:75]
    ds_read_b64_tr_b16 v[220:221], v17 offset:57344
    v_mfma_f32_16x16x32_bf16 a[76:79], v[172:175], v[136:139], a[76:79]
    ds_read_b64_tr_b16 v[222:223], v17 offset:61440
    v_mfma_f32_16x16x32_bf16 a[80:83], v[176:179], v[136:139], a[80:83]
    v_mfma_f32_16x16x32_bf16 a[84:87], v[180:183], v[136:139], a[84:87]
    buffer_load_dwordx4 v[72:75], v22, s[8:11], s26 offen offset:2048 sc1
    v_mfma_f32_16x16x32_bf16 a[88:91], v[184:187], v[136:139], a[88:91]
    v_mfma_f32_16x16x32_bf16 a[92:95], v[188:191], v[136:139], a[92:95]
    v_mfma_f32_16x16x32_bf16 a[96:99], v[160:163], v[140:143], a[96:99]
    v_mfma_f32_16x16x32_bf16 a[100:103], v[164:167], v[140:143], a[100:103]
    v_mfma_f32_16x16x32_bf16 a[104:107], v[168:171], v[140:143], a[104:107]
    buffer_load_dwordx4 v[76:79], v23, s[8:11], s26 offen offset:2048 sc1
    v_mfma_f32_16x16x32_bf16 a[108:111], v[172:175], v[140:143], a[108:111]
    v_mfma_f32_16x16x32_bf16 a[112:115], v[176:179], v[140:143], a[112:115]
    v_mfma_f32_16x16x32_bf16 a[116:119], v[180:183], v[140:143], a[116:119]
    v_mfma_f32_16x16x32_bf16 a[120:123], v[184:187], v[140:143], a[120:123]
    v_mfma_f32_16x16x32_bf16 a[124:127], v[188:191], v[140:143], a[124:127]
    s_waitcnt vmcnt(16) lgkmcnt(0)
    s_barrier
    v_mfma_f32_16x16x32_bf16 a[0:3], v[192:195], v[144:147], a[0:3]
    s_add_u32 m0, s23, 24576
    ds_read_b64_tr_b16 v[160:161], v10 offset:0
    v_mfma_f32_16x16x32_bf16 a[4:7], v[196:199], v[144:147], a[4:7]
    buffer_load_dwordx4 v18, s[12:15], s27 offen offset:0 lds
    v_mfma_f32_16x16x32_bf16 a[8:11], v[200:203], v[144:147], a[8:11]
    ds_read_b64_tr_b16 v[162:163], v10 offset:4096
    v_mfma_f32_16x16x32_bf16 a[12:15], v[204:207], v[144:147], a[12:15]
    ds_read_b64_tr_b16 v[164:165], v11 offset:0
    v_mfma_f32_16x16x32_bf16 a[16:19], v[208:211], v[144:147], a[16:19]
    ds_read_b64_tr_b16 v[166:167], v11 offset:4096
    v_mfma_f32_16x16x32_bf16 a[20:23], v[212:215], v[144:147], a[20:23]
    ds_read_b64_tr_b16 v[168:169], v12 offset:0
    v_mfma_f32_16x16x32_bf16 a[24:27], v[216:219], v[144:147], a[24:27]
    buffer_load_dwordx4 v19, s[12:15], s27 offen offset:1024 lds
    v_mfma_f32_16x16x32_bf16 a[28:31], v[220:223], v[144:147], a[28:31]
    s_add_u32 s27, s27, 65536
    ds_read_b64_tr_b16 v[170:171], v12 offset:4096
    v_mfma_f32_16x16x32_bf16 a[32:35], v[192:195], v[148:151], a[32:35]
    ds_read_b64_tr_b16 v[172:173], v13 offset:0
    v_mfma_f32_16x16x32_bf16 a[36:39], v[196:199], v[148:151], a[36:39]
    ds_read_b64_tr_b16 v[174:175], v13 offset:4096
    v_mfma_f32_16x16x32_bf16 a[40:43], v[200:203], v[148:151], a[40:43]
    ds_read_b64_tr_b16 v[176:177], v14 offset:0
    v_mfma_f32_16x16x32_bf16 a[44:47], v[204:207], v[148:151], a[44:47]
    buffer_load_dwordx4 v[80:83], v20, s[8:11], s26 offen offset:3072 sc1
    v_mfma_f32_16x16x32_bf16 a[48:51], v[208:211], v[148:151], a[48:51]
    ds_read_b64_tr_b16 v[178:179], v14 offset:4096
    v_mfma_f32_16x16x32_bf16 a[52:55], v[212:215], v[148:151], a[52:55]
    ds_read_b64_tr_b16 v[180:181], v15 offset:0
    v_mfma_f32_16x16x32_bf16 a[56:59], v[216:219], v[148:151], a[56:59]
    ds_read_b64_tr_b16 v[182:183], v15 offset:4096
    v_mfma_f32_16x16x32_bf16 a[60:63], v[220:223], v[148:151], a[60:63]
    ds_read_b64_tr_b16 v[184:185], v16 offset:0
    v_mfma_f32_16x16x32_bf16 a[64:67], v[192:195], v[152:155], a[64:67]
    buffer_load_dwordx4 v[84:87], v21, s[8:11], s26 offen offset:3072 sc1
    v_mfma_f32_16x16x32_bf16 a[68:71], v[196:199], v[152:155], a[68:71]
    ds_read_b64_tr_b16 v[186:187], v16 offset:4096
    v_mfma_f32_16x16x32_bf16 a[72:75], v[200:203], v[152:155], a[72:75]
    ds_read_b64_tr_b16 v[188:189], v17 offset:0
    v_mfma_f32_16x16x32_bf16 a[76:79], v[204:207], v[152:155], a[76:79]
    ds_read_b64_tr_b16 v[190:191], v17 offset:4096
    v_mfma_f32_16x16x32_bf16 a[80:83], v[208:211], v[152:155], a[80:83]
    v_mfma_f32_16x16x32_bf16 a[84:87], v[212:215], v[152:155], a[84:87]
    buffer_load_dwordx4 v[88:91], v22, s[8:11], s26 offen offset:3072 sc1
    v_mfma_f32_16x16x32_bf16 a[88:91], v[216:219], v[152:155], a[88:91]
    v_mfma_f32_16x16x32_bf16 a[92:95], v[220:223], v[152:155], a[92:95]
    v_mfma_f32_16x16x32_bf16 a[96:99], v[192:195], v[156:159], a[96:99]
    v_mfma_f32_16x16x32_bf16 a[100:103], v[196:199], v[156:159], a[100:103]
    v_mfma_f32_16x16x32_bf16 a[104:107], v[200:203], v[156:159], a[104:107]
    buffer_load_dwordx4 v[92:95], v23, s[8:11], s26 offen offset:3072 sc1
    v_mfma_f32_16x16x32_bf16 a[108:111], v[204:207], v[156:159], a[108:111]
    v_mfma_f32_16x16x32_bf16 a[112:115], v[208:211], v[156:159], a[112:115]
    v_mfma_f32_16x16x32_bf16 a[116:119], v[212:215], v[156:159], a[116:119]
    v_mfma_f32_16x16x32_bf16 a[120:123], v[216:219], v[156:159], a[120:123]
    v_mfma_f32_16x16x32_bf16 a[124:127], v[220:223], v[156:159], a[124:127]
    s_add_u32 s26, s26, 4096
    s_add_u32 s28, s28, 1
    s_cmp_lt_u32 s28, s29
    s_cbranch_scc1 k_g2_loop
    s_mov_b32 s93, 4096
    s_mov_b32 s94, 8192
    s_mov_b32 s95, 12288
    s_waitcnt vmcnt(16) lgkmcnt(0)
    s_barrier
    v_mfma_f32_16x16x32_bf16 a[64:67], v[160:163], v[40:43], a[64:67]
    s_add_u32 m0, s23, 32768
    ds_read_b64_tr_b16 v[192:193], v10 offset:8192
    v_mfma_f32_16x16x32_bf16 a[68:71], v[164:167], v[40:43], a[68:71]
    buffer_load_dwordx4 v18, s[12:15], s27 offen offset:0 lds
    ds_read_b64_tr_b16 v[194:195], v10 offset:12288
    v_mfma_f32_16x16x32_bf16 a[72:75], v[168:171], v[40:43], a[72:75]
    ds_read_b64_tr_b16 v[196:197], v11 offset:8192
    v_mfma_f32_16x16x32_bf16 a[76:79], v[172:175], v[40:43], a[76:79]
    ds_read_b64_tr_b16 v[198:199], v11 offset:12288
    s_waitcnt lgkmcnt(4)
    v_mfma_f32_16x16x32_bf16 a[80:83], v[176:179], v[40:43], a[80:83]
    ds_read_b64_tr_b16 v[200:201], v12 offset:8192
    v_mfma_f32_16x16x32_bf16 a[84:87], v[180:183], v[40:43], a[84:87]
    buffer_load_dwordx4 v19, s[12:15], s27 offen offset:1024 lds
    ds_read_b64_tr_b16 v[202:203], v12 offset:12288
    v_mfma_f32_16x16x32_bf16 a[88:91], v[184:187], v[40:43], a[88:91]
    s_add_u32 s27, s27, 65536
    ds_read_b64_tr_b16 v[204:205], v13 offset:8192
    v_mfma_f32_16x16x32_bf16 a[92:95], v[188:191], v[40:43], a[92:95]
    ds_read_b64_tr_b16 v[206:207], v13 offset:12288
    v_mfma_f32_16x16x32_bf16 a[96:99], v[160:163], v[44:47], a[96:99]
    ds_read_b64_tr_b16 v[208:209], v14 offset:8192
    v_mfma_f32_16x16x32_bf16 a[100:103], v[164:167], v[44:47], a[100:103]
    buffer_load_dwordx4 v[104:107], v22, s[8:11], s26 offen offset:0 sc1
    ds_read_b64_tr_b16 v[210:211], v14 offset:12288
    v_mfma_f32_16x16x32_bf16 a[104:107], v[168:171], v[44:47], a[104:107]
    ds_read_b64_tr_b16 v[212:213], v15 offset:8192
    v_mfma_f32_16x16x32_bf16 a[108:111], v[172:175], v[44:47], a[108:111]
    ds_read_b64_tr_b16 v[214:215], v15 offset:12288
    v_mfma_f32_16x16x32_bf16 a[112:115], v[176:179], v[44:47], a[112:115]
    ds_read_b64_tr_b16 v[216:217], v16 offset:8192
    v_mfma_f32_16x16x32_bf16 a[116:119], v[180:183], v[44:47], a[116:119]
    buffer_load_dwordx4 v[108:111], v23, s[8:11], s26 offen offset:0 sc1
    ds_read_b64_tr_b16 v[218:219], v16 offset:12288
    v_mfma_f32_16x16x32_bf16 a[120:123], v[184:187], v[44:47], a[120:123]
    ds_read_b64_tr_b16 v[220:221], v17 offset:8192
    v_mfma_f32_16x16x32_bf16 a[124:127], v[188:191], v[44:47], a[124:127]
    ds_read_b64_tr_b16 v[222:223], v17 offset:12288
    s_waitcnt vmcnt(14) lgkmcnt(8)
    s_barrier
    v_mfma_f32_16x16x32_bf16 a[64:67], v[192:195], v[56:59], a[64:67]
    s_add_u32 m0, s23, 40960
    ds_read_b64_tr_b16 v[160:161], v10 offset:16384
    v_mfma_f32_16x16x32_bf16 a[68:71], v[196:199], v[56:59], a[68:71]
    buffer_load_dwordx4 v18, s[12:15], s27 offen offset:0 lds
    ds_read_b64_tr_b16 v[162:163], v10 offset:20480
    v_mfma_f32_16x16x32_bf16 a[72:75], v[200:203], v[56:59], a[72:75]
    ds_read_b64_tr_b16 v[164:165], v11 offset:16384
    v_mfma_f32_16x16x32_bf16 a[76:79], v[204:207], v[56:59], a[76:79]
    ds_read_b64_tr_b16 v[166:167], v11 offset:20480
    s_waitcnt lgkmcnt(4)
    v_mfma_f32_16x16x32_bf16 a[80:83], v[208:211], v[56:59], a[80:83]
    ds_read_b64_tr_b16 v[168:169], v12 offset:16384
    v_mfma_f32_16x16x32_bf16 a[84:87], v[212:215], v[56:59], a[84:87]
    buffer_load_dwordx4 v19, s[12:15], s27 offen offset:1024 lds
    ds_read_b64_tr_b16 v[170:171], v12 offset:20480
    v_mfma_f32_16x16x32_bf16 a[88:91], v[216:219], v[56:59], a[88:91]
    s_add_u32 s27, s27, 65536
    ds_read_b64_tr_b16 v[172:173], v13 offset:16384
    v_mfma_f32_16x16x32_bf16 a[92:95], v[220:223], v[56:59], a[92:95]
    ds_read_b64_tr_b16 v[174:175], v13 offset:20480
    v_mfma_f32_16x16x32_bf16 a[96:99], v[192:195], v[60:63], a[96:99]
    ds_read_b64_tr_b16 v[176:177], v14 offset:16384
    v_mfma_f32_16x16x32_bf16 a[100:103], v[196:199], v[60:63], a[100:103]
    buffer_load_dwordx4 v[120:123], v22, s[8:11], s26 offen offset:1024 sc1
    ds_read_b64_tr_b16 v[178:179], v14 offset:20480
    v_mfma_f32_16x16x32_bf16 a[104:107], v[200:203], v[60:63], a[104:107]
    ds_read_b64_tr_b16 v[180:181], v15 offset:16384
    v_mfma_f32_16x16x32_bf16 a[108:111], v[204:207], v[60:63], a[108:111]
    ds_read_b64_tr_b16 v[182:183], v15 offset:20480
    v_mfma_f32_16x16x32_bf16 a[112:115], v[208:211], v[60:63], a[112:115]
    ds_read_b64_tr_b16 v[184:185], v16 offset:16384
    v_mfma_f32_16x16x32_bf16 a[116:119], v[212:215], v[60:63], a[116:119]
    buffer_load_dwordx4 v[124:127], v23, s[8:11], s26 offen offset:1024 sc1
    ds_read_b64_tr_b16 v[186:187], v16 offset:20480
    v_mfma_f32_16x16x32_bf16 a[120:123], v[216:219], v[60:63], a[120:123]
    ds_read_b64_tr_b16 v[188:189], v17 offset:16384
    v_mfma_f32_16x16x32_bf16 a[124:127], v[220:223], v[60:63], a[124:127]
    ds_read_b64_tr_b16 v[190:191], v17 offset:20480
    s_waitcnt vmcnt(12) lgkmcnt(8)
    s_barrier
    v_mfma_f32_16x16x32_bf16 a[64:67], v[160:163], v[72:75], a[64:67]
    s_add_u32 m0, s23, 49152
    ds_read_b64_tr_b16 v[192:193], v10 offset:24576
    v_mfma_f32_16x16x32_bf16 a[68:71], v[164:167], v[72:75], a[68:71]
    buffer_load_dwordx4 v18, s[12:15], s27 offen offset:0 lds
    ds_read_b64_tr_b16 v[194:195], v10 offset:28672
    v_mfma_f32_16x16x32_bf16 a[72:75], v[168:171], v[72:75], a[72:75]
    ds_read_b64_tr_b16 v[196:197], v11 offset:24576
    v_mfma_f32_16x16x32_bf16 a[76:79], v[172:175], v[72:75], a[76:79]
    ds_read_b64_tr_b16 v[198:199], v11 offset:28672
    s_waitcnt lgkmcnt(4)
    v_mfma_f32_16x16x32_bf16 a[80:83], v[176:179], v[72:75], a[80:83]
    ds_read_b64_tr_b16 v[200:201], v12 offset:24576
    v_mfma_f32_16x16x32_bf16 a[84:87], v[180:183], v[72:75], a[84:87]
    buffer_load_dwordx4 v19, s[12:15], s27 offen offset:1024 lds
    ds_read_b64_tr_b16 v[202:203], v12 offset:28672
    v_mfma_f32_16x16x32_bf16 a[88:91], v[184:187], v[72:75], a[88:91]
    s_add_u32 s27, s27, 65536
    ds_read_b64_tr_b16 v[204:205], v13 offset:24576
    v_mfma_f32_16x16x32_bf16 a[92:95], v[188:191], v[72:75], a[92:95]
    ds_read_b64_tr_b16 v[206:207], v13 offset:28672
    v_mfma_f32_16x16x32_bf16 a[96:99], v[160:163], v[76:79], a[96:99]
    ds_read_b64_tr_b16 v[208:209], v14 offset:24576
    v_mfma_f32_16x16x32_bf16 a[100:103], v[164:167], v[76:79], a[100:103]
    buffer_load_dwordx4 v[136:139], v22, s[8:11], s26 offen offset:2048 sc1
    ds_read_b64_tr_b16 v[210:211], v14 offset:28672
    v_mfma_f32_16x16x32_bf16 a[104:107], v[168:171], v[76:79], a[104:107]
    ds_read_b64_tr_b16 v[212:213], v15 offset:24576
    v_mfma_f32_16x16x32_bf16 a[108:111], v[172:175], v[76:79], a[108:111]
    ds_read_b64_tr_b16 v[214:215], v15 offset:28672
    v_mfma_f32_16x16x32_bf16 a[112:115], v[176:179], v[76:79], a[112:115]
    ds_read_b64_tr_b16 v[216:217], v16 offset:24576
    v_mfma_f32_16x16x32_bf16 a[116:119], v[180:183], v[76:79], a[116:119]
    buffer_load_dwordx4 v[140:143], v23, s[8:11], s26 offen offset:2048 sc1
    ds_read_b64_tr_b16 v[218:219], v16 offset:28672
    v_mfma_f32_16x16x32_bf16 a[120:123], v[184:187], v[76:79], a[120:123]
    ds_read_b64_tr_b16 v[220:221], v17 offset:24576
    v_mfma_f32_16x16x32_bf16 a[124:127], v[188:191], v[76:79], a[124:127]
    ds_read_b64_tr_b16 v[222:223], v17 offset:28672
    s_waitcnt vmcnt(10) lgkmcnt(8)
    s_barrier
    v_mfma_f32_16x16x32_bf16 a[64:67], v[192:195], v[88:91], a[64:67]
    s_add_u32 m0, s23, 57344
    ds_read_b64_tr_b16 v[160:161], v10 offset:32768
    v_mfma_f32_16x16x32_bf16 a[68:71], v[196:199], v[88:91], a[68:71]
    buffer_load_dwordx4 v18, s[12:15], s27 offen offset:0 lds
    ds_read_b64_tr_b16 v[162:163], v10 offset:36864
    v_mfma_f32_16x16x32_bf16 a[72:75], v[200:203], v[88:91], a[72:75]
    ds_read_b64_tr_b16 v[164:165], v11 offset:32768
    v_mfma_f32_16x16x32_bf16 a[76:79], v[204:207], v[88:91], a[76:79]
    ds_read_b64_tr_b16 v[166:167], v11 offset:36864
    s_waitcnt lgkmcnt(4)
    v_mfma_f32_16x16x32_bf16 a[80:83], v[208:211], v[88:91], a[80:83]
    ds_read_b64_tr_b16 v[168:169], v12 offset:32768
    v_mfma_f32_16x16x32_bf16 a[84:87], v[212:215], v[88:91], a[84:87]
    buffer_load_dwordx4 v19, s[12:15], s27 offen offset:1024 lds
    ds_read_b64_tr_b16 v[170:171], v12 offset:36864
    v_mfma_f32_16x16x32_bf16 a[88:91], v[216:219], v[88:91], a[88:91]
    s_add_u32 s27, s27, 65536
    ds_read_b64_tr_b16 v[172:173], v13 offset:32768
    v_mfma_f32_16x16x32_bf16 a[92:95], v[220:223], v[88:91], a[92:95]
    ds_read_b64_tr_b16 v[174:175], v13 offset:36864
    v_mfma_f32_16x16x32_bf16 a[96:99], v[192:195], v[92:95], a[96:99]
    ds_read_b64_tr_b16 v[176:177], v14 offset:32768
    v_mfma_f32_16x16x32_bf16 a[100:103], v[196:199], v[92:95], a[100:103]
    buffer_load_dwordx4 v[152:155], v22, s[8:11], s26 offen offset:3072 sc1
    ds_read_b64_tr_b16 v[178:179], v14 offset:36864
    v_mfma_f32_16x16x32_bf16 a[104:107], v[200:203], v[92:95], a[104:107]
    ds_read_b64_tr_b16 v[180:181], v15 offset:32768
    v_mfma_f32_16x16x32_bf16 a[108:111], v[204:207], v[92:95], a[108:111]
    ds_read_b64_tr_b16 v[182:183], v15 offset:36864
    v_mfma_f32_16x16x32_bf16 a[112:115], v[208:211], v[92:95], a[112:115]
    ds_read_b64_tr_b16 v[184:185], v16 offset:32768
    v_mfma_f32_16x16x32_bf16 a[116:119], v[212:215], v[92:95], a[116:119]
    buffer_load_dwordx4 v[156:159], v23, s[8:11], s26 offen offset:3072 sc1
    ds_read_b64_tr_b16 v[186:187], v16 offset:36864
    v_mfma_f32_16x16x32_bf16 a[120:123], v[216:219], v[92:95], a[120:123]
    ds_read_b64_tr_b16 v[188:189], v17 offset:32768
    v_mfma_f32_16x16x32_bf16 a[124:127], v[220:223], v[92:95], a[124:127]
    ds_read_b64_tr_b16 v[190:191], v17 offset:36864
    s_waitcnt vmcnt(10) lgkmcnt(8)
    s_barrier
    v_mfma_f32_16x16x32_bf16 a[64:67], v[160:163], v[104:107], a[64:67]
    ds_read_b64_tr_b16 v[192:193], v10 offset:40960
    v_mfma_f32_16x16x32_bf16 a[68:71], v[164:167], v[104:107], a[68:71]
    buffer_load_dwordx4 v[96:99], v20, s[8:11], s26 offen offset:0 sc1
    ds_read_b64_tr_b16 v[194:195], v10 offset:45056
    v_mfma_f32_16x16x32_bf16 a[72:75], v[168:171], v[104:107], a[72:75]
    ds_read_b64_tr_b16 v[196:197], v11 offset:40960
    v_mfma_f32_16x16x32_bf16 a[76:79], v[172:175], v[104:107], a[76:79]
    ds_read_b64_tr_b16 v[198:199], v11 offset:45056
    s_waitcnt lgkmcnt(4)
    v_mfma_f32_16x16x32_bf16 a[80:83], v[176:179], v[104:107], a[80:83]
    ds_read_b64_tr_b16 v[200:201], v12 offset:40960
    v_mfma_f32_16x16x32_bf16 a[84:87], v[180:183], v[104:107], a[84:87]
    buffer_load_dwordx4 v[100:103], v21, s[8:11], s26 offen offset:0 sc1
    ds_read_b64_tr_b16 v[202:203], v12 offset:45056
    v_mfma_f32_16x16x32_bf16 a[88:91], v[184:187], v[104:107], a[88:91]
    ds_read_b64_tr_b16 v[204:205], v13 offset:40960
    v_mfma_f32_16x16x32_bf16 a[92:95], v[188:191], v[104:107], a[92:95]
    ds_read_b64_tr_b16 v[206:207], v13 offset:45056
    v_mfma_f32_16x16x32_bf16 a[96:99], v[160:163], v[108:111], a[96:99]
    ds_read_b64_tr_b16 v[208:209], v14 offset:40960
    v_mfma_f32_16x16x32_bf16 a[100:103], v[164:167], v[108:111], a[100:103]
    buffer_load_dwordx4 v[112:115], v20, s[8:11], s26 offen offset:1024 sc1
    ds_read_b64_tr_b16 v[210:211], v14 offset:45056
    v_mfma_f32_16x16x32_bf16 a[104:107], v[168:171], v[108:111], a[104:107]
    ds_read_b64_tr_b16 v[212:213], v15 offset:40960
    v_mfma_f32_16x16x32_bf16 a[108:111], v[172:175], v[108:111], a[108:111]
    ds_read_b64_tr_b16 v[214:215], v15 offset:45056
    v_mfma_f32_16x16x32_bf16 a[112:115], v[176:179], v[108:111], a[112:115]
    ds_read_b64_tr_b16 v[216:217], v16 offset:40960
    v_mfma_f32_16x16x32_bf16 a[116:119], v[180:183], v[108:111], a[116:119]
    buffer_load_dwordx4 v[116:119], v21, s[8:11], s26 offen offset:1024 sc1
    ds_read_b64_tr_b16 v[218:219], v16 offset:45056
    v_mfma_f32_16x16x32_bf16 a[120:123], v[184:187], v[108:111], a[120:123]
    ds_read_b64_tr_b16 v[220:221], v17 offset:40960
    v_mfma_f32_16x16x32_bf16 a[124:127], v[188:191], v[108:111], a[124:127]
    ds_read_b64_tr_b16 v[222:223], v17 offset:45056
    s_waitcnt vmcnt(10) lgkmcnt(8)
    s_barrier
    v_mfma_f32_16x16x32_bf16 a[64:67], v[192:195], v[120:123], a[64:67]
    ds_read_b64_tr_b16 v[160:161], v10 offset:49152
    v_mfma_f32_16x16x32_bf16 a[68:71], v[196:199], v[120:123], a[68:71]
    buffer_load_dwordx4 v[128:131], v20, s[8:11], s26 offen offset:2048 sc1
    ds_read_b64_tr_b16 v[162:163], v10 offset:53248
    v_mfma_f32_16x16x32_bf16 a[72:75], v[200:203], v[120:123], a[72:75]
    ds_read_b64_tr_b16 v[164:165], v11 offset:49152
    v_mfma_f32_16x16x32_bf16 a[76:79], v[204:207], v[120:123], a[76:79]
    ds_read_b64_tr_b16 v[166:167], v11 offset:53248
    s_waitcnt lgkmcnt(4)
    v_mfma_f32_16x16x32_bf16 a[80:83], v[208:211], v[120:123], a[80:83]
    ds_read_b64_tr_b16 v[168:169], v12 offset:49152
    v_mfma_f32_16x16x32_bf16 a[84:87], v[212:215], v[120:123], a[84:87]
    buffer_load_dwordx4 v[132:135], v21, s[8:11], s26 offen offset:2048 sc1
    ds_read_b64_tr_b16 v[170:171], v12 offset:53248
    v_mfma_f32_16x16x32_bf16 a[88:91], v[216:219], v[120:123], a[88:91]
    ds_read_b64_tr_b16 v[172:173], v13 offset:49152
    v_mfma_f32_16x16x32_bf16 a[92:95], v[220:223], v[120:123], a[92:95]
    ds_read_b64_tr_b16 v[174:175], v13 offset:53248
    v_mfma_f32_16x16x32_bf16 a[96:99], v[192:195], v[124:127], a[96:99]
    ds_read_b64_tr_b16 v[176:177], v14 offset:49152
    v_mfma_f32_16x16x32_bf16 a[100:103], v[196:199], v[124:127], a[100:103]
    buffer_load_dwordx4 v[144:147], v20, s[8:11], s26 offen offset:3072 sc1
    ds_read_b64_tr_b16 v[178:179], v14 offset:53248
    v_mfma_f32_16x16x32_bf16 a[104:107], v[200:203], v[124:127], a[104:107]
    ds_read_b64_tr_b16 v[180:181], v15 offset:49152
    v_mfma_f32_16x16x32_bf16 a[108:111], v[204:207], v[124:127], a[108:111]
    ds_read_b64_tr_b16 v[182:183], v15 offset:53248
    v_mfma_f32_16x16x32_bf16 a[112:115], v[208:211], v[124:127], a[112:115]
    ds_read_b64_tr_b16 v[184:185], v16 offset:49152
    v_mfma_f32_16x16x32_bf16 a[116:119], v[212:215], v[124:127], a[116:119]
    buffer_load_dwordx4 v[148:151], v21, s[8:11], s26 offen offset:3072 sc1
    ds_read_b64_tr_b16 v[186:187], v16 offset:53248
    v_mfma_f32_16x16x32_bf16 a[120:123], v[216:219], v[124:127], a[120:123]
    ds_read_b64_tr_b16 v[188:189], v17 offset:49152
    v_mfma_f32_16x16x32_bf16 a[124:127], v[220:223], v[124:127], a[124:127]
    ds_read_b64_tr_b16 v[190:191], v17 offset:53248
    s_waitcnt vmcnt(10) lgkmcnt(8)
    s_barrier
    v_mfma_f32_16x16x32_bf16 a[64:67], v[160:163], v[136:139], a[64:67]
    ds_read_b64_tr_b16 v[192:193], v10 offset:57344
    s_add_u32 m0, s97, 0
    v_mfma_f32_16x16x32_bf16 a[68:71], v[164:167], v[136:139], a[68:71]
    ds_read_b64_tr_b16 v[194:195], v10 offset:61440
    buffer_load_dwordx4 v224, s[36:39], 0 offen offset:0 lds
    v_mfma_f32_16x16x32_bf16 a[72:75], v[168:171], v[136:139], a[72:75]
    ds_read_b64_tr_b16 v[196:197], v11 offset:57344
    v_mfma_f32_16x16x32_bf16 a[76:79], v[172:175], v[136:139], a[76:79]
    ds_read_b64_tr_b16 v[198:199], v11 offset:61440
    s_waitcnt lgkmcnt(4)
    v_mfma_f32_16x16x32_bf16 a[80:83], v[176:179], v[136:139], a[80:83]
    ds_read_b64_tr_b16 v[200:201], v12 offset:57344
    v_mfma_f32_16x16x32_bf16 a[84:87], v[180:183], v[136:139], a[84:87]
    ds_read_b64_tr_b16 v[202:203], v12 offset:61440
    buffer_load_dwordx4 v225, s[36:39], 0 offen offset:1024 lds
    v_mfma_f32_16x16x32_bf16 a[88:91], v[184:187], v[136:139], a[88:91]
    ds_read_b64_tr_b16 v[204:205], v13 offset:57344
    v_mfma_f32_16x16x32_bf16 a[92:95], v[188:191], v[136:139], a[92:95]
    ds_read_b64_tr_b16 v[206:207], v13 offset:61440
    v_mfma_f32_16x16x32_bf16 a[96:99], v[160:163], v[140:143], a[96:99]
    ds_read_b64_tr_b16 v[208:209], v14 offset:57344
    v_mfma_f32_16x16x32_bf16 a[100:103], v[164:167], v[140:143], a[100:103]
    ds_read_b64_tr_b16 v[210:211], v14 offset:61440
    buffer_load_dwordx4 v226, s[36:39], 0 offen offset:2048 lds
    v_mfma_f32_16x16x32_bf16 a[104:107], v[168:171], v[140:143], a[104:107]
    ds_read_b64_tr_b16 v[212:213], v15 offset:57344
    v_mfma_f32_16x16x32_bf16 a[108:111], v[172:175], v[140:143], a[108:111]
    ds_read_b64_tr_b16 v[214:215], v15 offset:61440
    v_mfma_f32_16x16x32_bf16 a[112:115], v[176:179], v[140:143], a[112:115]
    ds_read_b64_tr_b16 v[216:217], v16 offset:57344
    v_mfma_f32_16x16x32_bf16 a[116:119], v[180:183], v[140:143], a[116:119]
    ds_read_b64_tr_b16 v[218:219], v16 offset:61440
    buffer_load_dwordx4 v227, s[36:39], 0 offen offset:3072 lds
    v_mfma_f32_16x16x32_bf16 a[120:123], v[184:187], v[140:143], a[120:123]
    ds_read_b64_tr_b16 v[220:221], v17 offset:57344
    v_mfma_f32_16x16x32_bf16 a[124:127], v[188:191], v[140:143], a[124:127]
    ds_read_b64_tr_b16 v[222:223], v17 offset:61440
    s_waitcnt vmcnt(8) lgkmcnt(8)
    v_mfma_f32_16x16x32_bf16 a[64:67], v[192:195], v[152:155], a[64:67]
    ds_read_b64_tr_b16 v[160:161], v10 offset:0
    s_add_u32 m0, s97, 4096
    v_mfma_f32_16x16x32_bf16 a[68:71], v[196:199], v[152:155], a[68:71]
    ds_read_b64_tr_b16 v[162:163], v10 offset:4096
    buffer_load_dwordx4 v224, s[36:39], s96 offen offset:0 lds
    v_mfma_f32_16x16x32_bf16 a[72:75], v[200:203], v[152:155], a[72:75]
    ds_read_b64_tr_b16 v[164:165], v11 offset:0
    v_mfma_f32_16x16x32_bf16 a[76:79], v[204:207], v[152:155], a[76:79]
    ds_read_b64_tr_b16 v[166:167], v11 offset:4096
    s_waitcnt lgkmcnt(4)
    v_mfma_f32_16x16x32_bf16 a[80:83], v[208:211], v[152:155], a[80:83]
    ds_read_b64_tr_b16 v[168:169], v12 offset:0
    v_mfma_f32_16x16x32_bf16 a[84:87], v[212:215], v[152:155], a[84:87]
    ds_read_b64_tr_b16 v[170:171], v12 offset:4096
    buffer_load_dwordx4 v225, s[36:39], s96 offen offset:1024 lds
    v_mfma_f32_16x16x32_bf16 a[88:91], v[216:219], v[152:155], a[88:91]
    ds_read_b64_tr_b16 v[172:173], v13 offset:0
    v_mfma_f32_16x16x32_bf16 a[92:95], v[220:223], v[152:155], a[92:95]
    ds_read_b64_tr_b16 v[174:175], v13 offset:4096
    v_mfma_f32_16x16x32_bf16 a[96:99], v[192:195], v[156:159], a[96:99]
    ds_read_b64_tr_b16 v[176:177], v14 offset:0
    v_mfma_f32_16x16x32_bf16 a[100:103], v[196:199], v[156:159], a[100:103]
    ds_read_b64_tr_b16 v[178:179], v14 offset:4096
    buffer_load_dwordx4 v226, s[36:39], s96 offen offset:2048 lds
    v_mfma_f32_16x16x32_bf16 a[104:107], v[200:203], v[156:159], a[104:107]
    ds_read_b64_tr_b16 v[180:181], v15 offset:0
    v_mfma_f32_16x16x32_bf16 a[108:111], v[204:207], v[156:159], a[108:111]
    ds_read_b64_tr_b16 v[182:183], v15 offset:4096
    v_mfma_f32_16x16x32_bf16 a[112:115], v[208:211], v[156:159], a[112:115]
    ds_read_b64_tr_b16 v[184:185], v16 offset:0
    v_mfma_f32_16x16x32_bf16 a[116:119], v[212:215], v[156:159], a[116:119]
    ds_read_b64_tr_b16 v[186:187], v16 offset:4096
    buffer_load_dwordx4 v227, s[36:39], s96 offen offset:3072 lds
    v_mfma_f32_16x16x32_bf16 a[120:123], v[216:219], v[156:159], a[120:123]
    ds_read_b64_tr_b16 v[188:189], v17 offset:0
    v_mfma_f32_16x16x32_bf16 a[124:127], v[220:223], v[156:159], a[124:127]
    ds_read_b64_tr_b16 v[190:191], v17 offset:4096
    global_load_dword v30, v29, s[98:99] offset:512 sc1
    s_waitcnt lgkmcnt(8)
    v_mfma_f32_16x16x32_bf16 a[0:3], v[160:163], v[32:35], a[0:3]
    ds_read_b64_tr_b16 v[192:193], v10 offset:8192
    v_accvgpr_read_b32 v104, a64
    v_accvgpr_read_b32 v105, a65
    v_mfma_f32_16x16x32_bf16 a[4:7], v[164:167], v[32:35], a[4:7]
    ds_read_b64_tr_b16 v[194:195], v10 offset:12288
    v_accvgpr_read_b32 v106, a66
    v_accvgpr_read_b32 v107, a67
    v_mfma_f32_16x16x32_bf16 a[8:11], v[168:171], v[32:35], a[8:11]
    ds_read_b64_tr_b16 v[196:197], v11 offset:8192
    v_accvgpr_read_b32 v108, a68
    v_accvgpr_read_b32 v109, a69
    v_mfma_f32_16x16x32_bf16 a[12:15], v[172:175], v[32:35], a[12:15]
    ds_read_b64_tr_b16 v[198:199], v11 offset:12288
    s_waitcnt lgkmcnt(4)
    v_accvgpr_read_b32 v110, a70
    v_accvgpr_read_b32 v111, a71
    v_mfma_f32_16x16x32_bf16 a[16:19], v[176:179], v[32:35], a[16:19]
    ds_read_b64_tr_b16 v[200:201], v12 offset:8192
    v_accvgpr_read_b32 v120, a72
    v_accvgpr_read_b32 v121, a73
    v_mfma_f32_16x16x32_bf16 a[20:23], v[180:183], v[32:35], a[20:23]
    ds_read_b64_tr_b16 v[202:203], v12 offset:12288
    v_accvgpr_read_b32 v122, a74
    v_accvgpr_read_b32 v123, a75
    v_mfma_f32_16x16x32_bf16 a[24:27], v[184:187], v[32:35], a[24:27]
    ds_read_b64_tr_b16 v[204:205], v13 offset:8192
    v_accvgpr_read_b32 v124, a76
    v_accvgpr_read_b32 v125, a77
    v_mfma_f32_16x16x32_bf16 a[28:31], v[188:191], v[32:35], a[28:31]
    ds_read_b64_tr_b16 v[206:207], v13 offset:12288
    v_accvgpr_read_b32 v126, a78
    v_accvgpr_read_b32 v127, a79
    v_mfma_f32_16x16x32_bf16 a[32:35], v[160:163], v[36:39], a[32:35]
    ds_read_b64_tr_b16 v[208:209], v14 offset:8192
    v_accvgpr_read_b32 v136, a80
    v_accvgpr_read_b32 v137, a81
    v_mfma_f32_16x16x32_bf16 a[36:39], v[164:167], v[36:39], a[36:39]
    ds_read_b64_tr_b16 v[210:211], v14 offset:12288
    v_accvgpr_read_b32 v138, a82
    v_accvgpr_read_b32 v139, a83
    v_mfma_f32_16x16x32_bf16 a[40:43], v[168:171], v[36:39], a[40:43]
    ds_read_b64_tr_b16 v[212:213], v15 offset:8192
    v_accvgpr_read_b32 v140, a84
    v_accvgpr_read_b32 v141, a85
    v_mfma_f32_16x16x32_bf16 a[44:47], v[172:175], v[36:39], a[44:47]
    ds_read_b64_tr_b16 v[214:215], v15 offset:12288
    v_accvgpr_read_b32 v142, a86
    v_accvgpr_read_b32 v143, a87
    v_mfma_f32_16x16x32_bf16 a[48:51], v[176:179], v[36:39], a[48:51]
    ds_read_b64_tr_b16 v[216:217], v16 offset:8192
    v_accvgpr_read_b32 v152, a88
    v_accvgpr_read_b32 v153, a89
    v_mfma_f32_16x16x32_bf16 a[52:55], v[180:183], v[36:39], a[52:55]
    ds_read_b64_tr_b16 v[218:219], v16 offset:12288
    v_accvgpr_read_b32 v154, a90
    v_accvgpr_read_b32 v155, a91
    v_mfma_f32_16x16x32_bf16 a[56:59], v[184:187], v[36:39], a[56:59]
    ds_read_b64_tr_b16 v[220:221], v17 offset:8192
    v_accvgpr_read_b32 v156, a92
    v_accvgpr_read_b32 v157, a93
    v_mfma_f32_16x16x32_bf16 a[60:63], v[188:191], v[36:39], a[60:63]
    ds_read_b64_tr_b16 v[222:223], v17 offset:12288
    v_accvgpr_read_b32 v158, a94
    v_accvgpr_read_b32 v159, a95
    s_waitcnt lgkmcnt(8)
    v_mfma_f32_16x16x32_bf16 a[0:3], v[192:195], v[48:51], a[0:3]
    ds_read_b64_tr_b16 v[160:161], v10 offset:16384
    v_cvt_pk_bf16_f32 v40, v104, v105
    v_cvt_pk_bf16_f32 v41, v106, v107
    v_mfma_f32_16x16x32_bf16 a[4:7], v[196:199], v[48:51], a[4:7]
    ds_read_b64_tr_b16 v[162:163], v10 offset:20480
    v_cvt_pk_bf16_f32 v42, v108, v109
    v_cvt_pk_bf16_f32 v43, v110, v111
    v_mfma_f32_16x16x32_bf16 a[8:11], v[200:203], v[48:51], a[8:11]
    ds_read_b64_tr_b16 v[164:165], v11 offset:16384
    s_waitcnt vmcnt(9)
    buffer_store_dwordx4 v[40:43], v6, s[52:55], 0 offen offset:0 sc1
    v_mfma_f32_16x16x32_bf16 a[12:15], v[204:207], v[48:51], a[12:15]
    ds_read_b64_tr_b16 v[166:167], v11 offset:20480
    s_waitcnt lgkmcnt(4)
    v_cvt_pk_bf16_f32 v44, v120, v121
    v_cvt_pk_bf16_f32 v45, v122, v123
    v_mfma_f32_16x16x32_bf16 a[16:19], v[208:211], v[48:51], a[16:19]
    ds_read_b64_tr_b16 v[168:169], v12 offset:16384
    v_cvt_pk_bf16_f32 v46, v124, v125
    v_cvt_pk_bf16_f32 v47, v126, v127
    v_mfma_f32_16x16x32_bf16 a[20:23], v[212:215], v[48:51], a[20:23]
    buffer_store_dwordx4 v[44:47], v6, s[52:55], 0 offen offset:1024 sc1
    ds_read_b64_tr_b16 v[170:171], v12 offset:20480
    v_cvt_pk_bf16_f32 v56, v136, v137
    v_mfma_f32_16x16x32_bf16 a[24:27], v[216:219], v[48:51], a[24:27]
    ds_read_b64_tr_b16 v[172:173], v13 offset:16384
    v_cvt_pk_bf16_f32 v57, v138, v139
    v_cvt_pk_bf16_f32 v58, v140, v141
    v_mfma_f32_16x16x32_bf16 a[28:31], v[220:223], v[48:51], a[28:31]
    ds_read_b64_tr_b16 v[174:175], v13 offset:20480
    v_cvt_pk_bf16_f32 v59, v142, v143
    buffer_store_dwordx4 v[56:59], v6, s[52:55], 0 offen offset:2048 sc1
    v_mfma_f32_16x16x32_bf16 a[32:35], v[192:195], v[52:55], a[32:35]
    ds_read_b64_tr_b16 v[176:177], v14 offset:16384
    v_cvt_pk_bf16_f32 v60, v152, v153
    v_cvt_pk_bf16_f32 v61, v154, v155
    v_mfma_f32_16x16x32_bf16 a[36:39], v[196:199], v[52:55], a[36:39]
    ds_read_b64_tr_b16 v[178:179], v14 offset:20480
    v_cvt_pk_bf16_f32 v62, v156, v157
    v_cvt_pk_bf16_f32 v63, v158, v159
    v_mfma_f32_16x16x32_bf16 a[40:43], v[200:203], v[52:55], a[40:43]
    buffer_store_dwordx4 v[60:63], v6, s[52:55], 0 offen offset:3072 sc1
    ds_read_b64_tr_b16 v[180:181], v15 offset:16384
    v_accvgpr_read_b32 v104, a96
    v_mfma_f32_16x16x32_bf16 a[44:47], v[204:207], v[52:55], a[44:47]
    ds_read_b64_tr_b16 v[182:183], v15 offset:20480
    v_accvgpr_read_b32 v105, a97
    v_accvgpr_read_b32 v106, a98
    v_mfma_f32_16x16x32_bf16 a[48:51], v[208:211], v[52:55], a[48:51]
    ds_read_b64_tr_b16 v[184:185], v16 offset:16384
    v_accvgpr_read_b32 v107, a99
    v_accvgpr_read_b32 v108, a100
    v_mfma_f32_16x16x32_bf16 a[52:55], v[212:215], v[52:55], a[52:55]
    ds_read_b64_tr_b16 v[186:187], v16 offset:20480
    v_accvgpr_read_b32 v109, a101
    v_accvgpr_read_b32 v110, a102
    v_mfma_f32_16x16x32_bf16 a[56:59], v[216:219], v[52:55], a[56:59]
    ds_read_b64_tr_b16 v[188:189], v17 offset:16384
    v_accvgpr_read_b32 v111, a103
    v_accvgpr_read_b32 v120, a104
    v_mfma_f32_16x16x32_bf16 a[60:63], v[220:223], v[52:55], a[60:63]
    ds_read_b64_tr_b16 v[190:191], v17 offset:20480
    v_accvgpr_read_b32 v121, a105
    v_accvgpr_read_b32 v122, a106
    s_waitcnt lgkmcnt(8)
    v_mfma_f32_16x16x32_bf16 a[0:3], v[160:163], v[64:67], a[0:3]
    ds_read_b64_tr_b16 v[192:193], v10 offset:24576
    v_accvgpr_read_b32 v123, a107
    v_accvgpr_read_b32 v124, a108
    v_mfma_f32_16x16x32_bf16 a[4:7], v[164:167], v[64:67], a[4:7]
    ds_read_b64_tr_b16 v[194:195], v10 offset:28672
    v_accvgpr_read_b32 v125, a109
    v_accvgpr_read_b32 v126, a110
    v_mfma_f32_16x16x32_bf16 a[8:11], v[168:171], v[64:67], a[8:11]
    ds_read_b64_tr_b16 v[196:197], v11 offset:24576
    v_accvgpr_read_b32 v127, a111
    v_accvgpr_read_b32 v136, a112
    v_mfma_f32_16x16x32_bf16 a[12:15], v[172:175], v[64:67], a[12:15]
    ds_read_b64_tr_b16 v[198:199], v11 offset:28672
    s_waitcnt lgkmcnt(4)
    v_accvgpr_read_b32 v137, a113
    v_accvgpr_read_b32 v138, a114
    v_mfma_f32_16x16x32_bf16 a[16:19], v[176:179], v[64:67], a[16:19]
    ds_read_b64_tr_b16 v[200:201], v12 offset:24576
    v_accvgpr_read_b32 v139, a115
    v_accvgpr_read_b32 v140, a116
    v_mfma_f32_16x16x32_bf16 a[20:23], v[180:183], v[64:67], a[20:23]
    ds_read_b64_tr_b16 v[202:203], v12 offset:28672
    v_accvgpr_read_b32 v141, a117
    v_accvgpr_read_b32 v142, a118
    v_mfma_f32_16x16x32_bf16 a[24:27], v[184:187], v[64:67], a[24:27]
    ds_read_b64_tr_b16 v[204:205], v13 offset:24576
    v_accvgpr_read_b32 v143, a119
    v_accvgpr_read_b32 v152, a120
    v_mfma_f32_16x16x32_bf16 a[28:31], v[188:191], v[64:67], a[28:31]
    ds_read_b64_tr_b16 v[206:207], v13 offset:28672
    v_accvgpr_read_b32 v153, a121
    v_accvgpr_read_b32 v154, a122
    v_mfma_f32_16x16x32_bf16 a[32:35], v[160:163], v[68:71], a[32:35]
    ds_read_b64_tr_b16 v[208:209], v14 offset:24576
    v_accvgpr_read_b32 v155, a123
    v_accvgpr_read_b32 v156, a124
    v_mfma_f32_16x16x32_bf16 a[36:39], v[164:167], v[68:71], a[36:39]
    ds_read_b64_tr_b16 v[210:211], v14 offset:28672
    v_accvgpr_read_b32 v157, a125
    v_accvgpr_read_b32 v158, a126
    v_mfma_f32_16x16x32_bf16 a[40:43], v[168:171], v[68:71], a[40:43]
    ds_read_b64_tr_b16 v[212:213], v15 offset:24576
    v_accvgpr_read_b32 v159, a127
    v_cvt_pk_bf16_f32 v72, v104, v105
    v_mfma_f32_16x16x32_bf16 a[44:47], v[172:175], v[68:71], a[44:47]
    ds_read_b64_tr_b16 v[214:215], v15 offset:28672
    v_cvt_pk_bf16_f32 v73, v106, v107
    v_cvt_pk_bf16_f32 v74, v108, v109
    v_mfma_f32_16x16x32_bf16 a[48:51], v[176:179], v[68:71], a[48:51]
    ds_read_b64_tr_b16 v[216:217], v16 offset:24576
    v_cvt_pk_bf16_f32 v75, v110, v111
    buffer_store_dwordx4 v[72:75], v6, s[52:55], s93 offen offset:0 sc1
    v_mfma_f32_16x16x32_bf16 a[52:55], v[180:183], v[68:71], a[52:55]
    ds_read_b64_tr_b16 v[218:219], v16 offset:28672
    v_cvt_pk_bf16_f32 v76, v120, v121
    v_cvt_pk_bf16_f32 v77, v122, v123
    v_mfma_f32_16x16x32_bf16 a[56:59], v[184:187], v[68:71], a[56:59]
    ds_read_b64_tr_b16 v[220:221], v17 offset:24576
    v_cvt_pk_bf16_f32 v78, v124, v125
    v_cvt_pk_bf16_f32 v79, v126, v127
    v_mfma_f32_16x16x32_bf16 a[60:63], v[188:191], v[68:71], a[60:63]
    buffer_store_dwordx4 v[76:79], v6, s[52:55], s93 offen offset:1024 sc1
    ds_read_b64_tr_b16 v[222:223], v17 offset:28672
    v_cvt_pk_bf16_f32 v88, v136, v137
    s_waitcnt lgkmcnt(8)
    v_mfma_f32_16x16x32_bf16 a[0:3], v[192:195], v[80:83], a[0:3]
    ds_read_b64_tr_b16 v[160:161], v10 offset:32768
    v_cvt_pk_bf16_f32 v89, v138, v139
    v_cvt_pk_bf16_f32 v90, v140, v141
    v_mfma_f32_16x16x32_bf16 a[4:7], v[196:199], v[80:83], a[4:7]
    ds_read_b64_tr_b16 v[162:163], v10 offset:36864
    v_cvt_pk_bf16_f32 v91, v142, v143
    buffer_store_dwordx4 v[88:91], v6, s[52:55], s93 offen offset:2048 sc1
    v_mfma_f32_16x16x32_bf16 a[8:11], v[200:203], v[80:83], a[8:11]
    ds_read_b64_tr_b16 v[164:165], v11 offset:32768
    v_cvt_pk_bf16_f32 v92, v152, v153
    v_cvt_pk_bf16_f32 v93, v154, v155
    v_mfma_f32_16x16x32_bf16 a[12:15], v[204:207], v[80:83], a[12:15]
    ds_read_b64_tr_b16 v[166:167], v11 offset:36864
    s_waitcnt lgkmcnt(4)
    v_cvt_pk_bf16_f32 v94, v156, v157
    v_cvt_pk_bf16_f32 v95, v158, v159
    v_mfma_f32_16x16x32_bf16 a[16:19], v[208:211], v[80:83], a[16:19]
    buffer_store_dwordx4 v[92:95], v6, s[52:55], s93 offen offset:3072 sc1
    ds_read_b64_tr_b16 v[168:169], v12 offset:32768
    v_mfma_f32_16x16x32_bf16 a[20:23], v[212:215], v[80:83], a[20:23]
    ds_read_b64_tr_b16 v[170:171], v12 offset:36864
    v_mfma_f32_16x16x32_bf16 a[24:27], v[216:219], v[80:83], a[24:27]
    ds_read_b64_tr_b16 v[172:173], v13 offset:32768
    v_mfma_f32_16x16x32_bf16 a[28:31], v[220:223], v[80:83], a[28:31]
    ds_read_b64_tr_b16 v[174:175], v13 offset:36864
    v_mfma_f32_16x16x32_bf16 a[32:35], v[192:195], v[84:87], a[32:35]
    ds_read_b64_tr_b16 v[176:177], v14 offset:32768
    v_mfma_f32_16x16x32_bf16 a[36:39], v[196:199], v[84:87], a[36:39]
    ds_read_b64_tr_b16 v[178:179], v14 offset:36864
    v_mfma_f32_16x16x32_bf16 a[40:43], v[200:203], v[84:87], a[40:43]
    ds_read_b64_tr_b16 v[180:181], v15 offset:32768
    v_mfma_f32_16x16x32_bf16 a[44:47], v[204:207], v[84:87], a[44:47]
    ds_read_b64_tr_b16 v[182:183], v15 offset:36864
    v_mfma_f32_16x16x32_bf16 a[48:51], v[208:211], v[84:87], a[48:51]
    ds_read_b64_tr_b16 v[184:185], v16 offset:32768
    v_mfma_f32_16x16x32_bf16 a[52:55], v[212:215], v[84:87], a[52:55]
    ds_read_b64_tr_b16 v[186:187], v16 offset:36864
    v_mfma_f32_16x16x32_bf16 a[56:59], v[216:219], v[84:87], a[56:59]
    ds_read_b64_tr_b16 v[188:189], v17 offset:32768
    v_mfma_f32_16x16x32_bf16 a[60:63], v[220:223], v[84:87], a[60:63]
    ds_read_b64_tr_b16 v[190:191], v17 offset:36864
    s_waitcnt lgkmcnt(8)
    v_mfma_f32_16x16x32_bf16 a[0:3], v[160:163], v[96:99], a[0:3]
    ds_read_b64_tr_b16 v[192:193], v10 offset:40960
    v_mfma_f32_16x16x32_bf16 a[4:7], v[164:167], v[96:99], a[4:7]
    ds_read_b64_tr_b16 v[194:195], v10 offset:45056
    v_mfma_f32_16x16x32_bf16 a[8:11], v[168:171], v[96:99], a[8:11]
    ds_read_b64_tr_b16 v[196:197], v11 offset:40960
    v_mfma_f32_16x16x32_bf16 a[12:15], v[172:175], v[96:99], a[12:15]
    ds_read_b64_tr_b16 v[198:199], v11 offset:45056
    s_waitcnt lgkmcnt(4)
    v_mfma_f32_16x16x32_bf16 a[16:19], v[176:179], v[96:99], a[16:19]
    ds_read_b64_tr_b16 v[200:201], v12 offset:40960
    v_mfma_f32_16x16x32_bf16 a[20:23], v[180:183], v[96:99], a[20:23]
    ds_read_b64_tr_b16 v[202:203], v12 offset:45056
    v_mfma_f32_16x16x32_bf16 a[24:27], v[184:187], v[96:99], a[24:27]
    ds_read_b64_tr_b16 v[204:205], v13 offset:40960
    v_mfma_f32_16x16x32_bf16 a[28:31], v[188:191], v[96:99], a[28:31]
    ds_read_b64_tr_b16 v[206:207], v13 offset:45056
    v_mfma_f32_16x16x32_bf16 a[32:35], v[160:163], v[100:103], a[32:35]
    ds_read_b64_tr_b16 v[208:209], v14 offset:40960
    v_mfma_f32_16x16x32_bf16 a[36:39], v[164:167], v[100:103], a[36:39]
    ds_read_b64_tr_b16 v[210:211], v14 offset:45056
    v_mfma_f32_16x16x32_bf16 a[40:43], v[168:171], v[100:103], a[40:43]
    ds_read_b64_tr_b16 v[212:213], v15 offset:40960
    v_mfma_f32_16x16x32_bf16 a[44:47], v[172:175], v[100:103], a[44:47]
    ds_read_b64_tr_b16 v[214:215], v15 offset:45056
    v_mfma_f32_16x16x32_bf16 a[48:51], v[176:179], v[100:103], a[48:51]
    ds_read_b64_tr_b16 v[216:217], v16 offset:40960
    v_mfma_f32_16x16x32_bf16 a[52:55], v[180:183], v[100:103], a[52:55]
    ds_read_b64_tr_b16 v[218:219], v16 offset:45056
    v_mfma_f32_16x16x32_bf16 a[56:59], v[184:187], v[100:103], a[56:59]
    ds_read_b64_tr_b16 v[220:221], v17 offset:40960
    v_mfma_f32_16x16x32_bf16 a[60:63], v[188:191], v[100:103], a[60:63]
    ds_read_b64_tr_b16 v[222:223], v17 offset:45056
    s_waitcnt lgkmcnt(8)
    v_mfma_f32_16x16x32_bf16 a[0:3], v[192:195], v[112:115], a[0:3]
    ds_read_b64_tr_b16 v[160:161], v10 offset:49152
    v_mfma_f32_16x16x32_bf16 a[4:7], v[196:199], v[112:115], a[4:7]
    ds_read_b64_tr_b16 v[162:163], v10 offset:53248
    v_mfma_f32_16x16x32_bf16 a[8:11], v[200:203], v[112:115], a[8:11]
    ds_read_b64_tr_b16 v[164:165], v11 offset:49152
    v_mfma_f32_16x16x32_bf16 a[12:15], v[204:207], v[112:115], a[12:15]
    ds_read_b64_tr_b16 v[166:167], v11 offset:53248
    s_waitcnt lgkmcnt(4)
    v_mfma_f32_16x16x32_bf16 a[16:19], v[208:211], v[112:115], a[16:19]
    ds_read_b64_tr_b16 v[168:169], v12 offset:49152
    v_mfma_f32_16x16x32_bf16 a[20:23], v[212:215], v[112:115], a[20:23]
    ds_read_b64_tr_b16 v[170:171], v12 offset:53248
    v_mfma_f32_16x16x32_bf16 a[24:27], v[216:219], v[112:115], a[24:27]
    ds_read_b64_tr_b16 v[172:173], v13 offset:49152
    v_mfma_f32_16x16x32_bf16 a[28:31], v[220:223], v[112:115], a[28:31]
    ds_read_b64_tr_b16 v[174:175], v13 offset:53248
    v_mfma_f32_16x16x32_bf16 a[32:35], v[192:195], v[116:119], a[32:35]
    ds_read_b64_tr_b16 v[176:177], v14 offset:49152
    v_mfma_f32_16x16x32_bf16 a[36:39], v[196:199], v[116:119], a[36:39]
    ds_read_b64_tr_b16 v[178:179], v14 offset:53248
    v_mfma_f32_16x16x32_bf16 a[40:43], v[200:203], v[116:119], a[40:43]
    ds_read_b64_tr_b16 v[180:181], v15 offset:49152
    v_mfma_f32_16x16x32_bf16 a[44:47], v[204:207], v[116:119], a[44:47]
    ds_read_b64_tr_b16 v[182:183], v15 offset:53248
    v_mfma_f32_16x16x32_bf16 a[48:51], v[208:211], v[116:119], a[48:51]
    ds_read_b64_tr_b16 v[184:185], v16 offset:49152
    v_mfma_f32_16x16x32_bf16 a[52:55], v[212:215], v[116:119], a[52:55]
    ds_read_b64_tr_b16 v[186:187], v16 offset:53248
    v_mfma_f32_16x16x32_bf16 a[56:59], v[216:219], v[116:119], a[56:59]
    ds_read_b64_tr_b16 v[188:189], v17 offset:49152
    v_mfma_f32_16x16x32_bf16 a[60:63], v[220:223], v[116:119], a[60:63]
    ds_read_b64_tr_b16 v[190:191], v17 offset:53248
    s_waitcnt lgkmcnt(8)
    v_mfma_f32_16x16x32_bf16 a[0:3], v[160:163], v[128:131], a[0:3]
    ds_read_b64_tr_b16 v[192:193], v10 offset:57344
    v_mfma_f32_16x16x32_bf16 a[4:7], v[164:167], v[128:131], a[4:7]
    ds_read_b64_tr_b16 v[194:195], v10 offset:61440
    v_mfma_f32_16x16x32_bf16 a[8:11], v[168:171], v[128:131], a[8:11]
    ds_read_b64_tr_b16 v[196:197], v11 offset:57344
    v_mfma_f32_16x16x32_bf16 a[12:15], v[172:175], v[128:131], a[12:15]
    ds_read_b64_tr_b16 v[198:199], v11 offset:61440
    s_waitcnt lgkmcnt(4)
    v_mfma_f32_16x16x32_bf16 a[16:19], v[176:179], v[128:131], a[16:19]
    ds_read_b64_tr_b16 v[200:201], v12 offset:57344
    v_mfma_f32_16x16x32_bf16 a[20:23], v[180:183], v[128:131], a[20:23]
    ds_read_b64_tr_b16 v[202:203], v12 offset:61440
    v_mfma_f32_16x16x32_bf16 a[24:27], v[184:187], v[128:131], a[24:27]
    ds_read_b64_tr_b16 v[204:205], v13 offset:57344
    v_mfma_f32_16x16x32_bf16 a[28:31], v[188:191], v[128:131], a[28:31]
    ds_read_b64_tr_b16 v[206:207], v13 offset:61440
    v_mfma_f32_16x16x32_bf16 a[32:35], v[160:163], v[132:135], a[32:35]
    ds_read_b64_tr_b16 v[208:209], v14 offset:57344
    v_mfma_f32_16x16x32_bf16 a[36:39], v[164:167], v[132:135], a[36:39]
    ds_read_b64_tr_b16 v[210:211], v14 offset:61440
    v_mfma_f32_16x16x32_bf16 a[40:43], v[168:171], v[132:135], a[40:43]
    ds_read_b64_tr_b16 v[212:213], v15 offset:57344
    v_mfma_f32_16x16x32_bf16 a[44:47], v[172:175], v[132:135], a[44:47]
    ds_read_b64_tr_b16 v[214:215], v15 offset:61440
    v_mfma_f32_16x16x32_bf16 a[48:51], v[176:179], v[132:135], a[48:51]
    ds_read_b64_tr_b16 v[216:217], v16 offset:57344
    v_mfma_f32_16x16x32_bf16 a[52:55], v[180:183], v[132:135], a[52:55]
    ds_read_b64_tr_b16 v[218:219], v16 offset:61440
    v_mfma_f32_16x16x32_bf16 a[56:59], v[184:187], v[132:135], a[56:59]
    ds_read_b64_tr_b16 v[220:221], v17 offset:57344
    v_mfma_f32_16x16x32_bf16 a[60:63], v[188:191], v[132:135], a[60:63]
    ds_read_b64_tr_b16 v[222:223], v17 offset:61440
    s_waitcnt lgkmcnt(8)
    v_mfma_f32_16x16x32_bf16 a[0:3], v[192:195], v[144:147], a[0:3]
    v_mfma_f32_16x16x32_bf16 a[4:7], v[196:199], v[144:147], a[4:7]
    v_mfma_f32_16x16x32_bf16 a[8:11], v[200:203], v[144:147], a[8:11]
    v_mfma_f32_16x16x32_bf16 a[12:15], v[204:207], v[144:147], a[12:15]
    s_waitcnt lgkmcnt(0)
    v_mfma_f32_16x16x32_bf16 a[16:19], v[208:211], v[144:147], a[16:19]
    v_mfma_f32_16x16x32_bf16 a[20:23], v[212:215], v[144:147], a[20:23]
    v_mfma_f32_16x16x32_bf16 a[24:27], v[216:219], v[144:147], a[24:27]
    v_mfma_f32_16x16x32_bf16 a[28:31], v[220:223], v[144:147], a[28:31]
    v_mfma_f32_16x16x32_bf16 a[32:35], v[192:195], v[148:151], a[32:35]
    v_mfma_f32_16x16x32_bf16 a[36:39], v[196:199], v[148:151], a[36:39]
    v_mfma_f32_16x16x32_bf16 a[40:43], v[200:203], v[148:151], a[40:43]
    v_mfma_f32_16x16x32_bf16 a[44:47], v[204:207], v[148:151], a[44:47]
    v_mfma_f32_16x16x32_bf16 a[48:51], v[208:211], v[148:151], a[48:51]
    v_mfma_f32_16x16x32_bf16 a[52:55], v[212:215], v[148:151], a[52:55]
    v_mfma_f32_16x16x32_bf16 a[56:59], v[216:219], v[148:151], a[56:59]
    v_mfma_f32_16x16x32_bf16 a[60:63], v[220:223], v[148:151], a[60:63]
    s_mov_b32 s30, 0xbfb8aa3b
    s_mov_b32 s31, 0xbfb8aa3b
    v_lshrrev_b32 v7, 1, v4
    v_xor_b32 v7, v7, v5
    v_lshlrev_b32 v7, 4, v7
    v_lshl_add_u32 v7, v5, 8, v7
    v_and_b32 v8, 1, v4
    v_lshl_add_u32 v7, v8, 3, v7
    v_add_u32 v7, s97, v7
    v_xor_b32 v10, 0, v7
    v_xor_b32 v11, 32, v7
    v_xor_b32 v12, 64, v7
    v_xor_b32 v13, 96, v7
    v_xor_b32 v14, 128, v7
    v_xor_b32 v15, 160, v7
    v_xor_b32 v16, 192, v7
    v_xor_b32 v17, 224, v7
    s_waitcnt vmcnt(0)
    ds_read_b64 v[224:225], v10 offset:0
    ds_read_b64 v[226:227], v11 offset:0
    ds_read_b64 v[228:229], v12 offset:0
    ds_read_b64 v[230:231], v13 offset:0
    ds_read_b64 v[232:233], v14 offset:0
    ds_read_b64 v[234:235], v15 offset:0
    ds_read_b64 v[236:237], v16 offset:0
    ds_read_b64 v[238:239], v17 offset:0
    ds_read_b64 v[240:241], v10 offset:4096
    ds_read_b64 v[242:243], v11 offset:4096
    ds_read_b64 v[244:245], v12 offset:4096
    ds_read_b64 v[246:247], v13 offset:4096
    ds_read_b64 v[248:249], v14 offset:4096
    ds_read_b64 v[250:251], v15 offset:4096
    ds_read_b64 v[252:253], v16 offset:4096
    ds_read_b64 v[254:255], v17 offset:4096
    s_barrier
    s_cmp_eq_u32 s20, 0
    s_cbranch_scc0 k_p_pub
    v_mov_b32 v7, s60
    v_mov_b32 v8, s100
    s_mov_b64 exec, 1
    global_store_dword v7, v8, s[98:99] offset:384 sc1
    s_mov_b64 exec, -1
k_p_pub:
    s_cmp_eq_u32 s24, 1
    s_cbranch_scc0 k_no_g
    v_cmp_ne_u32 vcc, s100, v30
    s_cbranch_vccz k_g_wait_ok
    s_mov_b32 s3, 0
    global_load_dword v30, v29, s[98:99] offset:512 sc1
k_g_wait:
    s_waitcnt vmcnt(0)
    v_cmp_ne_u32 vcc, s100, v30
    s_add_u32 s3, s3, 1
    s_cbranch_vccz k_g_wait_ok
    s_cmp_gt_u32 s3, 0x40000
    s_cbranch_scc1 k_g_wait_ok
    global_load_dword v30, v29, s[98:99] offset:512 sc1
    s_branch k_g_wait
k_g_wait_ok:
    buffer_load_dwordx4 v[96:99], v6, s[16:19], 0 offen offset:0 sc1
    buffer_load_dwordx4 v[100:103], v6, s[16:19], 0 offen offset:1024 sc1
    buffer_load_dwordx4 v[104:107], v6, s[16:19], 0 offen offset:2048 sc1
    buffer_load_dwordx4 v[108:111], v6, s[16:19], 0 offen offset:3072 sc1
    buffer_load_dwordx4 v[112:115], v6, s[16:19], s93 offen offset:0 sc1
    buffer_load_dwordx4 v[116:119], v6, s[16:19], s93 offen offset:1024 sc1
    buffer_load_dwordx4 v[120:123], v6, s[16:19], s93 offen offset:2048 sc1
    buffer_load_dwordx4 v[124:127], v6, s[16:19], s93 offen offset:3072 sc1
k_no_g:
    global_load_dword v30, v28, s[98:99] offset:384 sc1
    v_accvgpr_read_b32 v32, a0
    v_accvgpr_read_b32 v33, a1
    v_accvgpr_read_b32 v34, a2
    v_accvgpr_read_b32 v35, a3
    v_accvgpr_read_b32 v36, a4
    v_accvgpr_read_b32 v37, a5
    v_accvgpr_read_b32 v38, a6
    v_accvgpr_read_b32 v39, a7
    v_accvgpr_read_b32 v40, a8
    v_accvgpr_read_b32 v41, a9
    v_accvgpr_read_b32 v42, a10
    v_accvgpr_read_b32 v43, a11
    v_accvgpr_read_b32 v44, a12
    v_accvgpr_read_b32 v45, a13
    v_accvgpr_read_b32 v46, a14
    v_accvgpr_read_b32 v47, a15
    v_accvgpr_read_b32 v48, a16
    v_accvgpr_read_b32 v49, a17
    v_accvgpr_read_b32 v50, a18
    v_accvgpr_read_b32 v51, a19
    v_accvgpr_read_b32 v52, a20
    v_accvgpr_read_b32 v53, a21
    v_accvgpr_read_b32 v54, a22
    v_accvgpr_read_b32 v55, a23
    v_accvgpr_read_b32 v56, a24
    v_accvgpr_read_b32 v57, a25
    v_accvgpr_read_b32 v58, a26
    v_accvgpr_read_b32 v59, a27
    v_accvgpr_read_b32 v60, a28
    v_accvgpr_read_b32 v61, a29
    v_accvgpr_read_b32 v62, a30
    v_accvgpr_read_b32 v63, a31
    v_accvgpr_read_b32 v64, a32
    v_accvgpr_read_b32 v65, a33
    v_accvgpr_read_b32 v66, a34
    v_accvgpr_read_b32 v67, a35
    v_accvgpr_read_b32 v68, a36
    v_accvgpr_read_b32 v69, a37
    v_accvgpr_read_b32 v70, a38
    v_accvgpr_read_b32 v71, a39
    v_accvgpr_read_b32 v72, a40
    v_accvgpr_read_b32 v73, a41
    v_accvgpr_read_b32 v74, a42
    v_accvgpr_read_b32 v75, a43
    v_accvgpr_read_b32 v76, a44
    v_accvgpr_read_b32 v77, a45
    v_accvgpr_read_b32 v78, a46
    v_accvgpr_read_b32 v79, a47
    v_accvgpr_read_b32 v80, a48
    v_accvgpr_read_b32 v81, a49
    v_accvgpr_read_b32 v82, a50
    v_accvgpr_read_b32 v83, a51
    v_accvgpr_read_b32 v84, a52
    v_accvgpr_read_b32 v85, a53
    v_accvgpr_read_b32 v86, a54
    v_accvgpr_read_b32 v87, a55
    v_accvgpr_read_b32 v88, a56
    v_accvgpr_read_b32 v89, a57
    v_accvgpr_read_b32 v90, a58
    v_accvgpr_read_b32 v91, a59
    v_accvgpr_read_b32 v92, a60
    v_accvgpr_read_b32 v93, a61
    v_accvgpr_read_b32 v94, a62
    v_accvgpr_read_b32 v95, a63
    s_waitcnt lgkmcnt(0)
    v_lshlrev_b32 v160, 16, v224
    v_and_b32 v161, 0xffff0000, v224
    v_lshlrev_b32 v162, 16, v225
    v_and_b32 v163, 0xffff0000, v225
    v_lshlrev_b32 v164, 16, v226
    v_and_b32 v165, 0xffff0000, v226
    v_lshlrev_b32 v166, 16, v227
    v_and_b32 v167, 0xffff0000, v227
    v_lshlrev_b32 v168, 16, v228
    v_and_b32 v169, 0xffff0000, v228
    v_lshlrev_b32 v170, 16, v229
    v_and_b32 v171, 0xffff0000, v229
    v_lshlrev_b32 v172, 16, v230
    v_and_b32 v173, 0xffff0000, v230
    v_lshlrev_b32 v174, 16, v231
    v_and_b32 v175, 0xffff0000, v231
    v_lshlrev_b32 v176, 16, v232
    v_and_b32 v177, 0xffff0000, v232
    v_lshlrev_b32 v178, 16, v233
    v_and_b32 v179, 0xffff0000, v233
    v_lshlrev_b32 v180, 16, v234
    v_and_b32 v181, 0xffff0000, v234
    v_lshlrev_b32 v182, 16, v235
    v_and_b32 v183, 0xffff0000, v235
    v_lshlrev_b32 v184, 16, v236
    v_and_b32 v185, 0xffff0000, v236
    v_lshlrev_b32 v186, 16, v237
    v_and_b32 v187, 0xffff0000, v237
    v_lshlrev_b32 v188, 16, v238
    v_and_b32 v189, 0xffff0000, v238
    v_lshlrev_b32 v190, 16, v239
    v_and_b32 v191, 0xffff0000, v239
    v_lshlrev_b32 v192, 16, v240
    v_and_b32 v193, 0xffff0000, v240
    v_lshlrev_b32 v194, 16, v241
    v_and_b32 v195, 0xffff0000, v241
    v_lshlrev_b32 v196, 16, v242
    v_and_b32 v197, 0xffff0000, v242
    v_lshlrev_b32 v198, 16, v243
    v_and_b32 v199, 0xffff0000, v243
    v_lshlrev_b32 v200, 16, v244
    v_and_b32 v201, 0xffff0000, v244
    v_lshlrev_b32 v202, 16, v245
    v_and_b32 v203, 0xffff0000, v245
    v_lshlrev_b32 v204, 16, v246
    v_and_b32 v205, 0xffff0000, v246
    v_lshlrev_b32 v206, 16, v247
    v_and_b32 v207, 0xffff0000, v247
    v_lshlrev_b32 v208, 16, v248
    v_and_b32 v209, 0xffff0000, v248
    v_lshlrev_b32 v210, 16, v249
    v_and_b32 v211, 0xffff0000, v249
    v_lshlrev_b32 v212, 16, v250
    v_and_b32 v213, 0xffff0000, v250
    v_lshlrev_b32 v214, 16, v251
    v_and_b32 v215, 0xffff0000, v251
    v_lshlrev_b32 v216, 16, v252
    v_and_b32 v217, 0xffff0000, v252
    v_lshlrev_b32 v218, 16, v253
    v_and_b32 v219, 0xffff0000, v253
    v_lshlrev_b32 v220, 16, v254
    v_and_b32 v221, 0xffff0000, v254
    v_lshlrev_b32 v222, 16, v255
    v_and_b32 v223, 0xffff0000, v255
    s_mov_b32 s3, 0
k_p_wait:
    s_waitcnt vmcnt(0)
    v_cmp_ne_u32 vcc, s100, v30
    s_add_u32 s3, s3, 1
    s_cbranch_vccz k_p_wait_ok
    s_cmp_gt_u32 s3, 0x40000
    s_cbranch_scc1 k_p_wait_ok
    global_load_dword v30, v28, s[98:99] offset:384 sc1
    s_branch k_p_wait
k_p_wait_ok:
    buffer_load_dwordx4 v[128:131], v6, s[56:59], 0 offen offset:0 sc1
    buffer_load_dwordx4 v[132:135], v6, s[56:59], 0 offen offset:1024 sc1
    buffer_load_dwordx4 v[136:139], v6, s[56:59], 0 offen offset:2048 sc1
    buffer_load_dwordx4 v[140:143], v6, s[56:59], 0 offen offset:3072 sc1
    buffer_load_dwordx4 v[144:147], v6, s[56:59], s93 offen offset:0 sc1
    buffer_load_dwordx4 v[148:151], v6, s[56:59], s93 offen offset:1024 sc1
    buffer_load_dwordx4 v[152:155], v6, s[56:59], s93 offen offset:2048 sc1
    buffer_load_dwordx4 v[156:159], v6, s[56:59], s93 offen offset:3072 sc1
    s_cmp_eq_u32 s24, 1
    s_cbranch_scc1 k_epi_s
    s_waitcnt vmcnt(6)
    v_lshlrev_b32 v8, 16, v128
    v_and_b32 v9, 0xffff0000, v128
    v_pk_add_f32 v[32:33], v[32:33], v[8:9]
    v_lshlrev_b32 v8, 16, v129
    v_and_b32 v9, 0xffff0000, v129
    v_pk_add_f32 v[34:35], v[34:35], v[8:9]
    v_lshlrev_b32 v8, 16, v130
    v_and_b32 v9, 0xffff0000, v130
    v_pk_add_f32 v[36:37], v[36:37], v[8:9]
    v_lshlrev_b32 v8, 16, v131
    v_and_b32 v9, 0xffff0000, v131
    v_pk_add_f32 v[38:39], v[38:39], v[8:9]
    v_lshlrev_b32 v8, 16, v132
    v_and_b32 v9, 0xffff0000, v132
    v_pk_add_f32 v[40:41], v[40:41], v[8:9]
    v_lshlrev_b32 v8, 16, v133
    v_and_b32 v9, 0xffff0000, v133
    v_pk_add_f32 v[42:43], v[42:43], v[8:9]
    v_lshlrev_b32 v8, 16, v134
    v_and_b32 v9, 0xffff0000, v134
    v_pk_add_f32 v[44:45], v[44:45], v[8:9]
    v_lshlrev_b32 v8, 16, v135
    v_and_b32 v9, 0xffff0000, v135
    v_pk_add_f32 v[46:47], v[46:47], v[8:9]
    s_waitcnt vmcnt(4)
    v_lshlrev_b32 v8, 16, v136
    v_and_b32 v9, 0xffff0000, v136
    v_pk_add_f32 v[48:49], v[48:49], v[8:9]
    v_lshlrev_b32 v8, 16, v137
    v_and_b32 v9, 0xffff0000, v137
    v_pk_add_f32 v[50:51], v[50:51], v[8:9]
    v_lshlrev_b32 v8, 16, v138
    v_and_b32 v9, 0xffff0000, v138
    v_pk_add_f32 v[52:53], v[52:53], v[8:9]
    v_lshlrev_b32 v8, 16, v139
    v_and_b32 v9, 0xffff0000, v139
    v_pk_add_f32 v[54:55], v[54:55], v[8:9]
    v_lshlrev_b32 v8, 16, v140
    v_and_b32 v9, 0xffff0000, v140
    v_pk_add_f32 v[56:57], v[56:57], v[8:9]
    v_lshlrev_b32 v8, 16, v141
    v_and_b32 v9, 0xffff0000, v141
    v_pk_add_f32 v[58:59], v[58:59], v[8:9]
    v_lshlrev_b32 v8, 16, v142
    v_and_b32 v9, 0xffff0000, v142
    v_pk_add_f32 v[60:61], v[60:61], v[8:9]
    v_lshlrev_b32 v8, 16, v143
    v_and_b32 v9, 0xffff0000, v143
    v_pk_add_f32 v[62:63], v[62:63], v[8:9]
    s_waitcnt vmcnt(2)
    v_lshlrev_b32 v8, 16, v144
    v_and_b32 v9, 0xffff0000, v144
    v_pk_add_f32 v[64:65], v[64:65], v[8:9]
    v_lshlrev_b32 v8, 16, v145
    v_and_b32 v9, 0xffff0000, v145
    v_pk_add_f32 v[66:67], v[66:67], v[8:9]
    v_lshlrev_b32 v8, 16, v146
    v_and_b32 v9, 0xffff0000, v146
    v_pk_add_f32 v[68:69], v[68:69], v[8:9]
    v_lshlrev_b32 v8, 16, v147
    v_and_b32 v9, 0xffff0000, v147
    v_pk_add_f32 v[70:71], v[70:71], v[8:9]
    v_lshlrev_b32 v8, 16, v148
    v_and_b32 v9, 0xffff0000, v148
    v_pk_add_f32 v[72:73], v[72:73], v[8:9]
    v_lshlrev_b32 v8, 16, v149
    v_and_b32 v9, 0xffff0000, v149
    v_pk_add_f32 v[74:75], v[74:75], v[8:9]
    v_lshlrev_b32 v8, 16, v150
    v_and_b32 v9, 0xffff0000, v150
    v_pk_add_f32 v[76:77], v[76:77], v[8:9]
    v_lshlrev_b32 v8, 16, v151
    v_and_b32 v9, 0xffff0000, v151
    v_pk_add_f32 v[78:79], v[78:79], v[8:9]
    s_waitcnt vmcnt(0)
    v_lshlrev_b32 v8, 16, v152
    v_and_b32 v9, 0xffff0000, v152
    v_pk_add_f32 v[80:81], v[80:81], v[8:9]
    v_lshlrev_b32 v8, 16, v153
    v_and_b32 v9, 0xffff0000, v153
    v_pk_add_f32 v[82:83], v[82:83], v[8:9]
    v_lshlrev_b32 v8, 16, v154
    v_and_b32 v9, 0xffff0000, v154
    v_pk_add_f32 v[84:85], v[84:85], v[8:9]
    v_lshlrev_b32 v8, 16, v155
    v_and_b32 v9, 0xffff0000, v155
    v_pk_add_f32 v[86:87], v[86:87], v[8:9]
    v_lshlrev_b32 v8, 16, v156
    v_and_b32 v9, 0xffff0000, v156
    v_pk_add_f32 v[88:89], v[88:89], v[8:9]
    v_lshlrev_b32 v8, 16, v157
    v_and_b32 v9, 0xffff0000, v157
    v_pk_add_f32 v[90:91], v[90:91], v[8:9]
    v_lshlrev_b32 v8, 16, v158
    v_and_b32 v9, 0xffff0000, v158
    v_pk_add_f32 v[92:93], v[92:93], v[8:9]
    v_lshlrev_b32 v8, 16, v159
    v_and_b32 v9, 0xffff0000, v159
    v_pk_add_f32 v[94:95], v[94:95], v[8:9]
    v_pk_mul_f32 v[96:97], v[32:33], s[30:31]
    v_pk_mul_f32 v[98:99], v[34:35], s[30:31]
    v_pk_mul_f32 v[100:101], v[36:37], s[30:31]
    v_pk_mul_f32 v[102:103], v[38:39], s[30:31]
    v_pk_mul_f32 v[104:105], v[40:41], s[30:31]
    v_pk_mul_f32 v[106:107], v[42:43], s[30:31]
    v_pk_mul_f32 v[108:109], v[44:45], s[30:31]
    v_pk_mul_f32 v[110:111], v[46:47], s[30:31]
    v_pk_mul_f32 v[112:113], v[48:49], s[30:31]
    v_pk_mul_f32 v[114:115], v[50:51], s[30:31]
    v_pk_mul_f32 v[116:117], v[52:53], s[30:31]
    v_pk_mul_f32 v[118:119], v[54:55], s[30:31]
    v_pk_mul_f32 v[120:121], v[56:57], s[30:31]
    v_pk_mul_f32 v[122:123], v[58:59], s[30:31]
    v_pk_mul_f32 v[124:125], v[60:61], s[30:31]
    v_pk_mul_f32 v[126:127], v[62:63], s[30:31]
    v_exp_f32 v96, v96
    v_exp_f32 v97, v97
    v_exp_f32 v98, v98
    v_exp_f32 v99, v99
    v_exp_f32 v100, v100
    v_exp_f32 v101, v101
    v_exp_f32 v102, v102
    v_exp_f32 v103, v103
    v_exp_f32 v104, v104
    v_exp_f32 v105, v105
    v_exp_f32 v106, v106
    v_exp_f32 v107, v107
    v_exp_f32 v108, v108
    v_exp_f32 v109, v109
    v_exp_f32 v110, v110
    v_exp_f32 v111, v111
    v_exp_f32 v112, v112
    v_exp_f32 v113, v113
    v_exp_f32 v114, v114
    v_exp_f32 v115, v115
    v_exp_f32 v116, v116
    v_exp_f32 v117, v117
    v_exp_f32 v118, v118
    v_exp_f32 v119, v119
    v_exp_f32 v120, v120
    v_exp_f32 v121, v121
    v_exp_f32 v122, v122
    v_exp_f32 v123, v123
    v_exp_f32 v124, v124
    v_exp_f32 v125, v125
    v_exp_f32 v126, v126
    v_exp_f32 v127, v127
    v_pk_add_f32 v[96:97], v[96:97], 1.0 op_sel_hi:[1,0]
    v_pk_add_f32 v[98:99], v[98:99], 1.0 op_sel_hi:[1,0]
    v_pk_add_f32 v[100:101], v[100:101], 1.0 op_sel_hi:[1,0]
    v_pk_add_f32 v[102:103], v[102:103], 1.0 op_sel_hi:[1,0]
    v_pk_add_f32 v[104:105], v[104:105], 1.0 op_sel_hi:[1,0]
    v_pk_add_f32 v[106:107], v[106:107], 1.0 op_sel_hi:[1,0]
    v_pk_add_f32 v[108:109], v[108:109], 1.0 op_sel_hi:[1,0]
    v_pk_add_f32 v[110:111], v[110:111], 1.0 op_sel_hi:[1,0]
    v_pk_add_f32 v[112:113], v[112:113], 1.0 op_sel_hi:[1,0]
    v_pk_add_f32 v[114:115], v[114:115], 1.0 op_sel_hi:[1,0]
    v_pk_add_f32 v[116:117], v[116:117], 1.0 op_sel_hi:[1,0]
    v_pk_add_f32 v[118:119], v[118:119], 1.0 op_sel_hi:[1,0]
    v_pk_add_f32 v[120:121], v[120:121], 1.0 op_sel_hi:[1,0]
    v_pk_add_f32 v[122:123], v[122:123], 1.0 op_sel_hi:[1,0]
    v_pk_add_f32 v[124:125], v[124:125], 1.0 op_sel_hi:[1,0]
    v_pk_add_f32 v[126:127], v[126:127], 1.0 op_sel_hi:[1,0]
    v_rcp_f32 v96, v96
    v_rcp_f32 v97, v97
    v_rcp_f32 v98, v98
    v_rcp_f32 v99, v99
    v_rcp_f32 v100, v100
    v_rcp_f32 v101, v101
    v_rcp_f32 v102, v102
    v_rcp_f32 v103, v103
    v_rcp_f32 v104, v104
    v_rcp_f32 v105, v105
    v_rcp_f32 v106, v106
    v_rcp_f32 v107, v107
    v_rcp_f32 v108, v108
    v_rcp_f32 v109, v109
    v_rcp_f32 v110, v110
    v_rcp_f32 v111, v111
    v_rcp_f32 v112, v112
    v_rcp_f32 v113, v113
    v_rcp_f32 v114, v114
    v_rcp_f32 v115, v115
    v_rcp_f32 v116, v116
    v_rcp_f32 v117, v117
    v_rcp_f32 v118, v118
    v_rcp_f32 v119, v119
    v_rcp_f32 v120, v120
    v_rcp_f32 v121, v121
    v_rcp_f32 v122, v122
    v_rcp_f32 v123, v123
    v_rcp_f32 v124, v124
    v_rcp_f32 v125, v125
    v_rcp_f32 v126, v126
    v_rcp_f32 v127, v127
    v_pk_mul_f32 v[32:33], v[32:33], v[96:97]
    v_pk_mul_f32 v[34:35], v[34:35], v[98:99]
    v_pk_mul_f32 v[36:37], v[36:37], v[100:101]
    v_pk_mul_f32 v[38:39], v[38:39], v[102:103]
    v_pk_mul_f32 v[40:41], v[40:41], v[104:105]
    v_pk_mul_f32 v[42:43], v[42:43], v[106:107]
    v_pk_mul_f32 v[44:45], v[44:45], v[108:109]
    v_pk_mul_f32 v[46:47], v[46:47], v[110:111]
    v_pk_mul_f32 v[48:49], v[48:49], v[112:113]
    v_pk_mul_f32 v[50:51], v[50:51], v[114:115]
    v_pk_mul_f32 v[52:53], v[52:53], v[116:117]
    v_pk_mul_f32 v[54:55], v[54:55], v[118:119]
    v_pk_mul_f32 v[56:57], v[56:57], v[120:121]
    v_pk_mul_f32 v[58:59], v[58:59], v[122:123]
    v_pk_mul_f32 v[60:61], v[60:61], v[124:125]
    v_pk_mul_f32 v[62:63], v[62:63], v[126:127]
    v_cvt_pk_bf16_f32 v160, v32, v33
    v_cvt_pk_bf16_f32 v161, v34, v35
    v_cvt_pk_bf16_f32 v162, v36, v37
    v_cvt_pk_bf16_f32 v163, v38, v39
    v_cvt_pk_bf16_f32 v164, v40, v41
    v_cvt_pk_bf16_f32 v165, v42, v43
    v_cvt_pk_bf16_f32 v166, v44, v45
    v_cvt_pk_bf16_f32 v167, v46, v47
    v_cvt_pk_bf16_f32 v168, v48, v49
    v_cvt_pk_bf16_f32 v169, v50, v51
    v_cvt_pk_bf16_f32 v170, v52, v53
    v_cvt_pk_bf16_f32 v171, v54, v55
    v_cvt_pk_bf16_f32 v172, v56, v57
    v_cvt_pk_bf16_f32 v173, v58, v59
    v_cvt_pk_bf16_f32 v174, v60, v61
    v_cvt_pk_bf16_f32 v175, v62, v63
    buffer_store_dwordx4 v[160:163], v6, s[52:55], s94 offen offset:0 sc1
    buffer_store_dwordx4 v[164:167], v6, s[52:55], s94 offen offset:1024 sc1
    buffer_store_dwordx4 v[168:171], v6, s[52:55], s94 offen offset:2048 sc1
    buffer_store_dwordx4 v[172:175], v6, s[52:55], s94 offen offset:3072 sc1
    v_pk_mul_f32 v[96:97], v[64:65], s[30:31]
    v_pk_mul_f32 v[98:99], v[66:67], s[30:31]
    v_pk_mul_f32 v[100:101], v[68:69], s[30:31]
    v_pk_mul_f32 v[102:103], v[70:71], s[30:31]
    v_pk_mul_f32 v[104:105], v[72:73], s[30:31]
    v_pk_mul_f32 v[106:107], v[74:75], s[30:31]
    v_pk_mul_f32 v[108:109], v[76:77], s[30:31]
    v_pk_mul_f32 v[110:111], v[78:79], s[30:31]
    v_pk_mul_f32 v[112:113], v[80:81], s[30:31]
    v_pk_mul_f32 v[114:115], v[82:83], s[30:31]
    v_pk_mul_f32 v[116:117], v[84:85], s[30:31]
    v_pk_mul_f32 v[118:119], v[86:87], s[30:31]
    v_pk_mul_f32 v[120:121], v[88:89], s[30:31]
    v_pk_mul_f32 v[122:123], v[90:91], s[30:31]
    v_pk_mul_f32 v[124:125], v[92:93], s[30:31]
    v_pk_mul_f32 v[126:127], v[94:95], s[30:31]
    v_exp_f32 v96, v96
    v_exp_f32 v97, v97
    v_exp_f32 v98, v98
    v_exp_f32 v99, v99
    v_exp_f32 v100, v100
    v_exp_f32 v101, v101
    v_exp_f32 v102, v102
    v_exp_f32 v103, v103
    v_exp_f32 v104, v104
    v_exp_f32 v105, v105
    v_exp_f32 v106, v106
    v_exp_f32 v107, v107
    v_exp_f32 v108, v108
    v_exp_f32 v109, v109
    v_exp_f32 v110, v110
    v_exp_f32 v111, v111
    v_exp_f32 v112, v112
    v_exp_f32 v113, v113
    v_exp_f32 v114, v114
    v_exp_f32 v115, v115
    v_exp_f32 v116, v116
    v_exp_f32 v117, v117
    v_exp_f32 v118, v118
    v_exp_f32 v119, v119
    v_exp_f32 v120, v120
    v_exp_f32 v121, v121
    v_exp_f32 v122, v122
    v_exp_f32 v123, v123
    v_exp_f32 v124, v124
    v_exp_f32 v125, v125
    v_exp_f32 v126, v126
    v_exp_f32 v127, v127
    v_pk_add_f32 v[96:97], v[96:97], 1.0 op_sel_hi:[1,0]
    v_pk_add_f32 v[98:99], v[98:99], 1.0 op_sel_hi:[1,0]
    v_pk_add_f32 v[100:101], v[100:101], 1.0 op_sel_hi:[1,0]
    v_pk_add_f32 v[102:103], v[102:103], 1.0 op_sel_hi:[1,0]
    v_pk_add_f32 v[104:105], v[104:105], 1.0 op_sel_hi:[1,0]
    v_pk_add_f32 v[106:107], v[106:107], 1.0 op_sel_hi:[1,0]
    v_pk_add_f32 v[108:109], v[108:109], 1.0 op_sel_hi:[1,0]
    v_pk_add_f32 v[110:111], v[110:111], 1.0 op_sel_hi:[1,0]
    v_pk_add_f32 v[112:113], v[112:113], 1.0 op_sel_hi:[1,0]
    v_pk_add_f32 v[114:115], v[114:115], 1.0 op_sel_hi:[1,0]
    v_pk_add_f32 v[116:117], v[116:117], 1.0 op_sel_hi:[1,0]
    v_pk_add_f32 v[118:119], v[118:119], 1.0 op_sel_hi:[1,0]
    v_pk_add_f32 v[120:121], v[120:121], 1.0 op_sel_hi:[1,0]
    v_pk_add_f32 v[122:123], v[122:123], 1.0 op_sel_hi:[1,0]
    v_pk_add_f32 v[124:125], v[124:125], 1.0 op_sel_hi:[1,0]
    v_pk_add_f32 v[126:127], v[126:127], 1.0 op_sel_hi:[1,0]
    v_rcp_f32 v96, v96
    v_rcp_f32 v97, v97
    v_rcp_f32 v98, v98
    v_rcp_f32 v99, v99
    v_rcp_f32 v100, v100
    v_rcp_f32 v101, v101
    v_rcp_f32 v102, v102
    v_rcp_f32 v103, v103
    v_rcp_f32 v104, v104
    v_rcp_f32 v105, v105
    v_rcp_f32 v106, v106
    v_rcp_f32 v107, v107
    v_rcp_f32 v108, v108
    v_rcp_f32 v109, v109
    v_rcp_f32 v110, v110
    v_rcp_f32 v111, v111
    v_rcp_f32 v112, v112
    v_rcp_f32 v113, v113
    v_rcp_f32 v114, v114
    v_rcp_f32 v115, v115
    v_rcp_f32 v116, v116
    v_rcp_f32 v117, v117
    v_rcp_f32 v118, v118
    v_rcp_f32 v119, v119
    v_rcp_f32 v120, v120
    v_rcp_f32 v121, v121
    v_rcp_f32 v122, v122
    v_rcp_f32 v123, v123
    v_rcp_f32 v124, v124
    v_rcp_f32 v125, v125
    v_rcp_f32 v126, v126
    v_rcp_f32 v127, v127
    v_pk_mul_f32 v[64:65], v[64:65], v[96:97]
    v_pk_mul_f32 v[66:67], v[66:67], v[98:99]
    v_pk_mul_f32 v[68:69], v[68:69], v[100:101]
    v_pk_mul_f32 v[70:71], v[70:71], v[102:103]
    v_pk_mul_f32 v[72:73], v[72:73], v[104:105]
    v_pk_mul_f32 v[74:75], v[74:75], v[106:107]
    v_pk_mul_f32 v[76:77], v[76:77], v[108:109]
    v_pk_mul_f32 v[78:79], v[78:79], v[110:111]
    v_pk_mul_f32 v[80:81], v[80:81], v[112:113]
    v_pk_mul_f32 v[82:83], v[82:83], v[114:115]
    v_pk_mul_f32 v[84:85], v[84:85], v[116:117]
    v_pk_mul_f32 v[86:87], v[86:87], v[118:119]
    v_pk_mul_f32 v[88:89], v[88:89], v[120:121]
    v_pk_mul_f32 v[90:91], v[90:91], v[122:123]
    v_pk_mul_f32 v[92:93], v[92:93], v[124:125]
    v_pk_mul_f32 v[94:95], v[94:95], v[126:127]
    v_cvt_pk_bf16_f32 v176, v64, v65
    v_cvt_pk_bf16_f32 v177, v66, v67
    v_cvt_pk_bf16_f32 v178, v68, v69
    v_cvt_pk_bf16_f32 v179, v70, v71
    v_cvt_pk_bf16_f32 v180, v72, v73
    v_cvt_pk_bf16_f32 v181, v74, v75
    v_cvt_pk_bf16_f32 v182, v76, v77
    v_cvt_pk_bf16_f32 v183, v78, v79
    v_cvt_pk_bf16_f32 v184, v80, v81
    v_cvt_pk_bf16_f32 v185, v82, v83
    v_cvt_pk_bf16_f32 v186, v84, v85
    v_cvt_pk_bf16_f32 v187, v86, v87
    v_cvt_pk_bf16_f32 v188, v88, v89
    v_cvt_pk_bf16_f32 v189, v90, v91
    v_cvt_pk_bf16_f32 v190, v92, v93
    v_cvt_pk_bf16_f32 v191, v94, v95
    buffer_store_dwordx4 v[176:179], v6, s[52:55], s95 offen offset:0 sc1
    buffer_store_dwordx4 v[180:183], v6, s[52:55], s95 offen offset:1024 sc1
    buffer_store_dwordx4 v[184:187], v6, s[52:55], s95 offen offset:2048 sc1
    buffer_store_dwordx4 v[188:191], v6, s[52:55], s95 offen offset:3072 sc1
    s_waitcnt vmcnt(0)
    s_barrier
    s_cmp_eq_u32 s20, 0
    s_cbranch_scc0 k_g_pub
    v_mov_b32 v7, s60
    v_mov_b32 v8, s100
    s_mov_b64 exec, 1
    global_store_dword v7, v8, s[98:99] offset:512 sc1
    s_mov_b64 exec, -1
k_g_pub:
    s_endpgm
k_epi_s:
    v_lshlrev_b32 v8, 16, v96
    v_and_b32 v9, 0xffff0000, v96
    v_pk_fma_f32 v[160:161], v[32:33], v[8:9], v[160:161]
    v_pk_mul_f32 v[32:33], v[8:9], 1.0 op_sel_hi:[1,0]
    v_lshlrev_b32 v8, 16, v97
    v_and_b32 v9, 0xffff0000, v97
    v_pk_fma_f32 v[162:163], v[34:35], v[8:9], v[162:163]
    v_pk_mul_f32 v[34:35], v[8:9], 1.0 op_sel_hi:[1,0]
    v_lshlrev_b32 v8, 16, v98
    v_and_b32 v9, 0xffff0000, v98
    v_pk_fma_f32 v[164:165], v[36:37], v[8:9], v[164:165]
    v_pk_mul_f32 v[36:37], v[8:9], 1.0 op_sel_hi:[1,0]
    v_lshlrev_b32 v8, 16, v99
    v_and_b32 v9, 0xffff0000, v99
    v_pk_fma_f32 v[166:167], v[38:39], v[8:9], v[166:167]
    v_pk_mul_f32 v[38:39], v[8:9], 1.0 op_sel_hi:[1,0]
    v_lshlrev_b32 v8, 16, v100
    v_and_b32 v9, 0xffff0000, v100
    v_pk_fma_f32 v[168:169], v[40:41], v[8:9], v[168:169]
    v_pk_mul_f32 v[40:41], v[8:9], 1.0 op_sel_hi:[1,0]
    v_lshlrev_b32 v8, 16, v101
    v_and_b32 v9, 0xffff0000, v101
    v_pk_fma_f32 v[170:171], v[42:43], v[8:9], v[170:171]
    v_pk_mul_f32 v[42:43], v[8:9], 1.0 op_sel_hi:[1,0]
    v_lshlrev_b32 v8, 16, v102
    v_and_b32 v9, 0xffff0000, v102
    v_pk_fma_f32 v[172:173], v[44:45], v[8:9], v[172:173]
    v_pk_mul_f32 v[44:45], v[8:9], 1.0 op_sel_hi:[1,0]
    v_lshlrev_b32 v8, 16, v103
    v_and_b32 v9, 0xffff0000, v103
    v_pk_fma_f32 v[174:175], v[46:47], v[8:9], v[174:175]
    v_pk_mul_f32 v[46:47], v[8:9], 1.0 op_sel_hi:[1,0]
    v_lshlrev_b32 v8, 16, v104
    v_and_b32 v9, 0xffff0000, v104
    v_pk_fma_f32 v[176:177], v[48:49], v[8:9], v[176:177]
    v_pk_mul_f32 v[48:49], v[8:9], 1.0 op_sel_hi:[1,0]
    v_lshlrev_b32 v8, 16, v105
    v_and_b32 v9, 0xffff0000, v105
    v_pk_fma_f32 v[178:179], v[50:51], v[8:9], v[178:179]
    v_pk_mul_f32 v[50:51], v[8:9], 1.0 op_sel_hi:[1,0]
    v_lshlrev_b32 v8, 16, v106
    v_and_b32 v9, 0xffff0000, v106
    v_pk_fma_f32 v[180:181], v[52:53], v[8:9], v[180:181]
    v_pk_mul_f32 v[52:53], v[8:9], 1.0 op_sel_hi:[1,0]
    v_lshlrev_b32 v8, 16, v107
    v_and_b32 v9, 0xffff0000, v107
    v_pk_fma_f32 v[182:183], v[54:55], v[8:9], v[182:183]
    v_pk_mul_f32 v[54:55], v[8:9], 1.0 op_sel_hi:[1,0]
    v_lshlrev_b32 v8, 16, v108
    v_and_b32 v9, 0xffff0000, v108
    v_pk_fma_f32 v[184:185], v[56:57], v[8:9], v[184:185]
    v_pk_mul_f32 v[56:57], v[8:9], 1.0 op_sel_hi:[1,0]
    v_lshlrev_b32 v8, 16, v109
    v_and_b32 v9, 0xffff0000, v109
    v_pk_fma_f32 v[186:187], v[58:59], v[8:9], v[186:187]
    v_pk_mul_f32 v[58:59], v[8:9], 1.0 op_sel_hi:[1,0]
    v_lshlrev_b32 v8, 16, v110
    v_and_b32 v9, 0xffff0000, v110
    v_pk_fma_f32 v[188:189], v[60:61], v[8:9], v[188:189]
    v_pk_mul_f32 v[60:61], v[8:9], 1.0 op_sel_hi:[1,0]
    v_lshlrev_b32 v8, 16, v111
    v_and_b32 v9, 0xffff0000, v111
    v_pk_fma_f32 v[190:191], v[62:63], v[8:9], v[190:191]
    v_pk_mul_f32 v[62:63], v[8:9], 1.0 op_sel_hi:[1,0]
    v_lshlrev_b32 v8, 16, v112
    v_and_b32 v9, 0xffff0000, v112
    v_pk_fma_f32 v[192:193], v[64:65], v[8:9], v[192:193]
    v_pk_mul_f32 v[64:65], v[8:9], 1.0 op_sel_hi:[1,0]
    v_lshlrev_b32 v8, 16, v113
    v_and_b32 v9, 0xffff0000, v113
    v_pk_fma_f32 v[194:195], v[66:67], v[8:9], v[194:195]
    v_pk_mul_f32 v[66:67], v[8:9], 1.0 op_sel_hi:[1,0]
    v_lshlrev_b32 v8, 16, v114
    v_and_b32 v9, 0xffff0000, v114
    v_pk_fma_f32 v[196:197], v[68:69], v[8:9], v[196:197]
    v_pk_mul_f32 v[68:69], v[8:9], 1.0 op_sel_hi:[1,0]
    v_lshlrev_b32 v8, 16, v115
    v_and_b32 v9, 0xffff0000, v115
    v_pk_fma_f32 v[198:199], v[70:71], v[8:9], v[198:199]
    v_pk_mul_f32 v[70:71], v[8:9], 1.0 op_sel_hi:[1,0]
    v_lshlrev_b32 v8, 16, v116
    v_and_b32 v9, 0xffff0000, v116
    v_pk_fma_f32 v[200:201], v[72:73], v[8:9], v[200:201]
    v_pk_mul_f32 v[72:73], v[8:9], 1.0 op_sel_hi:[1,0]
    v_lshlrev_b32 v8, 16, v117
    v_and_b32 v9, 0xffff0000, v117
    v_pk_fma_f32 v[202:203], v[74:75], v[8:9], v[202:203]
    v_pk_mul_f32 v[74:75], v[8:9], 1.0 op_sel_hi:[1,0]
    v_lshlrev_b32 v8, 16, v118
    v_and_b32 v9, 0xffff0000, v118
    v_pk_fma_f32 v[204:205], v[76:77], v[8:9], v[204:205]
    v_pk_mul_f32 v[76:77], v[8:9], 1.0 op_sel_hi:[1,0]
    v_lshlrev_b32 v8, 16, v119
    v_and_b32 v9, 0xffff0000, v119
    v_pk_fma_f32 v[206:207], v[78:79], v[8:9], v[206:207]
    v_pk_mul_f32 v[78:79], v[8:9], 1.0 op_sel_hi:[1,0]
    v_lshlrev_b32 v8, 16, v120
    v_and_b32 v9, 0xffff0000, v120
    v_pk_fma_f32 v[208:209], v[80:81], v[8:9], v[208:209]
    v_pk_mul_f32 v[80:81], v[8:9], 1.0 op_sel_hi:[1,0]
    v_lshlrev_b32 v8, 16, v121
    v_and_b32 v9, 0xffff0000, v121
    v_pk_fma_f32 v[210:211], v[82:83], v[8:9], v[210:211]
    v_pk_mul_f32 v[82:83], v[8:9], 1.0 op_sel_hi:[1,0]
    v_lshlrev_b32 v8, 16, v122
    v_and_b32 v9, 0xffff0000, v122
    v_pk_fma_f32 v[212:213], v[84:85], v[8:9], v[212:213]
    v_pk_mul_f32 v[84:85], v[8:9], 1.0 op_sel_hi:[1,0]
    v_lshlrev_b32 v8, 16, v123
    v_and_b32 v9, 0xffff0000, v123
    v_pk_fma_f32 v[214:215], v[86:87], v[8:9], v[214:215]
    v_pk_mul_f32 v[86:87], v[8:9], 1.0 op_sel_hi:[1,0]
    v_lshlrev_b32 v8, 16, v124
    v_and_b32 v9, 0xffff0000, v124
    v_pk_fma_f32 v[216:217], v[88:89], v[8:9], v[216:217]
    v_pk_mul_f32 v[88:89], v[8:9], 1.0 op_sel_hi:[1,0]
    v_lshlrev_b32 v8, 16, v125
    v_and_b32 v9, 0xffff0000, v125
    v_pk_fma_f32 v[218:219], v[90:91], v[8:9], v[218:219]
    v_pk_mul_f32 v[90:91], v[8:9], 1.0 op_sel_hi:[1,0]
    v_lshlrev_b32 v8, 16, v126
    v_and_b32 v9, 0xffff0000, v126
    v_pk_fma_f32 v[220:221], v[92:93], v[8:9], v[220:221]
    v_pk_mul_f32 v[92:93], v[8:9], 1.0 op_sel_hi:[1,0]
    v_lshlrev_b32 v8, 16, v127
    v_and_b32 v9, 0xffff0000, v127
    v_pk_fma_f32 v[222:223], v[94:95], v[8:9], v[222:223]
    v_pk_mul_f32 v[94:95], v[8:9], 1.0 op_sel_hi:[1,0]
    s_waitcnt vmcnt(6)
    v_lshlrev_b32 v8, 16, v128
    v_and_b32 v9, 0xffff0000, v128
    v_pk_fma_f32 v[160:161], v[8:9], v[32:33], v[160:161]
    v_cvt_pk_bf16_f32 v224, v160, v161
    v_lshlrev_b32 v8, 16, v129
    v_and_b32 v9, 0xffff0000, v129
    v_pk_fma_f32 v[162:163], v[8:9], v[34:35], v[162:163]
    v_cvt_pk_bf16_f32 v225, v162, v163
    v_lshlrev_b32 v8, 16, v130
    v_and_b32 v9, 0xffff0000, v130
    v_pk_fma_f32 v[164:165], v[8:9], v[36:37], v[164:165]
    v_cvt_pk_bf16_f32 v226, v164, v165
    v_lshlrev_b32 v8, 16, v131
    v_and_b32 v9, 0xffff0000, v131
    v_pk_fma_f32 v[166:167], v[8:9], v[38:39], v[166:167]
    v_cvt_pk_bf16_f32 v227, v166, v167
    v_lshlrev_b32 v8, 16, v132
    v_and_b32 v9, 0xffff0000, v132
    v_pk_fma_f32 v[168:169], v[8:9], v[40:41], v[168:169]
    v_cvt_pk_bf16_f32 v228, v168, v169
    v_lshlrev_b32 v8, 16, v133
    v_and_b32 v9, 0xffff0000, v133
    v_pk_fma_f32 v[170:171], v[8:9], v[42:43], v[170:171]
    v_cvt_pk_bf16_f32 v229, v170, v171
    v_lshlrev_b32 v8, 16, v134
    v_and_b32 v9, 0xffff0000, v134
    v_pk_fma_f32 v[172:173], v[8:9], v[44:45], v[172:173]
    v_cvt_pk_bf16_f32 v230, v172, v173
    v_lshlrev_b32 v8, 16, v135
    v_and_b32 v9, 0xffff0000, v135
    v_pk_fma_f32 v[174:175], v[8:9], v[46:47], v[174:175]
    v_cvt_pk_bf16_f32 v231, v174, v175
    s_waitcnt vmcnt(4)
    v_lshlrev_b32 v8, 16, v136
    v_and_b32 v9, 0xffff0000, v136
    v_pk_fma_f32 v[176:177], v[8:9], v[48:49], v[176:177]
    v_cvt_pk_bf16_f32 v232, v176, v177
    v_lshlrev_b32 v8, 16, v137
    v_and_b32 v9, 0xffff0000, v137
    v_pk_fma_f32 v[178:179], v[8:9], v[50:51], v[178:179]
    v_cvt_pk_bf16_f32 v233, v178, v179
    v_lshlrev_b32 v8, 16, v138
    v_and_b32 v9, 0xffff0000, v138
    v_pk_fma_f32 v[180:181], v[8:9], v[52:53], v[180:181]
    v_cvt_pk_bf16_f32 v234, v180, v181
    v_lshlrev_b32 v8, 16, v139
    v_and_b32 v9, 0xffff0000, v139
    v_pk_fma_f32 v[182:183], v[8:9], v[54:55], v[182:183]
    v_cvt_pk_bf16_f32 v235, v182, v183
    v_lshlrev_b32 v8, 16, v140
    v_and_b32 v9, 0xffff0000, v140
    v_pk_fma_f32 v[184:185], v[8:9], v[56:57], v[184:185]
    v_cvt_pk_bf16_f32 v236, v184, v185
    v_lshlrev_b32 v8, 16, v141
    v_and_b32 v9, 0xffff0000, v141
    v_pk_fma_f32 v[186:187], v[8:9], v[58:59], v[186:187]
    v_cvt_pk_bf16_f32 v237, v186, v187
    v_lshlrev_b32 v8, 16, v142
    v_and_b32 v9, 0xffff0000, v142
    v_pk_fma_f32 v[188:189], v[8:9], v[60:61], v[188:189]
    v_cvt_pk_bf16_f32 v238, v188, v189
    v_lshlrev_b32 v8, 16, v143
    v_and_b32 v9, 0xffff0000, v143
    v_pk_fma_f32 v[190:191], v[8:9], v[62:63], v[190:191]
    v_cvt_pk_bf16_f32 v239, v190, v191
    ds_write_b64 v10, v[224:225] offset:0
    ds_write_b64 v11, v[226:227] offset:0
    ds_write_b64 v12, v[228:229] offset:0
    ds_write_b64 v13, v[230:231] offset:0
    ds_write_b64 v14, v[232:233] offset:0
    ds_write_b64 v15, v[234:235] offset:0
    ds_write_b64 v16, v[236:237] offset:0
    ds_write_b64 v17, v[238:239] offset:0
    s_waitcnt vmcnt(2)
    v_lshlrev_b32 v8, 16, v144
    v_and_b32 v9, 0xffff0000, v144
    v_pk_fma_f32 v[192:193], v[8:9], v[64:65], v[192:193]
    v_cvt_pk_bf16_f32 v240, v192, v193
    v_lshlrev_b32 v8, 16, v145
    v_and_b32 v9, 0xffff0000, v145
    v_pk_fma_f32 v[194:195], v[8:9], v[66:67], v[194:195]
    v_cvt_pk_bf16_f32 v241, v194, v195
    v_lshlrev_b32 v8, 16, v146
    v_and_b32 v9, 0xffff0000, v146
    v_pk_fma_f32 v[196:197], v[8:9], v[68:69], v[196:197]
    v_cvt_pk_bf16_f32 v242, v196, v197
    v_lshlrev_b32 v8, 16, v147
    v_and_b32 v9, 0xffff0000, v147
    v_pk_fma_f32 v[198:199], v[8:9], v[70:71], v[198:199]
    v_cvt_pk_bf16_f32 v243, v198, v199
    v_lshlrev_b32 v8, 16, v148
    v_and_b32 v9, 0xffff0000, v148
    v_pk_fma_f32 v[200:201], v[8:9], v[72:73], v[200:201]
    v_cvt_pk_bf16_f32 v244, v200, v201
    v_lshlrev_b32 v8, 16, v149
    v_and_b32 v9, 0xffff0000, v149
    v_pk_fma_f32 v[202:203], v[8:9], v[74:75], v[202:203]
    v_cvt_pk_bf16_f32 v245, v202, v203
    v_lshlrev_b32 v8, 16, v150
    v_and_b32 v9, 0xffff0000, v150
    v_pk_fma_f32 v[204:205], v[8:9], v[76:77], v[204:205]
    v_cvt_pk_bf16_f32 v246, v204, v205
    v_lshlrev_b32 v8, 16, v151
    v_and_b32 v9, 0xffff0000, v151
    v_pk_fma_f32 v[206:207], v[8:9], v[78:79], v[206:207]
    v_cvt_pk_bf16_f32 v247, v206, v207
    s_waitcnt vmcnt(0)
    v_lshlrev_b32 v8, 16, v152
    v_and_b32 v9, 0xffff0000, v152
    v_pk_fma_f32 v[208:209], v[8:9], v[80:81], v[208:209]
    v_cvt_pk_bf16_f32 v248, v208, v209
    v_lshlrev_b32 v8, 16, v153
    v_and_b32 v9, 0xffff0000, v153
    v_pk_fma_f32 v[210:211], v[8:9], v[82:83], v[210:211]
    v_cvt_pk_bf16_f32 v249, v210, v211
    v_lshlrev_b32 v8, 16, v154
    v_and_b32 v9, 0xffff0000, v154
    v_pk_fma_f32 v[212:213], v[8:9], v[84:85], v[212:213]
    v_cvt_pk_bf16_f32 v250, v212, v213
    v_lshlrev_b32 v8, 16, v155
    v_and_b32 v9, 0xffff0000, v155
    v_pk_fma_f32 v[214:215], v[8:9], v[86:87], v[214:215]
    v_cvt_pk_bf16_f32 v251, v214, v215
    v_lshlrev_b32 v8, 16, v156
    v_and_b32 v9, 0xffff0000, v156
    v_pk_fma_f32 v[216:217], v[8:9], v[88:89], v[216:217]
    v_cvt_pk_bf16_f32 v252, v216, v217
    v_lshlrev_b32 v8, 16, v157
    v_and_b32 v9, 0xffff0000, v157
    v_pk_fma_f32 v[218:219], v[8:9], v[90:91], v[218:219]
    v_cvt_pk_bf16_f32 v253, v218, v219
    v_lshlrev_b32 v8, 16, v158
    v_and_b32 v9, 0xffff0000, v158
    v_pk_fma_f32 v[220:221], v[8:9], v[92:93], v[220:221]
    v_cvt_pk_bf16_f32 v254, v220, v221
    v_lshlrev_b32 v8, 16, v159
    v_and_b32 v9, 0xffff0000, v159
    v_pk_fma_f32 v[222:223], v[8:9], v[94:95], v[222:223]
    v_cvt_pk_bf16_f32 v255, v222, v223
    ds_write_b64 v10, v[240:241] offset:4096
    ds_write_b64 v11, v[242:243] offset:4096
    ds_write_b64 v12, v[244:245] offset:4096
    ds_write_b64 v13, v[246:247] offset:4096
    ds_write_b64 v14, v[248:249] offset:4096
    ds_write_b64 v15, v[250:251] offset:4096
    ds_write_b64 v16, v[252:253] offset:4096
    ds_write_b64 v17, v[254:255] offset:4096
    v_accvgpr_read_b32 v20, a128
    v_accvgpr_read_b32 v21, a129
    v_accvgpr_read_b32 v22, a130
    v_accvgpr_read_b32 v23, a131
    v_add_u32 v7, s97, v6
    s_waitcnt lgkmcnt(0)
    ds_read_b128 v[32:35], v7 offset:0
    ds_read_b128 v[36:39], v7 offset:1024
    ds_read_b128 v[40:43], v7 offset:2048
    ds_read_b128 v[44:47], v7 offset:3072
    ds_read_b128 v[48:51], v7 offset:4096
    ds_read_b128 v[52:55], v7 offset:5120
    ds_read_b128 v[56:59], v7 offset:6144
    ds_read_b128 v[60:63], v7 offset:7168
    s_waitcnt lgkmcnt(7)
    buffer_store_dwordx4 v[32:35], v20, s[44:47], 0 offen offset:0 sc1
    s_waitcnt lgkmcnt(6)
    buffer_store_dwordx4 v[36:39], v21, s[44:47], 0 offen offset:1024 sc1
    s_waitcnt lgkmcnt(5)
    buffer_store_dwordx4 v[40:43], v22, s[44:47], 0 offen offset:2048 sc1
    s_waitcnt lgkmcnt(4)
    buffer_store_dwordx4 v[44:47], v23, s[44:47], 0 offen offset:3072 sc1
    s_waitcnt lgkmcnt(3)
    buffer_store_dwordx4 v[48:51], v20, s[44:47], s96 offen offset:0 sc1
    s_waitcnt lgkmcnt(2)
    buffer_store_dwordx4 v[52:55], v21, s[44:47], s96 offen offset:1024 sc1
    s_waitcnt lgkmcnt(1)
    buffer_store_dwordx4 v[56:59], v22, s[44:47], s96 offen offset:2048 sc1
    s_waitcnt lgkmcnt(0)
    buffer_store_dwordx4 v[60:63], v23, s[44:47], s96 offen offset:3072 sc1
k_done:
    s_endpgm
code_end:
.section .rodata,"a"
.p2align 6
.amdhsa_kernel recurrent_scan__mha_block_cached__dense_activation_silu__prompt_kernel
  .amdhsa_next_free_vgpr 512
  .amdhsa_next_free_sgpr 102
  .amdhsa_accum_offset 256
  .amdhsa_group_segment_fixed_size 0
  .amdhsa_kernarg_size 88
  .amdhsa_user_sgpr_count 2
  .amdhsa_user_sgpr_kernarg_segment_ptr 1
  .amdhsa_system_sgpr_workgroup_id_x 1
.end_amdhsa_kernel
```
